```python
import torch

def _softmax(x, axis=-1):
    return torch.softmax(x, dim=axis)
def _gelu(x):
    return torch.nn.functional.gelu(x, approximate="tanh")
def _silu(x):
    return torch.nn.functional.silu(x)
def _sigmoid(x):
    return torch.sigmoid(x)
def _layernorm(x, axis=-1, eps=1e-5):
    m = x.mean(dim=axis, keepdim=True)
    v = x.var(dim=axis, keepdim=True, unbiased=False)
    return (x - m) / torch.sqrt(v + eps)
def _scatter_add(tgt, idx, src, axis=0):
    return tgt.clone().index_add_(axis, idx, src)
def _segment_sum(src, seg, n):
    out = torch.zeros((n,) + src.shape[1:], dtype=src.dtype)
    return out.index_add_(0, seg, src)
def _pad(x, pw):
    flat = tuple(v for pair in reversed(pw) for v in pair)
    return torch.nn.functional.pad(x, flat)

kernel_name = 'recurrent_scan__sliding_block_cached__glu_gated_geglu__prompt'

def setup_inputs():

    _w = (lambda a: (lambda t: t.to(torch.bfloat16) if t.is_floating_point() else t)(torch.as_tensor(a)))
    def _A_setup():
        B, Sq, D = 1, 2048, 640
        Hq, Hkv, Sk, Dh = 32, 32, 2048, 192
        assert Hq % Hkv == 0, (Hq, Hkv)
        return {
            "x": _w((lambda *s: torch.randn(*s, dtype=torch.bfloat16) * 0.05)(B, Sq, D)),
            "k_cache": _w((lambda *s: torch.randn(*s, dtype=torch.bfloat16) * 3.2)(B, Hkv, Sk, Dh)),
            "v_cache": _w((lambda *s: torch.randn(*s, dtype=torch.bfloat16) * 3.2)(B, Hkv, Sk, Dh)),
            "wq": _w((lambda *s: torch.randn(*s, dtype=torch.bfloat16) * 3.2)(D, Hq * Dh) * (D ** -0.5)),
            "wo": _w((lambda *s: torch.randn(*s, dtype=torch.bfloat16) * 3.2)(Hq * Dh, D) * ((Hq * Dh) ** -0.5)),
        }
    _A_in = _A_setup()

    def _B_setup():
        B, S, Dm, Df = 1, 2048, 640, 1536
        return {
            "x": _w((lambda *s: torch.randn(*s, dtype=torch.bfloat16) * 0.05)(B, S, Dm)),
            "w_gate": _w((lambda *s: torch.randn(*s, dtype=torch.bfloat16) * 0.4)(Dm, Df) * (Dm ** -0.5)),
            "w_up": _w((lambda *s: torch.randn(*s, dtype=torch.bfloat16) * 0.4)(Dm, Df) * (Dm ** -0.5)),
            "w_down": _w((lambda *s: torch.randn(*s, dtype=torch.bfloat16) * 0.4)(Df, Dm) * (Df ** -0.5)),
        }
    _B_in = _B_setup()

    return {
        "A_x": _A_in["x"],
        "A_k_cache": _A_in["k_cache"],
        "A_v_cache": _A_in["v_cache"],
        "A_wq": _A_in["wq"],
        "A_wo": _A_in["wo"],
        "B_x": _B_in["x"],
        "B_w_gate": _B_in["w_gate"],
        "B_w_up": _B_in["w_up"],
        "B_w_down": _B_in["w_down"],
    }

def reference(A_x, A_k_cache, A_v_cache, A_wq, A_wo, B_x, B_w_gate, B_w_up, B_w_down):
    def _A_ref(x, k_cache, v_cache, wq, wo):
        B, Sq, D = x.shape
        Hq, Dh = 32, 192
        Hkv, Sk = k_cache.shape[1], k_cache.shape[2]
        W = min(4096, max(256, Sk // 4))
        rep = Hq // Hkv
        q = (lambda x, *d: x.permute(*d))((x @ wq).reshape(B, Sq, Hq, Dh), 0, 2, 1, 3)
        k = (lambda x, n, axis: torch.repeat_interleave(x, n, dim=axis))(k_cache[:, :, Sk - W:, :], rep, axis=1)
        v = (lambda x, n, axis: torch.repeat_interleave(x, n, dim=axis))(v_cache[:, :, Sk - W:, :], rep, axis=1)
        scores = torch.einsum("bhqd,bhkd->bhqk", q, k) * (Dh ** -0.5)
        p = _softmax(scores, axis=-1)
        o = torch.einsum("bhqk,bhkd->bhqd", p, v)
        return (lambda x, *d: x.permute(*d))(o, 0, 2, 1, 3).reshape(B, Sq, Hq * Dh) @ wo

    def _B_ref(x, w_gate, w_up, w_down):
        g = torch.einsum("bsd,df->bsf", x, w_gate)
        u = torch.einsum("bsd,df->bsf", x, w_up)
        h = _gelu(g) * u
        return torch.einsum("bsf,fd->bsd", h, w_down)

    x = A_x
    xn = _layernorm(x, axis=-1)
    s = _A_ref(xn, A_k_cache, A_v_cache, A_wq, A_wo)
    g = _silu(_B_ref(xn, B_w_gate, B_w_up, B_w_down))
    return x + s * g
```

```asm
; @launch grid=(256,1,1) block=(512,1,1) lds=163840
.amdgcn_target "amdgcn-amd-amdhsa--gfx950"
.text
.globl recurrent_scan__sliding_block_cached__glu_gated_geglu__prompt_kernel
.p2align 8
.type recurrent_scan__sliding_block_cached__glu_gated_geglu__prompt_kernel,@function
recurrent_scan__sliding_block_cached__glu_gated_geglu__prompt_kernel:
    s_cmp_ge_u32 s2, 256
    s_cbranch_scc1 L_k1_done
    s_load_dwordx16 s[4:19], s[0:1], 0
    s_load_dwordx8 s[20:27], s[0:1], 64
    v_lshrrev_b32 v1, 6, v0
    v_and_b32 v0, 63, v0
    v_readfirstlane_b32 s52, v1
    s_and_b32 s66, s2, 7
    s_lshr_b32 s67, s2, 3
    s_lshl_b32 s53, s66, 2
    s_and_b32 s66, s67, 3
    s_add_u32 s53, s53, s66
    s_lshr_b32 s54, s67, 2
    s_lshl_b32 s66, s66, 1
    s_add_u32 s61, s66, s54
    s_sub_u32 s66, s61, 9
    s_cmp_ge_u32 s61, 9
    s_cselect_b32 s61, s66, s61
    s_add_u32 s61, s61, 1
    s_mov_b32 s55, 0
    s_mov_b32 s60, s55
    s_mul_i32 s69, s52, 3072
    v_lshlrev_b32 v248, 4, v0
    s_lshl_b32 s66, s54, 5
    s_add_u32 s66, s66, s53
    s_lshl_b32 s66, s66, 3
    s_add_u32 s66, s66, s52
    s_mul_i32 s67, s66, 1280
    v_lshlrev_b32 v20, 5, v0
    s_waitcnt lgkmcnt(0)
    s_add_u32 s28, s4, s67
    s_addc_u32 s29, s5, 0
    s_and_b32 s29, s29, 0xffff
    s_mov_b32 s30, 1280
    s_mov_b32 s31, 0x20000
    buffer_load_dwordx4 v[24:27], v20, s[28:31], 0 offen
    buffer_load_dwordx4 v[28:31], v20, s[28:31], 0 offen offset:16
    s_lshl_b32 s66, s52, 3
    v_add_u32 v2, 0, v0
    v_mul_u32_u24 v3, 2731, v2
    v_lshrrev_b32 v3, 16, v3
    v_mul_u32_u24 v4, 24, v3
    v_sub_u32 v4, v2, v4
    v_add_u32 v3, s66, v3
    v_and_b32 v5, 2, v3
    v_bfe_u32 v6, v3, 3, 1
    v_lshl_or_b32 v5, v6, 2, v5
    v_xor_b32 v5, v4, v5
    v_mul_u32_u24 v8, 12288, v3
    v_lshl_add_u32 v244, v5, 4, v8
    v_add_u32 v2, 64, v0
    v_mul_u32_u24 v3, 2731, v2
    v_lshrrev_b32 v3, 16, v3
    v_mul_u32_u24 v4, 24, v3
    v_sub_u32 v4, v2, v4
    v_add_u32 v3, s66, v3
    v_and_b32 v5, 2, v3
    v_bfe_u32 v6, v3, 3, 1
    v_lshl_or_b32 v5, v6, 2, v5
    v_xor_b32 v5, v4, v5
    v_mul_u32_u24 v8, 12288, v3
    v_lshl_add_u32 v245, v5, 4, v8
    v_add_u32 v2, 128, v0
    v_mul_u32_u24 v3, 2731, v2
    v_lshrrev_b32 v3, 16, v3
    v_mul_u32_u24 v4, 24, v3
    v_sub_u32 v4, v2, v4
    v_add_u32 v3, s66, v3
    v_and_b32 v5, 2, v3
    v_bfe_u32 v6, v3, 3, 1
    v_lshl_or_b32 v5, v6, 2, v5
    v_xor_b32 v5, v4, v5
    v_mul_u32_u24 v8, 12288, v3
    v_lshl_add_u32 v246, v5, 4, v8
    s_and_b32 s68, s52, 3
    s_lshl_b32 s67, s68, 4
    v_mul_u32_u24 v3, 10923, v0
    v_lshrrev_b32 v3, 16, v3
    v_mul_u32_u24 v4, 6, v3
    v_sub_u32 v4, v0, v4
    v_add_u32 v3, s67, v3
    v_mul_u32_u24 v8, 3072, v3
    v_lshl_add_u32 v243, v4, 4, v8
    s_mul_i32 s59, s68, 3328
    s_cmp_ge_u32 s52, 4
    s_mov_b32 s67, 24576
    s_cselect_b32 s67, 25344, s67
    s_add_u32 s59, s59, s67
    s_mov_b32 s62, -1
    s_mov_b32 s63, 0xffff
    s_mov_b32 s71, 0xbdd2d3e8
    s_mul_i32 s67, s53, 384
    s_add_u32 s32, s10, s67
    s_addc_u32 s33, s11, 0
    s_and_b32 s33, s33, 0xffff
    s_mov_b32 s34, 0
    s_mov_b32 s35, 0x20000
    s_sub_u32 s34, 7864320, s67
    s_cmp_ge_u32 s52, 4
    s_cselect_b32 s14, s18, s16
    s_cselect_b32 s15, s19, s17
    s_mul_i32 s67, s53, 96
    s_add_u32 s36, s14, s67
    s_addc_u32 s37, s15, 0
    s_and_b32 s37, s37, 0xffff
    s_mov_b32 s38, 0
    s_mov_b32 s39, 0x20000
    s_sub_u32 s38, 1966080, s67
    s_mov_b32 s67, 52428800
    s_add_u32 s88, s26, s67
    s_addc_u32 s89, s27, 0
    s_and_b32 s89, s89, 0xffff
    s_mov_b32 s90, 49152
    s_mov_b32 s91, 0x20000
    s_mov_b32 s92, s24
    s_and_b32 s93, s25, 0xffff
    s_mov_b32 s94, 256
    s_mov_b32 s95, 0x20000
    s_lshl_b32 s67, s54, 4
    s_lshr_b32 s68, s53, 1
    s_add_u32 s67, s67, s68
    s_mul_i32 s67, s67, 20480
    s_add_u32 s67, s67, 52494336
    s_add_u32 s40, s26, s67
    s_addc_u32 s41, s27, 0
    s_and_b32 s41, s41, 0xffff
    s_mov_b32 s42, 20480
    s_mov_b32 s43, 0x20000
    s_mul_i32 s67, s52, 10
    v_lshrrev_b32 v2, 3, v0
    v_add_u32 v2, s67, v2
    v_and_b32 v3, 7, v0
    v_mul_u32_u24 v21, 1296, v3
    v_lshl_add_u32 v21, v2, 4, v21
    v_add_u32 v21, 114688, v21
    s_and_b32 s67, s53, 1
    s_lshl_b32 s67, s67, 3
    v_add_u32 v3, s67, v3
    v_lshlrev_b32 v22, 8, v2
    v_lshl_add_u32 v22, v3, 4, v22
    s_mul_i32 s67, s52, 1296
    s_add_u32 s67, s67, 114688
    v_add_u32 v23, s67, v20
    s_mul_i32 s56, s55, 786432
    s_mul_i32 s57, s55, 196608
    s_add_u32 m0, s69, 75520
    s_add_u32 s58, s57, 24576
    buffer_load_dwordx4 v244, s[32:35], s56 offen lds
    s_add_u32 m0, s69, 76544
    s_add_u32 s55, s55, 1
    buffer_load_dwordx4 v245, s[32:35], s56 offen lds
    s_add_u32 m0, s69, 77568
    s_cmp_eq_u32 s55, 10
    buffer_load_dwordx4 v246, s[32:35], s56 offen lds
    s_cselect_b32 s55, 1, s55
    s_mov_b32 s55, s61
    s_add_u32 m0, s59, 75520
    s_mov_b64 exec, s[62:63]
    buffer_load_dwordx4 v243, s[36:39], s57 offen lds
    s_mov_b64 exec, -1
    s_add_u32 m0, s59, 77184
    s_mov_b64 exec, s[62:63]
    buffer_load_dwordx4 v243, s[36:39], s58 offen lds
    s_mov_b64 exec, -1
    s_waitcnt vmcnt(5)
    v_lshlrev_b32 v32, 16, v24
    v_and_b32 v33, 0xffff0000, v24
    v_lshlrev_b32 v34, 16, v25
    v_and_b32 v35, 0xffff0000, v25
    v_lshlrev_b32 v36, 16, v26
    v_and_b32 v37, 0xffff0000, v26
    v_lshlrev_b32 v38, 16, v27
    v_and_b32 v39, 0xffff0000, v27
    v_lshlrev_b32 v40, 16, v28
    v_and_b32 v41, 0xffff0000, v28
    v_lshlrev_b32 v42, 16, v29
    v_and_b32 v43, 0xffff0000, v29
    v_lshlrev_b32 v44, 16, v30
    v_and_b32 v45, 0xffff0000, v30
    v_lshlrev_b32 v46, 16, v31
    v_and_b32 v47, 0xffff0000, v31
    v_add_f32 v48, v32, v33
    v_add_f32 v49, v34, v35
    v_add_f32 v48, v48, v36
    v_add_f32 v49, v49, v37
    v_add_f32 v48, v48, v38
    v_add_f32 v49, v49, v39
    v_add_f32 v48, v48, v40
    v_add_f32 v49, v49, v41
    v_add_f32 v48, v48, v42
    v_add_f32 v49, v49, v43
    v_add_f32 v48, v48, v44
    v_add_f32 v49, v49, v45
    v_add_f32 v48, v48, v46
    v_add_f32 v49, v49, v47
    v_add_f32 v48, v48, v49
    s_nop 1
    v_add_f32_dpp v48, v48, v48 row_shr:1 row_mask:0xf bank_mask:0xf bound_ctrl:0
    s_nop 1
    v_add_f32_dpp v48, v48, v48 row_shr:2 row_mask:0xf bank_mask:0xf bound_ctrl:0
    s_nop 1
    v_add_f32_dpp v48, v48, v48 row_shr:4 row_mask:0xf bank_mask:0xf bound_ctrl:0
    s_nop 1
    v_add_f32_dpp v48, v48, v48 row_shr:8 row_mask:0xf bank_mask:0xf bound_ctrl:0
    s_nop 1
    v_add_f32_dpp v48, v48, v48 row_bcast:15 row_mask:0xa bank_mask:0xf
    s_nop 1
    v_add_f32_dpp v48, v48, v48 row_bcast:31 row_mask:0xc bank_mask:0xf
    s_nop 1
    v_readlane_b32 s97, v48, 63
    s_nop 3
    v_mov_b32 v50, 0x3acccccd
    v_mul_f32 v50, s97, v50
    v_cmp_gt_u32 vcc, 40, v0
    v_mov_b32 v48, 0
    v_mov_b32 v49, 0
    v_sub_f32 v52, v32, v50
    v_sub_f32 v53, v33, v50
    v_sub_f32 v54, v34, v50
    v_sub_f32 v55, v35, v50
    v_sub_f32 v56, v36, v50
    v_sub_f32 v57, v37, v50
    v_sub_f32 v58, v38, v50
    v_sub_f32 v59, v39, v50
    v_sub_f32 v60, v40, v50
    v_sub_f32 v61, v41, v50
    v_sub_f32 v62, v42, v50
    v_sub_f32 v63, v43, v50
    v_sub_f32 v64, v44, v50
    v_sub_f32 v65, v45, v50
    v_sub_f32 v66, v46, v50
    v_sub_f32 v67, v47, v50
    v_fmac_f32 v48, v52, v52
    v_fmac_f32 v49, v53, v53
    v_fmac_f32 v48, v54, v54
    v_fmac_f32 v49, v55, v55
    v_fmac_f32 v48, v56, v56
    v_fmac_f32 v49, v57, v57
    v_fmac_f32 v48, v58, v58
    v_fmac_f32 v49, v59, v59
    v_fmac_f32 v48, v60, v60
    v_fmac_f32 v49, v61, v61
    v_fmac_f32 v48, v62, v62
    v_fmac_f32 v49, v63, v63
    v_fmac_f32 v48, v64, v64
    v_fmac_f32 v49, v65, v65
    v_fmac_f32 v48, v66, v66
    v_fmac_f32 v49, v67, v67
    v_add_f32 v48, v48, v49
    v_cndmask_b32 v48, 0, v48, vcc
    s_nop 1
    v_add_f32_dpp v48, v48, v48 row_shr:1 row_mask:0xf bank_mask:0xf bound_ctrl:0
    s_nop 1
    v_add_f32_dpp v48, v48, v48 row_shr:2 row_mask:0xf bank_mask:0xf bound_ctrl:0
    s_nop 1
    v_add_f32_dpp v48, v48, v48 row_shr:4 row_mask:0xf bank_mask:0xf bound_ctrl:0
    s_nop 1
    v_add_f32_dpp v48, v48, v48 row_shr:8 row_mask:0xf bank_mask:0xf bound_ctrl:0
    s_nop 1
    v_add_f32_dpp v48, v48, v48 row_bcast:15 row_mask:0xa bank_mask:0xf
    s_nop 1
    v_add_f32_dpp v48, v48, v48 row_bcast:31 row_mask:0xc bank_mask:0xf
    s_nop 1
    v_readlane_b32 s97, v48, 63
    s_nop 3
    v_mov_b32 v51, 0x3acccccd
    v_mul_f32 v51, s97, v51
    v_cvt_pk_bf16_f32 v50, v50, v50
    v_and_b32 v50, 0xffff0000, v50
    v_cvt_pk_bf16_f32 v51, v51, v51
    v_and_b32 v51, 0xffff0000, v51
    v_add_f32 v51, 0x3727c5ac, v51
    v_cvt_pk_bf16_f32 v51, v51, v51
    v_and_b32 v51, 0xffff0000, v51
    v_sqrt_f32 v51, v51
    s_nop 0
    v_cvt_pk_bf16_f32 v51, v51, v51
    v_and_b32 v51, 0xffff0000, v51
    v_rcp_f32 v51, v51
    v_sub_f32 v52, v32, v50
    v_sub_f32 v53, v33, v50
    v_sub_f32 v54, v34, v50
    v_sub_f32 v55, v35, v50
    v_sub_f32 v56, v36, v50
    v_sub_f32 v57, v37, v50
    v_sub_f32 v58, v38, v50
    v_sub_f32 v59, v39, v50
    v_sub_f32 v60, v40, v50
    v_sub_f32 v61, v41, v50
    v_sub_f32 v62, v42, v50
    v_sub_f32 v63, v43, v50
    v_sub_f32 v64, v44, v50
    v_sub_f32 v65, v45, v50
    v_sub_f32 v66, v46, v50
    v_sub_f32 v67, v47, v50
    v_cvt_pk_bf16_f32 v24, v52, v53
    v_cvt_pk_bf16_f32 v25, v54, v55
    v_cvt_pk_bf16_f32 v26, v56, v57
    v_cvt_pk_bf16_f32 v27, v58, v59
    v_cvt_pk_bf16_f32 v28, v60, v61
    v_cvt_pk_bf16_f32 v29, v62, v63
    v_cvt_pk_bf16_f32 v30, v64, v65
    v_cvt_pk_bf16_f32 v31, v66, v67
    v_lshlrev_b32 v32, 16, v24
    v_and_b32 v33, 0xffff0000, v24
    v_lshlrev_b32 v34, 16, v25
    v_and_b32 v35, 0xffff0000, v25
    v_lshlrev_b32 v36, 16, v26
    v_and_b32 v37, 0xffff0000, v26
    v_lshlrev_b32 v38, 16, v27
    v_and_b32 v39, 0xffff0000, v27
    v_lshlrev_b32 v40, 16, v28
    v_and_b32 v41, 0xffff0000, v28
    v_lshlrev_b32 v42, 16, v29
    v_and_b32 v43, 0xffff0000, v29
    v_lshlrev_b32 v44, 16, v30
    v_and_b32 v45, 0xffff0000, v30
    v_lshlrev_b32 v46, 16, v31
    v_and_b32 v47, 0xffff0000, v31
    v_mul_f32 v32, v32, v51
    v_mul_f32 v33, v33, v51
    v_mul_f32 v34, v34, v51
    v_mul_f32 v35, v35, v51
    v_mul_f32 v36, v36, v51
    v_mul_f32 v37, v37, v51
    v_mul_f32 v38, v38, v51
    v_mul_f32 v39, v39, v51
    v_mul_f32 v40, v40, v51
    v_mul_f32 v41, v41, v51
    v_mul_f32 v42, v42, v51
    v_mul_f32 v43, v43, v51
    v_mul_f32 v44, v44, v51
    v_mul_f32 v45, v45, v51
    v_mul_f32 v46, v46, v51
    v_mul_f32 v47, v47, v51
    v_cvt_pk_bf16_f32 v24, v32, v33
    v_cvt_pk_bf16_f32 v25, v34, v35
    v_cvt_pk_bf16_f32 v26, v36, v37
    v_cvt_pk_bf16_f32 v27, v38, v39
    v_cvt_pk_bf16_f32 v28, v40, v41
    v_cvt_pk_bf16_f32 v29, v42, v43
    v_cvt_pk_bf16_f32 v30, v44, v45
    v_cvt_pk_bf16_f32 v31, v46, v47
    s_mov_b32 exec_hi, 0xff
    ds_write_b128 v23, v[24:27]
    ds_write_b128 v23, v[28:31] offset:16
    s_mov_b64 exec, -1
    s_waitcnt lgkmcnt(0)
    s_barrier
    ds_read_b128 v[32:35], v21
    ds_read_b128 v[36:39], v21 offset:128
    s_lshl_b32 s67, s54, 3
    s_add_u32 s67, s67, s53
    s_lshl_b32 s67, s67, 7
    s_cmp_lt_u32 s53, 8
    s_cselect_b32 s67, s67, 0x100000
    v_mov_b32 v40, 0
    v_mov_b32 v41, 0
    v_mov_b32 v42, 0
    v_mov_b32 v43, 0
    s_waitcnt lgkmcnt(0)
    buffer_store_dwordx4 v[32:35], v22, s[40:43], 0 offen sc1
    s_mov_b64 exec, 0xffff
    buffer_store_dwordx4 v[36:39], v22, s[40:43], 0 offen offset:2048 sc1
    s_mov_b64 exec, 1
    buffer_store_dword v40, v40, s[88:91], s67 offen sc1
    s_lshl_b32 s99, s2, 7
    s_add_u32 s99, s99, 16384
    s_mov_b64 exec, 15
    buffer_store_dwordx4 v[40:43], v248, s[88:91], s99 offen sc1
    s_mov_b64 exec, -1
    s_waitcnt vmcnt(0)
    s_barrier
    s_lshl_b32 s100, s54, 5
    s_cmp_eq_u32 s52, 0
    s_cselect_b32 s100, s100, 0x100000
    s_cselect_b32 s101, s99, 0x100000
    v_mov_b32 v40, 0
    v_mov_b32 v41, 1
    s_mov_b64 exec, 1
    buffer_atomic_add v41, v40, s[92:95], s100 offen offset:0 sc0 sc1
    s_mov_b64 exec, -1
    s_waitcnt vmcnt(0)
    v_readfirstlane_b32 s98, v41
    s_nop 3
    s_and_b32 s98, s98, 31
    s_cmp_eq_u32 s98, 31
    s_cbranch_scc1 L_xs_sig
L_xs_sigr:
    s_cmp_eq_u32 s52, 0
    s_cbranch_scc1 L_w1_skip
    s_mul_i32 s56, s55, 786432
    s_mul_i32 s57, s55, 196608
    s_add_u32 m0, s69, 0
    s_add_u32 s58, s57, 24576
    buffer_load_dwordx4 v244, s[32:35], s56 offen lds
    s_add_u32 m0, s69, 1024
    s_add_u32 s55, s55, 1
    buffer_load_dwordx4 v245, s[32:35], s56 offen lds
    s_add_u32 m0, s69, 2048
    s_cmp_eq_u32 s55, 10
    buffer_load_dwordx4 v246, s[32:35], s56 offen lds
    s_cselect_b32 s55, 1, s55
    s_add_u32 m0, s59, 0
    s_mov_b64 exec, s[62:63]
    buffer_load_dwordx4 v243, s[36:39], s57 offen lds
    s_mov_b64 exec, -1
    s_add_u32 m0, s59, 1664
    s_mov_b64 exec, s[62:63]
    buffer_load_dwordx4 v243, s[36:39], s58 offen lds
    s_mov_b64 exec, -1
L_w1_skip:
    s_lshl_b32 s67, s54, 3
    s_add_u32 s67, s67, s52
    s_mul_i32 s97, s67, 40960
    s_add_u32 s97, s97, 52494336
    s_add_u32 s28, s26, s97
    s_addc_u32 s29, s27, 0
    s_and_b32 s29, s29, 0xffff
    s_mov_b32 s30, 40960
    s_mov_b32 s31, 0x20000
    s_mul_i32 s67, s67, 491520
    s_add_u32 s48, s26, s67
    s_addc_u32 s49, s27, 0
    s_and_b32 s49, s49, 0xffff
    s_mov_b32 s50, 491520
    s_mov_b32 s51, 0x20000
    s_mul_i32 s67, s53, 786432
    s_add_u32 s67, s67, 589824
    s_add_u32 s40, s6, s67
    s_addc_u32 s41, s7, 0
    s_and_b32 s41, s41, 0xffff
    s_mov_b32 s42, 196608
    s_mov_b32 s43, 0x20000
    s_add_u32 s44, s8, s67
    s_addc_u32 s45, s9, 0
    s_and_b32 s45, s45, 0xffff
    s_mov_b32 s46, 196608
    s_mov_b32 s47, 0x20000
    v_add_u32 v2, 0, v0
    v_mul_u32_u24 v3, 2731, v2
    v_lshrrev_b32 v3, 16, v3
    v_mul_u32_u24 v4, 24, v3
    v_sub_u32 v4, v2, v4
    v_add_u32 v3, s66, v3
    v_mul_u32_u24 v8, 384, v3
    v_bfe_u32 v5, v3, 1, 3
    v_xor_b32 v5, v4, v5
    v_lshl_add_u32 v249, v5, 4, v8
    v_and_b32 v5, 6, v3
    v_xor_b32 v5, v4, v5
    v_lshl_add_u32 v252, v5, 4, v8
    v_add_u32 v2, 64, v0
    v_mul_u32_u24 v3, 2731, v2
    v_lshrrev_b32 v3, 16, v3
    v_mul_u32_u24 v4, 24, v3
    v_sub_u32 v4, v2, v4
    v_add_u32 v3, s66, v3
    v_mul_u32_u24 v8, 384, v3
    v_bfe_u32 v5, v3, 1, 3
    v_xor_b32 v5, v4, v5
    v_lshl_add_u32 v250, v5, 4, v8
    v_and_b32 v5, 6, v3
    v_xor_b32 v5, v4, v5
    v_lshl_add_u32 v253, v5, 4, v8
    v_add_u32 v2, 128, v0
    v_mul_u32_u24 v3, 2731, v2
    v_lshrrev_b32 v3, 16, v3
    v_mul_u32_u24 v4, 24, v3
    v_sub_u32 v4, v2, v4
    v_add_u32 v3, s66, v3
    v_mul_u32_u24 v8, 384, v3
    v_bfe_u32 v5, v3, 1, 3
    v_xor_b32 v5, v4, v5
    v_lshl_add_u32 v251, v5, 4, v8
    v_and_b32 v5, 6, v3
    v_xor_b32 v5, v4, v5
    v_lshl_add_u32 v254, v5, 4, v8
    v_lshrrev_b32 v3, 4, v0
    v_bfe_u32 v5, v0, 2, 2
    v_and_b32 v6, 3, v0
    v_lshlrev_b32 v6, 3, v6
    v_bfe_u32 v7, v0, 3, 2
    v_lshl_add_u32 v9, v3, 3, v5
    v_mul_u32_u24 v10, 384, v9
    v_add_u32 v10, v10, v6
    v_add_u32 v10, 75520, v10
    v_xor_b32 v11, 0, v7
    v_lshl_add_u32 v238, v11, 5, v10
    v_xor_b32 v11, 1, v7
    v_lshl_add_u32 v239, v11, 5, v10
    v_xor_b32 v11, 2, v7
    v_lshl_add_u32 v240, v11, 5, v10
    v_xor_b32 v11, 3, v7
    v_lshl_add_u32 v241, v11, 5, v10
    v_mul_u32_u24 v10, 1664, v3
    v_mul_u32_u24 v11, 96, v5
    v_add3_u32 v10, v10, v11, v6
    v_add_u32 v242, 100096, v10
    v_mov_b32 v224, 0x3f803f80
    v_mov_b32 v225, 0x3f803f80
    v_mov_b32 v226, 0x3f803f80
    v_mov_b32 v227, 0x3f803f80
    s_cmp_eq_u32 s52, 0
    s_cbranch_scc1 L_px_spin
L_px_ok:
    s_barrier
    s_lshl_b32 s64, s60, 11
    s_add_u32 s60, s60, 1
    s_add_u32 s65, s64, 20480
    s_cmp_eq_u32 s60, 10
    s_cselect_b32 s60, 1, s60
    s_mov_b32 s60, s61
    buffer_load_dwordx4 v[144:147], v248, s[28:31], s64 offen offset:0 sc1
    buffer_load_dwordx4 v[148:151], v248, s[28:31], s65 offen offset:0 sc1
    buffer_load_dwordx4 v[152:155], v248, s[28:31], s64 offen offset:1024 sc1
    buffer_load_dwordx4 v[156:159], v248, s[28:31], s65 offen offset:1024 sc1
    ds_read_b64_tr_b16 v[176:177], v238 offset:0
    ds_read_b64_tr_b16 v[178:179], v238 offset:1536
    ds_read_b64_tr_b16 v[180:181], v239 offset:0
    ds_read_b64_tr_b16 v[182:183], v239 offset:1536
    ds_read_b64_tr_b16 v[184:185], v240 offset:0
    ds_read_b64_tr_b16 v[186:187], v240 offset:1536
    s_waitcnt vmcnt(2)
    s_waitcnt lgkmcnt(4)
    v_mfma_f32_16x16x32_bf16 v[0:3], v[176:179], v[144:147], 0
    ds_read_b64_tr_b16 v[188:189], v241 offset:0
    s_lshl_b32 s64, s60, 11
    s_add_u32 s60, s60, 1
    s_add_u32 s65, s64, 20480
    s_cmp_eq_u32 s60, 10
    s_cselect_b32 s60, 1, s60
    v_mfma_f32_16x16x32_bf16 v[4:7], v[176:179], v[148:151], 0
    ds_read_b64_tr_b16 v[190:191], v241 offset:1536
    s_waitcnt lgkmcnt(4)
    v_mfma_f32_16x16x32_bf16 v[8:11], v[180:183], v[144:147], 0
    ds_read_b64_tr_b16 v[176:177], v238 offset:128
    buffer_load_dwordx4 v[160:163], v248, s[28:31], s64 offen offset:0 sc1
    v_mfma_f32_16x16x32_bf16 v[12:15], v[180:183], v[148:151], 0
    ds_read_b64_tr_b16 v[178:179], v238 offset:1664
    s_waitcnt lgkmcnt(4)
    v_mfma_f32_16x16x32_bf16 v[16:19], v[184:187], v[144:147], 0
    ds_read_b64_tr_b16 v[180:181], v239 offset:128
    buffer_load_dwordx4 v[164:167], v248, s[28:31], s65 offen offset:0 sc1
    v_mfma_f32_16x16x32_bf16 v[20:23], v[184:187], v[148:151], 0
    ds_read_b64_tr_b16 v[182:183], v239 offset:1664
    s_waitcnt lgkmcnt(4)
    v_mfma_f32_16x16x32_bf16 v[24:27], v[188:191], v[144:147], 0
    ds_read_b64_tr_b16 v[184:185], v240 offset:128
    buffer_load_dwordx4 v[168:171], v248, s[28:31], s64 offen offset:1024 sc1
    v_mfma_f32_16x16x32_bf16 v[28:31], v[188:191], v[148:151], 0
    ds_read_b64_tr_b16 v[186:187], v240 offset:1664
    s_waitcnt lgkmcnt(4)
    v_mfma_f32_16x16x32_bf16 v[32:35], v[176:179], v[144:147], 0
    ds_read_b64_tr_b16 v[188:189], v241 offset:128
    buffer_load_dwordx4 v[172:175], v248, s[28:31], s65 offen offset:1024 sc1
    v_mfma_f32_16x16x32_bf16 v[36:39], v[176:179], v[148:151], 0
    ds_read_b64_tr_b16 v[190:191], v241 offset:1664
    s_waitcnt lgkmcnt(4)
    v_mfma_f32_16x16x32_bf16 v[40:43], v[180:183], v[144:147], 0
    ds_read_b64_tr_b16 v[176:177], v238 offset:256
    v_mfma_f32_16x16x32_bf16 v[44:47], v[180:183], v[148:151], 0
    ds_read_b64_tr_b16 v[178:179], v238 offset:1792
    s_waitcnt lgkmcnt(4)
    v_mfma_f32_16x16x32_bf16 v[48:51], v[184:187], v[144:147], 0
    ds_read_b64_tr_b16 v[180:181], v239 offset:256
    v_mfma_f32_16x16x32_bf16 v[52:55], v[184:187], v[148:151], 0
    ds_read_b64_tr_b16 v[182:183], v239 offset:1792
    s_waitcnt lgkmcnt(4)
    v_mfma_f32_16x16x32_bf16 v[56:59], v[188:191], v[144:147], 0
    ds_read_b64_tr_b16 v[184:185], v240 offset:256
    v_mfma_f32_16x16x32_bf16 v[60:63], v[188:191], v[148:151], 0
    ds_read_b64_tr_b16 v[186:187], v240 offset:1792
    s_waitcnt lgkmcnt(4)
    v_mfma_f32_16x16x32_bf16 v[64:67], v[176:179], v[144:147], 0
    ds_read_b64_tr_b16 v[188:189], v241 offset:256
    v_mfma_f32_16x16x32_bf16 v[68:71], v[176:179], v[148:151], 0
    ds_read_b64_tr_b16 v[190:191], v241 offset:1792
    s_waitcnt lgkmcnt(4)
    v_mfma_f32_16x16x32_bf16 v[72:75], v[180:183], v[144:147], 0
    ds_read_b64_tr_b16 v[176:177], v242 offset:0
    v_mfma_f32_16x16x32_bf16 v[76:79], v[180:183], v[148:151], 0
    ds_read_b64_tr_b16 v[178:179], v242 offset:384
    s_waitcnt lgkmcnt(4)
    v_mfma_f32_16x16x32_bf16 v[80:83], v[184:187], v[144:147], 0
    ds_read_b64_tr_b16 v[180:181], v242 offset:32
    v_mfma_f32_16x16x32_bf16 v[84:87], v[184:187], v[148:151], 0
    ds_read_b64_tr_b16 v[182:183], v242 offset:416
    s_waitcnt lgkmcnt(4)
    v_mfma_f32_16x16x32_bf16 v[88:91], v[188:191], v[144:147], 0
    ds_read_b64_tr_b16 v[184:185], v242 offset:64
    v_mfma_f32_16x16x32_bf16 v[92:95], v[188:191], v[148:151], 0
    ds_read_b64_tr_b16 v[186:187], v242 offset:448
    s_waitcnt lgkmcnt(4)
    v_mfma_f32_16x16x32_bf16 v[96:99], v[176:179], v[144:147], 0
    ds_read_b64_tr_b16 v[188:189], v242 offset:768
    v_mfma_f32_16x16x32_bf16 v[100:103], v[176:179], v[148:151], 0
    ds_read_b64_tr_b16 v[190:191], v242 offset:1152
    s_waitcnt lgkmcnt(4)
    v_mfma_f32_16x16x32_bf16 v[104:107], v[180:183], v[144:147], 0
    ds_read_b64_tr_b16 v[176:177], v242 offset:800
    v_mfma_f32_16x16x32_bf16 v[108:111], v[180:183], v[148:151], 0
    ds_read_b64_tr_b16 v[178:179], v242 offset:1184
    s_waitcnt lgkmcnt(4)
    v_mfma_f32_16x16x32_bf16 v[112:115], v[184:187], v[144:147], 0
    ds_read_b64_tr_b16 v[180:181], v242 offset:832
    v_mfma_f32_16x16x32_bf16 v[116:119], v[184:187], v[148:151], 0
    ds_read_b64_tr_b16 v[182:183], v242 offset:1216
    s_waitcnt lgkmcnt(4)
    v_mfma_f32_16x16x32_bf16 v[120:123], v[188:191], v[144:147], 0
    ds_read_b64_tr_b16 v[184:185], v238 offset:12288
    v_mfma_f32_16x16x32_bf16 v[124:127], v[188:191], v[148:151], 0
    ds_read_b64_tr_b16 v[186:187], v238 offset:13824
    s_waitcnt lgkmcnt(4)
    v_mfma_f32_16x16x32_bf16 v[128:131], v[176:179], v[144:147], 0
    ds_read_b64_tr_b16 v[188:189], v239 offset:12288
    v_mfma_f32_16x16x32_bf16 v[132:135], v[176:179], v[148:151], 0
    ds_read_b64_tr_b16 v[190:191], v239 offset:13824
    s_waitcnt lgkmcnt(4)
    v_mfma_f32_16x16x32_bf16 v[136:139], v[180:183], v[144:147], 0
    ds_read_b64_tr_b16 v[176:177], v240 offset:12288
    v_mfma_f32_16x16x32_bf16 v[140:143], v[180:183], v[148:151], 0
    ds_read_b64_tr_b16 v[178:179], v240 offset:13824
    s_waitcnt vmcnt(4)
    s_waitcnt lgkmcnt(4)
    v_mfma_f32_16x16x32_bf16 v[0:3], v[184:187], v[152:155], v[0:3]
    ds_read_b64_tr_b16 v[180:181], v241 offset:12288
    s_mul_i32 s56, s55, 786432
    s_mul_i32 s57, s55, 196608
    v_mfma_f32_16x16x32_bf16 v[4:7], v[184:187], v[156:159], v[4:7]
    ds_read_b64_tr_b16 v[182:183], v241 offset:13824
    s_waitcnt lgkmcnt(4)
    v_mfma_f32_16x16x32_bf16 v[8:11], v[188:191], v[152:155], v[8:11]
    ds_read_b64_tr_b16 v[184:185], v238 offset:12416
    v_mfma_f32_16x16x32_bf16 v[12:15], v[188:191], v[156:159], v[12:15]
    ds_read_b64_tr_b16 v[186:187], v238 offset:13952
    s_waitcnt lgkmcnt(4)
    v_mfma_f32_16x16x32_bf16 v[16:19], v[176:179], v[152:155], v[16:19]
    ds_read_b64_tr_b16 v[188:189], v239 offset:12416
    s_add_u32 m0, s69, 37760
    s_add_u32 s58, s57, 24576
    buffer_load_dwordx4 v244, s[32:35], s56 offen lds
    v_mfma_f32_16x16x32_bf16 v[20:23], v[176:179], v[156:159], v[20:23]
    ds_read_b64_tr_b16 v[190:191], v239 offset:13952
    s_waitcnt lgkmcnt(4)
    v_mfma_f32_16x16x32_bf16 v[24:27], v[180:183], v[152:155], v[24:27]
    ds_read_b64_tr_b16 v[176:177], v240 offset:12416
    v_mfma_f32_16x16x32_bf16 v[28:31], v[180:183], v[156:159], v[28:31]
    ds_read_b64_tr_b16 v[178:179], v240 offset:13952
    s_waitcnt lgkmcnt(4)
    v_mfma_f32_16x16x32_bf16 v[32:35], v[184:187], v[152:155], v[32:35]
    ds_read_b64_tr_b16 v[180:181], v241 offset:12416
    v_mfma_f32_16x16x32_bf16 v[36:39], v[184:187], v[156:159], v[36:39]
    ds_read_b64_tr_b16 v[182:183], v241 offset:13952
    s_add_u32 m0, s69, 38784
    s_add_u32 s55, s55, 1
    buffer_load_dwordx4 v245, s[32:35], s56 offen lds
    s_waitcnt lgkmcnt(4)
    v_mfma_f32_16x16x32_bf16 v[40:43], v[188:191], v[152:155], v[40:43]
    ds_read_b64_tr_b16 v[184:185], v238 offset:12544
    v_mfma_f32_16x16x32_bf16 v[44:47], v[188:191], v[156:159], v[44:47]
    ds_read_b64_tr_b16 v[186:187], v238 offset:14080
    s_waitcnt lgkmcnt(4)
    v_mfma_f32_16x16x32_bf16 v[48:51], v[176:179], v[152:155], v[48:51]
    ds_read_b64_tr_b16 v[188:189], v239 offset:12544
    v_mfma_f32_16x16x32_bf16 v[52:55], v[176:179], v[156:159], v[52:55]
    ds_read_b64_tr_b16 v[190:191], v239 offset:14080
    s_waitcnt lgkmcnt(4)
    v_mfma_f32_16x16x32_bf16 v[56:59], v[180:183], v[152:155], v[56:59]
    ds_read_b64_tr_b16 v[176:177], v240 offset:12544
    s_add_u32 m0, s69, 39808
    s_cmp_eq_u32 s55, 10
    buffer_load_dwordx4 v246, s[32:35], s56 offen lds
    s_cselect_b32 s55, 1, s55
    v_mfma_f32_16x16x32_bf16 v[60:63], v[180:183], v[156:159], v[60:63]
    ds_read_b64_tr_b16 v[178:179], v240 offset:14080
    s_waitcnt lgkmcnt(4)
    v_mfma_f32_16x16x32_bf16 v[64:67], v[184:187], v[152:155], v[64:67]
    ds_read_b64_tr_b16 v[180:181], v241 offset:12544
    v_mfma_f32_16x16x32_bf16 v[68:71], v[184:187], v[156:159], v[68:71]
    ds_read_b64_tr_b16 v[182:183], v241 offset:14080
    s_waitcnt lgkmcnt(4)
    v_mfma_f32_16x16x32_bf16 v[72:75], v[188:191], v[152:155], v[72:75]
    ds_read_b64_tr_b16 v[184:185], v242 offset:6656
    s_add_u32 m0, s59, 37760
    s_mov_b64 exec, s[62:63]
    buffer_load_dwordx4 v243, s[36:39], s57 offen lds
    s_mov_b64 exec, -1
    v_mfma_f32_16x16x32_bf16 v[76:79], v[188:191], v[156:159], v[76:79]
    ds_read_b64_tr_b16 v[186:187], v242 offset:7040
    s_waitcnt lgkmcnt(4)
    v_mfma_f32_16x16x32_bf16 v[80:83], v[176:179], v[152:155], v[80:83]
    ds_read_b64_tr_b16 v[188:189], v242 offset:6688
    v_mfma_f32_16x16x32_bf16 v[84:87], v[176:179], v[156:159], v[84:87]
    ds_read_b64_tr_b16 v[190:191], v242 offset:7072
    s_waitcnt lgkmcnt(4)
    v_mfma_f32_16x16x32_bf16 v[88:91], v[180:183], v[152:155], v[88:91]
    ds_read_b64_tr_b16 v[176:177], v242 offset:6720
    v_mfma_f32_16x16x32_bf16 v[92:95], v[180:183], v[156:159], v[92:95]
    ds_read_b64_tr_b16 v[178:179], v242 offset:7104
    s_add_u32 m0, s59, 39424
    s_mov_b64 exec, s[62:63]
    buffer_load_dwordx4 v243, s[36:39], s58 offen lds
    s_mov_b64 exec, -1
    s_waitcnt lgkmcnt(4)
    v_mfma_f32_16x16x32_bf16 v[96:99], v[184:187], v[152:155], v[96:99]
    ds_read_b64_tr_b16 v[180:181], v242 offset:7424
    v_mfma_f32_16x16x32_bf16 v[100:103], v[184:187], v[156:159], v[100:103]
    ds_read_b64_tr_b16 v[182:183], v242 offset:7808
    s_waitcnt lgkmcnt(4)
    v_mfma_f32_16x16x32_bf16 v[104:107], v[188:191], v[152:155], v[104:107]
    ds_read_b64_tr_b16 v[184:185], v242 offset:7456
    v_mfma_f32_16x16x32_bf16 v[108:111], v[188:191], v[156:159], v[108:111]
    ds_read_b64_tr_b16 v[186:187], v242 offset:7840
    s_waitcnt lgkmcnt(4)
    v_mfma_f32_16x16x32_bf16 v[112:115], v[176:179], v[152:155], v[112:115]
    ds_read_b64_tr_b16 v[188:189], v242 offset:7488
    v_mfma_f32_16x16x32_bf16 v[116:119], v[176:179], v[156:159], v[116:119]
    ds_read_b64_tr_b16 v[190:191], v242 offset:7872
    s_waitcnt lgkmcnt(0)
    s_barrier
    v_add_u32 v238, 4294891776, v238
    v_add_u32 v239, 4294891776, v239
    v_add_u32 v240, 4294891776, v240
    v_add_u32 v241, 4294891776, v241
    v_add_u32 v242, 4294891776, v242
    v_mfma_f32_16x16x32_bf16 v[120:123], v[180:183], v[152:155], v[120:123]
    ds_read_b64_tr_b16 v[176:177], v238 offset:0
    v_mfma_f32_16x16x32_bf16 v[124:127], v[180:183], v[156:159], v[124:127]
    ds_read_b64_tr_b16 v[178:179], v238 offset:1536
    v_mfma_f32_16x16x32_bf16 v[128:131], v[184:187], v[152:155], v[128:131]
    ds_read_b64_tr_b16 v[180:181], v239 offset:0
    v_mfma_f32_16x16x32_bf16 v[132:135], v[184:187], v[156:159], v[132:135]
    ds_read_b64_tr_b16 v[182:183], v239 offset:1536
    v_mfma_f32_16x16x32_bf16 v[136:139], v[188:191], v[152:155], v[136:139]
    ds_read_b64_tr_b16 v[184:185], v240 offset:0
    v_mfma_f32_16x16x32_bf16 v[140:143], v[188:191], v[156:159], v[140:143]
    ds_read_b64_tr_b16 v[186:187], v240 offset:1536
    s_waitcnt vmcnt(7)
    s_waitcnt lgkmcnt(4)
    v_mfma_f32_16x16x32_bf16 v[0:3], v[176:179], v[160:163], v[0:3]
    ds_read_b64_tr_b16 v[188:189], v241 offset:0
    s_mul_i32 s56, s55, 786432
    s_mul_i32 s57, s55, 196608
    v_mfma_f32_16x16x32_bf16 v[4:7], v[176:179], v[164:167], v[4:7]
    ds_read_b64_tr_b16 v[190:191], v241 offset:1536
    s_waitcnt lgkmcnt(4)
    v_mfma_f32_16x16x32_bf16 v[8:11], v[180:183], v[160:163], v[8:11]
    ds_read_b64_tr_b16 v[176:177], v238 offset:128
    v_mfma_f32_16x16x32_bf16 v[12:15], v[180:183], v[164:167], v[12:15]
    ds_read_b64_tr_b16 v[178:179], v238 offset:1664
    s_lshl_b32 s64, s60, 11
    s_add_u32 s60, s60, 1
    s_add_u32 s65, s64, 20480
    s_cmp_eq_u32 s60, 10
    s_cselect_b32 s60, 1, s60
    s_waitcnt lgkmcnt(4)
    v_mfma_f32_16x16x32_bf16 v[16:19], v[184:187], v[160:163], v[16:19]
    ds_read_b64_tr_b16 v[180:181], v239 offset:128
    v_mfma_f32_16x16x32_bf16 v[20:23], v[184:187], v[164:167], v[20:23]
    ds_read_b64_tr_b16 v[182:183], v239 offset:1664
    s_waitcnt lgkmcnt(4)
    v_mfma_f32_16x16x32_bf16 v[24:27], v[188:191], v[160:163], v[24:27]
    ds_read_b64_tr_b16 v[184:185], v240 offset:128
    v_mfma_f32_16x16x32_bf16 v[28:31], v[188:191], v[164:167], v[28:31]
    ds_read_b64_tr_b16 v[186:187], v240 offset:1664
    s_waitcnt lgkmcnt(4)
    v_mfma_f32_16x16x32_bf16 v[32:35], v[176:179], v[160:163], v[32:35]
    ds_read_b64_tr_b16 v[188:189], v241 offset:128
    buffer_load_dwordx4 v[192:195], v248, s[28:31], s64 offen offset:0 sc1
    v_mfma_f32_16x16x32_bf16 v[36:39], v[176:179], v[164:167], v[36:39]
    ds_read_b64_tr_b16 v[190:191], v241 offset:1664
    s_waitcnt lgkmcnt(4)
    v_mfma_f32_16x16x32_bf16 v[40:43], v[180:183], v[160:163], v[40:43]
    ds_read_b64_tr_b16 v[176:177], v238 offset:256
    s_add_u32 m0, s69, 75520
    s_add_u32 s58, s57, 24576
    buffer_load_dwordx4 v244, s[32:35], s56 offen lds
    v_mfma_f32_16x16x32_bf16 v[44:47], v[180:183], v[164:167], v[44:47]
    ds_read_b64_tr_b16 v[178:179], v238 offset:1792
    s_waitcnt lgkmcnt(4)
    v_mfma_f32_16x16x32_bf16 v[48:51], v[184:187], v[160:163], v[48:51]
    ds_read_b64_tr_b16 v[180:181], v239 offset:256
    v_mfma_f32_16x16x32_bf16 v[52:55], v[184:187], v[164:167], v[52:55]
    ds_read_b64_tr_b16 v[182:183], v239 offset:1792
    s_waitcnt lgkmcnt(4)
    v_mfma_f32_16x16x32_bf16 v[56:59], v[188:191], v[160:163], v[56:59]
    ds_read_b64_tr_b16 v[184:185], v240 offset:256
    buffer_load_dwordx4 v[196:199], v248, s[28:31], s65 offen offset:0 sc1
    v_mfma_f32_16x16x32_bf16 v[60:63], v[188:191], v[164:167], v[60:63]
    ds_read_b64_tr_b16 v[186:187], v240 offset:1792
    s_waitcnt lgkmcnt(4)
    v_mfma_f32_16x16x32_bf16 v[64:67], v[176:179], v[160:163], v[64:67]
    ds_read_b64_tr_b16 v[188:189], v241 offset:256
    v_mfma_f32_16x16x32_bf16 v[68:71], v[176:179], v[164:167], v[68:71]
    ds_read_b64_tr_b16 v[190:191], v241 offset:1792
    s_waitcnt lgkmcnt(4)
    v_mfma_f32_16x16x32_bf16 v[72:75], v[180:183], v[160:163], v[72:75]
    ds_read_b64_tr_b16 v[176:177], v242 offset:0
    v_mfma_f32_16x16x32_bf16 v[76:79], v[180:183], v[164:167], v[76:79]
    ds_read_b64_tr_b16 v[178:179], v242 offset:384
    s_waitcnt lgkmcnt(4)
    v_mfma_f32_16x16x32_bf16 v[80:83], v[184:187], v[160:163], v[80:83]
    ds_read_b64_tr_b16 v[180:181], v242 offset:32
    s_add_u32 m0, s69, 76544
    s_add_u32 s55, s55, 1
    buffer_load_dwordx4 v245, s[32:35], s56 offen lds
    buffer_load_dwordx4 v[200:203], v248, s[28:31], s64 offen offset:1024 sc1
    v_mfma_f32_16x16x32_bf16 v[84:87], v[184:187], v[164:167], v[84:87]
    ds_read_b64_tr_b16 v[182:183], v242 offset:416
    s_waitcnt lgkmcnt(4)
    v_mfma_f32_16x16x32_bf16 v[88:91], v[188:191], v[160:163], v[88:91]
    ds_read_b64_tr_b16 v[184:185], v242 offset:64
    v_mfma_f32_16x16x32_bf16 v[92:95], v[188:191], v[164:167], v[92:95]
    ds_read_b64_tr_b16 v[186:187], v242 offset:448
    s_waitcnt lgkmcnt(4)
    v_mfma_f32_16x16x32_bf16 v[96:99], v[176:179], v[160:163], v[96:99]
    ds_read_b64_tr_b16 v[188:189], v242 offset:768
    v_mfma_f32_16x16x32_bf16 v[100:103], v[176:179], v[164:167], v[100:103]
    ds_read_b64_tr_b16 v[190:191], v242 offset:1152
    buffer_load_dwordx4 v[204:207], v248, s[28:31], s65 offen offset:1024 sc1
    s_waitcnt lgkmcnt(4)
    v_mfma_f32_16x16x32_bf16 v[104:107], v[180:183], v[160:163], v[104:107]
    ds_read_b64_tr_b16 v[176:177], v242 offset:800
    v_mfma_f32_16x16x32_bf16 v[108:111], v[180:183], v[164:167], v[108:111]
    ds_read_b64_tr_b16 v[178:179], v242 offset:1184
    s_waitcnt lgkmcnt(4)
    v_mfma_f32_16x16x32_bf16 v[112:115], v[184:187], v[160:163], v[112:115]
    ds_read_b64_tr_b16 v[180:181], v242 offset:832
    v_mfma_f32_16x16x32_bf16 v[116:119], v[184:187], v[164:167], v[116:119]
    ds_read_b64_tr_b16 v[182:183], v242 offset:1216
    s_waitcnt lgkmcnt(4)
    v_mfma_f32_16x16x32_bf16 v[120:123], v[188:191], v[160:163], v[120:123]
    ds_read_b64_tr_b16 v[184:185], v238 offset:12288
    v_mfma_f32_16x16x32_bf16 v[124:127], v[188:191], v[164:167], v[124:127]
    ds_read_b64_tr_b16 v[186:187], v238 offset:13824
    s_add_u32 m0, s69, 77568
    s_cmp_eq_u32 s55, 10
    buffer_load_dwordx4 v246, s[32:35], s56 offen lds
    s_cselect_b32 s55, 1, s55
    s_lshl_b32 s64, s60, 11
    s_add_u32 s60, s60, 1
    s_add_u32 s65, s64, 20480
    s_cmp_eq_u32 s60, 10
    s_cselect_b32 s60, 1, s60
    s_waitcnt lgkmcnt(4)
    v_mfma_f32_16x16x32_bf16 v[128:131], v[176:179], v[160:163], v[128:131]
    ds_read_b64_tr_b16 v[188:189], v239 offset:12288
    v_mfma_f32_16x16x32_bf16 v[132:135], v[176:179], v[164:167], v[132:135]
    ds_read_b64_tr_b16 v[190:191], v239 offset:13824
    s_waitcnt lgkmcnt(4)
    v_mfma_f32_16x16x32_bf16 v[136:139], v[180:183], v[160:163], v[136:139]
    ds_read_b64_tr_b16 v[176:177], v240 offset:12288
    v_mfma_f32_16x16x32_bf16 v[140:143], v[180:183], v[164:167], v[140:143]
    ds_read_b64_tr_b16 v[178:179], v240 offset:13824
    s_waitcnt vmcnt(12)
    s_waitcnt lgkmcnt(4)
    v_mfma_f32_16x16x32_bf16 v[0:3], v[184:187], v[168:171], v[0:3]
    ds_read_b64_tr_b16 v[180:181], v241 offset:12288
    v_mfma_f32_16x16x32_bf16 v[4:7], v[184:187], v[172:175], v[4:7]
    ds_read_b64_tr_b16 v[182:183], v241 offset:13824
    buffer_load_dwordx4 v[144:147], v248, s[28:31], s64 offen offset:0 sc1
    s_waitcnt lgkmcnt(4)
    v_mfma_f32_16x16x32_bf16 v[8:11], v[188:191], v[168:171], v[8:11]
    ds_read_b64_tr_b16 v[184:185], v238 offset:12416
    v_mfma_f32_16x16x32_bf16 v[12:15], v[188:191], v[172:175], v[12:15]
    ds_read_b64_tr_b16 v[186:187], v238 offset:13952
    s_waitcnt lgkmcnt(4)
    v_mfma_f32_16x16x32_bf16 v[16:19], v[176:179], v[168:171], v[16:19]
    ds_read_b64_tr_b16 v[188:189], v239 offset:12416
    v_mfma_f32_16x16x32_bf16 v[20:23], v[176:179], v[172:175], v[20:23]
    ds_read_b64_tr_b16 v[190:191], v239 offset:13952
    s_add_u32 m0, s59, 75520
    s_mov_b64 exec, s[62:63]
    buffer_load_dwordx4 v243, s[36:39], s57 offen lds
    s_mov_b64 exec, -1
    s_waitcnt lgkmcnt(4)
    v_mfma_f32_16x16x32_bf16 v[24:27], v[180:183], v[168:171], v[24:27]
    ds_read_b64_tr_b16 v[176:177], v240 offset:12416
    buffer_load_dwordx4 v[148:151], v248, s[28:31], s65 offen offset:0 sc1
    v_mfma_f32_16x16x32_bf16 v[28:31], v[180:183], v[172:175], v[28:31]
    ds_read_b64_tr_b16 v[178:179], v240 offset:13952
    s_waitcnt lgkmcnt(4)
    v_mfma_f32_16x16x32_bf16 v[32:35], v[184:187], v[168:171], v[32:35]
    ds_read_b64_tr_b16 v[180:181], v241 offset:12416
    v_mfma_f32_16x16x32_bf16 v[36:39], v[184:187], v[172:175], v[36:39]
    ds_read_b64_tr_b16 v[182:183], v241 offset:13952
    s_waitcnt lgkmcnt(4)
    v_mfma_f32_16x16x32_bf16 v[40:43], v[188:191], v[168:171], v[40:43]
    ds_read_b64_tr_b16 v[184:185], v238 offset:12544
    v_mfma_f32_16x16x32_bf16 v[44:47], v[188:191], v[172:175], v[44:47]
    ds_read_b64_tr_b16 v[186:187], v238 offset:14080
    s_waitcnt lgkmcnt(4)
    v_mfma_f32_16x16x32_bf16 v[48:51], v[176:179], v[168:171], v[48:51]
    ds_read_b64_tr_b16 v[188:189], v239 offset:12544
    buffer_load_dwordx4 v[152:155], v248, s[28:31], s64 offen offset:1024 sc1
    v_mfma_f32_16x16x32_bf16 v[52:55], v[176:179], v[172:175], v[52:55]
    ds_read_b64_tr_b16 v[190:191], v239 offset:14080
    s_waitcnt lgkmcnt(4)
    v_mfma_f32_16x16x32_bf16 v[56:59], v[180:183], v[168:171], v[56:59]
    ds_read_b64_tr_b16 v[176:177], v240 offset:12544
    v_mfma_f32_16x16x32_bf16 v[60:63], v[180:183], v[172:175], v[60:63]
    ds_read_b64_tr_b16 v[178:179], v240 offset:14080
    s_add_u32 m0, s59, 77184
    s_mov_b64 exec, s[62:63]
    buffer_load_dwordx4 v243, s[36:39], s58 offen lds
    s_mov_b64 exec, -1
    s_waitcnt lgkmcnt(4)
    v_mfma_f32_16x16x32_bf16 v[64:67], v[184:187], v[168:171], v[64:67]
    ds_read_b64_tr_b16 v[180:181], v241 offset:12544
    v_mfma_f32_16x16x32_bf16 v[68:71], v[184:187], v[172:175], v[68:71]
    ds_read_b64_tr_b16 v[182:183], v241 offset:14080
    s_waitcnt lgkmcnt(4)
    v_mfma_f32_16x16x32_bf16 v[72:75], v[188:191], v[168:171], v[72:75]
    ds_read_b64_tr_b16 v[184:185], v242 offset:6656
    buffer_load_dwordx4 v[156:159], v248, s[28:31], s65 offen offset:1024 sc1
    v_mfma_f32_16x16x32_bf16 v[76:79], v[188:191], v[172:175], v[76:79]
    ds_read_b64_tr_b16 v[186:187], v242 offset:7040
    s_waitcnt lgkmcnt(4)
    v_mfma_f32_16x16x32_bf16 v[80:83], v[176:179], v[168:171], v[80:83]
    ds_read_b64_tr_b16 v[188:189], v242 offset:6688
    v_mfma_f32_16x16x32_bf16 v[84:87], v[176:179], v[172:175], v[84:87]
    ds_read_b64_tr_b16 v[190:191], v242 offset:7072
    s_waitcnt lgkmcnt(4)
    v_mfma_f32_16x16x32_bf16 v[88:91], v[180:183], v[168:171], v[88:91]
    ds_read_b64_tr_b16 v[176:177], v242 offset:6720
    v_mfma_f32_16x16x32_bf16 v[92:95], v[180:183], v[172:175], v[92:95]
    ds_read_b64_tr_b16 v[178:179], v242 offset:7104
    s_waitcnt lgkmcnt(4)
    v_mfma_f32_16x16x32_bf16 v[96:99], v[184:187], v[168:171], v[96:99]
    ds_read_b64_tr_b16 v[180:181], v242 offset:7424
    v_mfma_f32_16x16x32_bf16 v[100:103], v[184:187], v[172:175], v[100:103]
    ds_read_b64_tr_b16 v[182:183], v242 offset:7808
    s_waitcnt lgkmcnt(4)
    v_mfma_f32_16x16x32_bf16 v[104:107], v[188:191], v[168:171], v[104:107]
    ds_read_b64_tr_b16 v[184:185], v242 offset:7456
    v_mfma_f32_16x16x32_bf16 v[108:111], v[188:191], v[172:175], v[108:111]
    ds_read_b64_tr_b16 v[186:187], v242 offset:7840
    s_waitcnt lgkmcnt(4)
    v_mfma_f32_16x16x32_bf16 v[112:115], v[176:179], v[168:171], v[112:115]
    ds_read_b64_tr_b16 v[188:189], v242 offset:7488
    v_mfma_f32_16x16x32_bf16 v[116:119], v[176:179], v[172:175], v[116:119]
    ds_read_b64_tr_b16 v[190:191], v242 offset:7872
    s_waitcnt vmcnt(13)
    s_waitcnt lgkmcnt(0)
    s_barrier
    v_mfma_f32_16x16x32_bf16 v[120:123], v[180:183], v[168:171], v[120:123]
    ds_read_b64_tr_b16 v[176:177], v238 offset:37760
    v_mfma_f32_16x16x32_bf16 v[124:127], v[180:183], v[172:175], v[124:127]
    ds_read_b64_tr_b16 v[178:179], v238 offset:39296
    v_mfma_f32_16x16x32_bf16 v[128:131], v[184:187], v[168:171], v[128:131]
    ds_read_b64_tr_b16 v[180:181], v239 offset:37760
    v_mfma_f32_16x16x32_bf16 v[132:135], v[184:187], v[172:175], v[132:135]
    ds_read_b64_tr_b16 v[182:183], v239 offset:39296
    v_mfma_f32_16x16x32_bf16 v[136:139], v[188:191], v[168:171], v[136:139]
    ds_read_b64_tr_b16 v[184:185], v240 offset:37760
    v_mfma_f32_16x16x32_bf16 v[140:143], v[188:191], v[172:175], v[140:143]
    ds_read_b64_tr_b16 v[186:187], v240 offset:39296
    s_waitcnt vmcnt(10)
    s_waitcnt lgkmcnt(4)
    v_mfma_f32_16x16x32_bf16 v[0:3], v[176:179], v[192:195], v[0:3]
    ds_read_b64_tr_b16 v[188:189], v241 offset:37760
    s_mul_i32 s56, s55, 786432
    s_mul_i32 s57, s55, 196608
    v_mfma_f32_16x16x32_bf16 v[4:7], v[176:179], v[196:199], v[4:7]
    ds_read_b64_tr_b16 v[190:191], v241 offset:39296
    s_waitcnt lgkmcnt(4)
    v_mfma_f32_16x16x32_bf16 v[8:11], v[180:183], v[192:195], v[8:11]
    ds_read_b64_tr_b16 v[176:177], v238 offset:37888
    v_mfma_f32_16x16x32_bf16 v[12:15], v[180:183], v[196:199], v[12:15]
    ds_read_b64_tr_b16 v[178:179], v238 offset:39424
    s_lshl_b32 s64, s60, 11
    s_add_u32 s60, s60, 1
    s_add_u32 s65, s64, 20480
    s_cmp_eq_u32 s60, 10
    s_cselect_b32 s60, 1, s60
    s_waitcnt lgkmcnt(4)
    v_mfma_f32_16x16x32_bf16 v[16:19], v[184:187], v[192:195], v[16:19]
    ds_read_b64_tr_b16 v[180:181], v239 offset:37888
    v_mfma_f32_16x16x32_bf16 v[20:23], v[184:187], v[196:199], v[20:23]
    ds_read_b64_tr_b16 v[182:183], v239 offset:39424
    s_waitcnt lgkmcnt(4)
    v_mfma_f32_16x16x32_bf16 v[24:27], v[188:191], v[192:195], v[24:27]
    ds_read_b64_tr_b16 v[184:185], v240 offset:37888
    v_mfma_f32_16x16x32_bf16 v[28:31], v[188:191], v[196:199], v[28:31]
    ds_read_b64_tr_b16 v[186:187], v240 offset:39424
    s_waitcnt lgkmcnt(4)
    v_mfma_f32_16x16x32_bf16 v[32:35], v[176:179], v[192:195], v[32:35]
    ds_read_b64_tr_b16 v[188:189], v241 offset:37888
    v_mfma_f32_16x16x32_bf16 v[36:39], v[176:179], v[196:199], v[36:39]
    ds_read_b64_tr_b16 v[190:191], v241 offset:39424
    s_waitcnt lgkmcnt(4)
    v_mfma_f32_16x16x32_bf16 v[40:43], v[180:183], v[192:195], v[40:43]
    ds_read_b64_tr_b16 v[176:177], v238 offset:38016
    s_add_u32 m0, s69, 0
    s_add_u32 s58, s57, 24576
    buffer_load_dwordx4 v244, s[32:35], s56 offen lds
    v_mfma_f32_16x16x32_bf16 v[44:47], v[180:183], v[196:199], v[44:47]
    ds_read_b64_tr_b16 v[178:179], v238 offset:39552
    s_waitcnt lgkmcnt(4)
    v_mfma_f32_16x16x32_bf16 v[48:51], v[184:187], v[192:195], v[48:51]
    ds_read_b64_tr_b16 v[180:181], v239 offset:38016
    v_mfma_f32_16x16x32_bf16 v[52:55], v[184:187], v[196:199], v[52:55]
    ds_read_b64_tr_b16 v[182:183], v239 offset:39552
    s_waitcnt lgkmcnt(4)
    v_mfma_f32_16x16x32_bf16 v[56:59], v[188:191], v[192:195], v[56:59]
    ds_read_b64_tr_b16 v[184:185], v240 offset:38016
    buffer_load_dwordx4 v[160:163], v248, s[28:31], s64 offen offset:0 sc1
    v_mfma_f32_16x16x32_bf16 v[60:63], v[188:191], v[196:199], v[60:63]
    ds_read_b64_tr_b16 v[186:187], v240 offset:39552
    s_waitcnt lgkmcnt(4)
    v_mfma_f32_16x16x32_bf16 v[64:67], v[176:179], v[192:195], v[64:67]
    ds_read_b64_tr_b16 v[188:189], v241 offset:38016
    v_mfma_f32_16x16x32_bf16 v[68:71], v[176:179], v[196:199], v[68:71]
    ds_read_b64_tr_b16 v[190:191], v241 offset:39552
    s_waitcnt lgkmcnt(4)
    v_mfma_f32_16x16x32_bf16 v[72:75], v[180:183], v[192:195], v[72:75]
    ds_read_b64_tr_b16 v[176:177], v242 offset:37760
    v_mfma_f32_16x16x32_bf16 v[76:79], v[180:183], v[196:199], v[76:79]
    ds_read_b64_tr_b16 v[178:179], v242 offset:38144
    s_waitcnt lgkmcnt(4)
    v_mfma_f32_16x16x32_bf16 v[80:83], v[184:187], v[192:195], v[80:83]
    ds_read_b64_tr_b16 v[180:181], v242 offset:37792
    s_add_u32 m0, s69, 1024
    s_add_u32 s55, s55, 1
    buffer_load_dwordx4 v245, s[32:35], s56 offen lds
    v_mfma_f32_16x16x32_bf16 v[84:87], v[184:187], v[196:199], v[84:87]
    ds_read_b64_tr_b16 v[182:183], v242 offset:38176
    s_waitcnt lgkmcnt(4)
    v_mfma_f32_16x16x32_bf16 v[88:91], v[188:191], v[192:195], v[88:91]
    ds_read_b64_tr_b16 v[184:185], v242 offset:37824
    v_mfma_f32_16x16x32_bf16 v[92:95], v[188:191], v[196:199], v[92:95]
    ds_read_b64_tr_b16 v[186:187], v242 offset:38208
    s_waitcnt lgkmcnt(4)
    v_mfma_f32_16x16x32_bf16 v[96:99], v[176:179], v[192:195], v[96:99]
    ds_read_b64_tr_b16 v[188:189], v242 offset:38528
    v_mfma_f32_16x16x32_bf16 v[100:103], v[176:179], v[196:199], v[100:103]
    ds_read_b64_tr_b16 v[190:191], v242 offset:38912
    buffer_load_dwordx4 v[164:167], v248, s[28:31], s65 offen offset:0 sc1
    s_waitcnt lgkmcnt(4)
    v_mfma_f32_16x16x32_bf16 v[104:107], v[180:183], v[192:195], v[104:107]
    ds_read_b64_tr_b16 v[176:177], v242 offset:38560
    v_mfma_f32_16x16x32_bf16 v[108:111], v[180:183], v[196:199], v[108:111]
    ds_read_b64_tr_b16 v[178:179], v242 offset:38944
    s_waitcnt lgkmcnt(4)
    v_mfma_f32_16x16x32_bf16 v[112:115], v[184:187], v[192:195], v[112:115]
    ds_read_b64_tr_b16 v[180:181], v242 offset:38592
    v_mfma_f32_16x16x32_bf16 v[116:119], v[184:187], v[196:199], v[116:119]
    ds_read_b64_tr_b16 v[182:183], v242 offset:38976
    s_waitcnt lgkmcnt(4)
    v_mfma_f32_16x16x32_bf16 v[120:123], v[188:191], v[192:195], v[120:123]
    ds_read_b64_tr_b16 v[184:185], v238 offset:50048
    v_mfma_f32_16x16x32_bf16 v[124:127], v[188:191], v[196:199], v[124:127]
    ds_read_b64_tr_b16 v[186:187], v238 offset:51584
    s_add_u32 m0, s69, 2048
    s_cmp_eq_u32 s55, 10
    buffer_load_dwordx4 v246, s[32:35], s56 offen lds
    s_cselect_b32 s55, 1, s55
    s_waitcnt lgkmcnt(4)
    v_mfma_f32_16x16x32_bf16 v[128:131], v[176:179], v[192:195], v[128:131]
    ds_read_b64_tr_b16 v[188:189], v239 offset:50048
    v_mfma_f32_16x16x32_bf16 v[132:135], v[176:179], v[196:199], v[132:135]
    ds_read_b64_tr_b16 v[190:191], v239 offset:51584
    s_waitcnt lgkmcnt(4)
    v_mfma_f32_16x16x32_bf16 v[136:139], v[180:183], v[192:195], v[136:139]
    ds_read_b64_tr_b16 v[176:177], v240 offset:50048
    v_mfma_f32_16x16x32_bf16 v[140:143], v[180:183], v[196:199], v[140:143]
    ds_read_b64_tr_b16 v[178:179], v240 offset:51584
    s_waitcnt vmcnt(12)
    s_waitcnt lgkmcnt(4)
    v_mfma_f32_16x16x32_bf16 v[0:3], v[184:187], v[200:203], v[0:3]
    ds_read_b64_tr_b16 v[180:181], v241 offset:50048
    v_mfma_f32_16x16x32_bf16 v[4:7], v[184:187], v[204:207], v[4:7]
    ds_read_b64_tr_b16 v[182:183], v241 offset:51584
    buffer_load_dwordx4 v[168:171], v248, s[28:31], s64 offen offset:1024 sc1
    s_waitcnt lgkmcnt(4)
    v_mfma_f32_16x16x32_bf16 v[8:11], v[188:191], v[200:203], v[8:11]
    ds_read_b64_tr_b16 v[184:185], v238 offset:50176
    v_mfma_f32_16x16x32_bf16 v[12:15], v[188:191], v[204:207], v[12:15]
    ds_read_b64_tr_b16 v[186:187], v238 offset:51712
    s_waitcnt lgkmcnt(4)
    v_mfma_f32_16x16x32_bf16 v[16:19], v[176:179], v[200:203], v[16:19]
    ds_read_b64_tr_b16 v[188:189], v239 offset:50176
    v_mfma_f32_16x16x32_bf16 v[20:23], v[176:179], v[204:207], v[20:23]
    ds_read_b64_tr_b16 v[190:191], v239 offset:51712
    s_add_u32 m0, s59, 0
    s_mov_b64 exec, s[62:63]
    buffer_load_dwordx4 v243, s[36:39], s57 offen lds
    s_mov_b64 exec, -1
    s_waitcnt lgkmcnt(4)
    v_mfma_f32_16x16x32_bf16 v[24:27], v[180:183], v[200:203], v[24:27]
    ds_read_b64_tr_b16 v[176:177], v240 offset:50176
    v_mfma_f32_16x16x32_bf16 v[28:31], v[180:183], v[204:207], v[28:31]
    ds_read_b64_tr_b16 v[178:179], v240 offset:51712
    s_waitcnt lgkmcnt(4)
    v_mfma_f32_16x16x32_bf16 v[32:35], v[184:187], v[200:203], v[32:35]
    ds_read_b64_tr_b16 v[180:181], v241 offset:50176
    v_mfma_f32_16x16x32_bf16 v[36:39], v[184:187], v[204:207], v[36:39]
    ds_read_b64_tr_b16 v[182:183], v241 offset:51712
    s_waitcnt lgkmcnt(4)
    v_mfma_f32_16x16x32_bf16 v[40:43], v[188:191], v[200:203], v[40:43]
    ds_read_b64_tr_b16 v[184:185], v238 offset:50304
    v_mfma_f32_16x16x32_bf16 v[44:47], v[188:191], v[204:207], v[44:47]
    ds_read_b64_tr_b16 v[186:187], v238 offset:51840
    s_waitcnt lgkmcnt(4)
    v_mfma_f32_16x16x32_bf16 v[48:51], v[176:179], v[200:203], v[48:51]
    ds_read_b64_tr_b16 v[188:189], v239 offset:50304
    buffer_load_dwordx4 v[172:175], v248, s[28:31], s65 offen offset:1024 sc1
    v_mfma_f32_16x16x32_bf16 v[52:55], v[176:179], v[204:207], v[52:55]
    ds_read_b64_tr_b16 v[190:191], v239 offset:51840
    s_waitcnt lgkmcnt(4)
    v_mfma_f32_16x16x32_bf16 v[56:59], v[180:183], v[200:203], v[56:59]
    ds_read_b64_tr_b16 v[176:177], v240 offset:50304
    v_mfma_f32_16x16x32_bf16 v[60:63], v[180:183], v[204:207], v[60:63]
    ds_read_b64_tr_b16 v[178:179], v240 offset:51840
    s_add_u32 m0, s59, 1664
    s_mov_b64 exec, s[62:63]
    buffer_load_dwordx4 v243, s[36:39], s58 offen lds
    s_mov_b64 exec, -1
    s_waitcnt lgkmcnt(4)
    v_mfma_f32_16x16x32_bf16 v[64:67], v[184:187], v[200:203], v[64:67]
    ds_read_b64_tr_b16 v[180:181], v241 offset:50304
    v_mfma_f32_16x16x32_bf16 v[68:71], v[184:187], v[204:207], v[68:71]
    ds_read_b64_tr_b16 v[182:183], v241 offset:51840
    s_waitcnt lgkmcnt(4)
    v_mfma_f32_16x16x32_bf16 v[72:75], v[188:191], v[200:203], v[72:75]
    ds_read_b64_tr_b16 v[184:185], v242 offset:44416
    v_mfma_f32_16x16x32_bf16 v[76:79], v[188:191], v[204:207], v[76:79]
    ds_read_b64_tr_b16 v[186:187], v242 offset:44800
    s_waitcnt lgkmcnt(4)
    v_mfma_f32_16x16x32_bf16 v[80:83], v[176:179], v[200:203], v[80:83]
    ds_read_b64_tr_b16 v[188:189], v242 offset:44448
    v_mfma_f32_16x16x32_bf16 v[84:87], v[176:179], v[204:207], v[84:87]
    ds_read_b64_tr_b16 v[190:191], v242 offset:44832
    s_waitcnt lgkmcnt(4)
    v_mfma_f32_16x16x32_bf16 v[88:91], v[180:183], v[200:203], v[88:91]
    ds_read_b64_tr_b16 v[176:177], v242 offset:44480
    v_mfma_f32_16x16x32_bf16 v[92:95], v[180:183], v[204:207], v[92:95]
    ds_read_b64_tr_b16 v[178:179], v242 offset:44864
    s_waitcnt lgkmcnt(4)
    v_mfma_f32_16x16x32_bf16 v[96:99], v[184:187], v[200:203], v[96:99]
    ds_read_b64_tr_b16 v[180:181], v242 offset:45184
    v_mfma_f32_16x16x32_bf16 v[100:103], v[184:187], v[204:207], v[100:103]
    ds_read_b64_tr_b16 v[182:183], v242 offset:45568
    s_waitcnt lgkmcnt(4)
    v_mfma_f32_16x16x32_bf16 v[104:107], v[188:191], v[200:203], v[104:107]
    ds_read_b64_tr_b16 v[184:185], v242 offset:45216
    v_mfma_f32_16x16x32_bf16 v[108:111], v[188:191], v[204:207], v[108:111]
    ds_read_b64_tr_b16 v[186:187], v242 offset:45600
    s_add_u32 s74, s54, 0
    s_and_b32 s74, s74, 7
    s_mul_i32 s74, s74, 24576
    s_waitcnt lgkmcnt(4)
    v_mfma_f32_16x16x32_bf16 v[112:115], v[176:179], v[200:203], v[112:115]
    ds_read_b64_tr_b16 v[188:189], v242 offset:45248
    s_add_u32 m0, s69, 114688
    s_nop 0
    buffer_load_dwordx4 v249, s[40:43], s74 offen lds
    v_mfma_f32_16x16x32_bf16 v[116:119], v[176:179], v[204:207], v[116:119]
    ds_read_b64_tr_b16 v[190:191], v242 offset:45632
    s_waitcnt vmcnt(11)
    s_waitcnt lgkmcnt(0)
    s_barrier
    v_add_u32 v238, 75520, v238
    v_add_u32 v239, 75520, v239
    v_add_u32 v240, 75520, v240
    v_add_u32 v241, 75520, v241
    v_add_u32 v242, 75520, v242
    v_mfma_f32_16x16x32_bf16 v[120:123], v[180:183], v[200:203], v[120:123]
    ds_read_b64_tr_b16 v[176:177], v238 offset:0
    v_mfma_f32_16x16x32_bf16 v[124:127], v[180:183], v[204:207], v[124:127]
    ds_read_b64_tr_b16 v[178:179], v238 offset:1536
    v_mfma_f32_16x16x32_bf16 v[128:131], v[184:187], v[200:203], v[128:131]
    ds_read_b64_tr_b16 v[180:181], v239 offset:0
    v_mfma_f32_16x16x32_bf16 v[132:135], v[184:187], v[204:207], v[132:135]
    ds_read_b64_tr_b16 v[182:183], v239 offset:1536
    v_mfma_f32_16x16x32_bf16 v[136:139], v[188:191], v[200:203], v[136:139]
    ds_read_b64_tr_b16 v[184:185], v240 offset:0
    v_mfma_f32_16x16x32_bf16 v[140:143], v[188:191], v[204:207], v[140:143]
    ds_read_b64_tr_b16 v[186:187], v240 offset:1536
    s_waitcnt lgkmcnt(4)
    v_mfma_f32_16x16x32_bf16 v[0:3], v[176:179], v[144:147], v[0:3]
    ds_read_b64_tr_b16 v[188:189], v241 offset:0
    s_mul_i32 s56, s55, 786432
    s_mul_i32 s57, s55, 196608
    v_mfma_f32_16x16x32_bf16 v[4:7], v[176:179], v[148:151], v[4:7]
    ds_read_b64_tr_b16 v[190:191], v241 offset:1536
    s_waitcnt lgkmcnt(4)
    v_mfma_f32_16x16x32_bf16 v[8:11], v[180:183], v[144:147], v[8:11]
    ds_read_b64_tr_b16 v[176:177], v238 offset:128
    v_mfma_f32_16x16x32_bf16 v[12:15], v[180:183], v[148:151], v[12:15]
    ds_read_b64_tr_b16 v[178:179], v238 offset:1664
    s_lshl_b32 s64, s60, 11
    s_add_u32 s60, s60, 1
    s_add_u32 s65, s64, 20480
    s_cmp_eq_u32 s60, 10
    s_cselect_b32 s60, 1, s60
    s_waitcnt lgkmcnt(4)
    v_mfma_f32_16x16x32_bf16 v[16:19], v[184:187], v[144:147], v[16:19]
    ds_read_b64_tr_b16 v[180:181], v239 offset:128
    v_mfma_f32_16x16x32_bf16 v[20:23], v[184:187], v[148:151], v[20:23]
    ds_read_b64_tr_b16 v[182:183], v239 offset:1664
    s_waitcnt lgkmcnt(4)
    v_mfma_f32_16x16x32_bf16 v[24:27], v[188:191], v[144:147], v[24:27]
    ds_read_b64_tr_b16 v[184:185], v240 offset:128
    v_mfma_f32_16x16x32_bf16 v[28:31], v[188:191], v[148:151], v[28:31]
    ds_read_b64_tr_b16 v[186:187], v240 offset:1664
    s_waitcnt lgkmcnt(4)
    v_mfma_f32_16x16x32_bf16 v[32:35], v[176:179], v[144:147], v[32:35]
    ds_read_b64_tr_b16 v[188:189], v241 offset:128
    v_mfma_f32_16x16x32_bf16 v[36:39], v[176:179], v[148:151], v[36:39]
    ds_read_b64_tr_b16 v[190:191], v241 offset:1664
    s_waitcnt lgkmcnt(4)
    v_mfma_f32_16x16x32_bf16 v[40:43], v[180:183], v[144:147], v[40:43]
    ds_read_b64_tr_b16 v[176:177], v238 offset:256
    s_add_u32 m0, s69, 37760
    s_add_u32 s58, s57, 24576
    buffer_load_dwordx4 v244, s[32:35], s56 offen lds
    v_mfma_f32_16x16x32_bf16 v[44:47], v[180:183], v[148:151], v[44:47]
    ds_read_b64_tr_b16 v[178:179], v238 offset:1792
    s_waitcnt lgkmcnt(4)
    v_mfma_f32_16x16x32_bf16 v[48:51], v[184:187], v[144:147], v[48:51]
    ds_read_b64_tr_b16 v[180:181], v239 offset:256
    v_mfma_f32_16x16x32_bf16 v[52:55], v[184:187], v[148:151], v[52:55]
    ds_read_b64_tr_b16 v[182:183], v239 offset:1792
    s_waitcnt lgkmcnt(4)
    v_mfma_f32_16x16x32_bf16 v[56:59], v[188:191], v[144:147], v[56:59]
    ds_read_b64_tr_b16 v[184:185], v240 offset:256
    buffer_load_dwordx4 v[192:195], v248, s[28:31], s64 offen offset:0 sc1
    v_mfma_f32_16x16x32_bf16 v[60:63], v[188:191], v[148:151], v[60:63]
    ds_read_b64_tr_b16 v[186:187], v240 offset:1792
    s_waitcnt lgkmcnt(4)
    v_mfma_f32_16x16x32_bf16 v[64:67], v[176:179], v[144:147], v[64:67]
    ds_read_b64_tr_b16 v[188:189], v241 offset:256
    v_mfma_f32_16x16x32_bf16 v[68:71], v[176:179], v[148:151], v[68:71]
    ds_read_b64_tr_b16 v[190:191], v241 offset:1792
    s_waitcnt lgkmcnt(4)
    v_mfma_f32_16x16x32_bf16 v[72:75], v[180:183], v[144:147], v[72:75]
    ds_read_b64_tr_b16 v[176:177], v242 offset:0
    v_mfma_f32_16x16x32_bf16 v[76:79], v[180:183], v[148:151], v[76:79]
    ds_read_b64_tr_b16 v[178:179], v242 offset:384
    s_waitcnt lgkmcnt(4)
    v_mfma_f32_16x16x32_bf16 v[80:83], v[184:187], v[144:147], v[80:83]
    ds_read_b64_tr_b16 v[180:181], v242 offset:32
    s_add_u32 m0, s69, 38784
    s_add_u32 s55, s55, 1
    buffer_load_dwordx4 v245, s[32:35], s56 offen lds
    v_mfma_f32_16x16x32_bf16 v[84:87], v[184:187], v[148:151], v[84:87]
    ds_read_b64_tr_b16 v[182:183], v242 offset:416
    s_waitcnt lgkmcnt(4)
    v_mfma_f32_16x16x32_bf16 v[88:91], v[188:191], v[144:147], v[88:91]
    ds_read_b64_tr_b16 v[184:185], v242 offset:64
    v_mfma_f32_16x16x32_bf16 v[92:95], v[188:191], v[148:151], v[92:95]
    ds_read_b64_tr_b16 v[186:187], v242 offset:448
    s_waitcnt lgkmcnt(4)
    v_mfma_f32_16x16x32_bf16 v[96:99], v[176:179], v[144:147], v[96:99]
    ds_read_b64_tr_b16 v[188:189], v242 offset:768
    v_mfma_f32_16x16x32_bf16 v[100:103], v[176:179], v[148:151], v[100:103]
    ds_read_b64_tr_b16 v[190:191], v242 offset:1152
    buffer_load_dwordx4 v[196:199], v248, s[28:31], s65 offen offset:0 sc1
    s_waitcnt lgkmcnt(4)
    v_mfma_f32_16x16x32_bf16 v[104:107], v[180:183], v[144:147], v[104:107]
    ds_read_b64_tr_b16 v[176:177], v242 offset:800
    v_mfma_f32_16x16x32_bf16 v[108:111], v[180:183], v[148:151], v[108:111]
    ds_read_b64_tr_b16 v[178:179], v242 offset:1184
    s_waitcnt lgkmcnt(4)
    v_mfma_f32_16x16x32_bf16 v[112:115], v[184:187], v[144:147], v[112:115]
    ds_read_b64_tr_b16 v[180:181], v242 offset:832
    v_mfma_f32_16x16x32_bf16 v[116:119], v[184:187], v[148:151], v[116:119]
    ds_read_b64_tr_b16 v[182:183], v242 offset:1216
    s_waitcnt lgkmcnt(4)
    v_mfma_f32_16x16x32_bf16 v[120:123], v[188:191], v[144:147], v[120:123]
    ds_read_b64_tr_b16 v[184:185], v238 offset:12288
    v_mfma_f32_16x16x32_bf16 v[124:127], v[188:191], v[148:151], v[124:127]
    ds_read_b64_tr_b16 v[186:187], v238 offset:13824
    s_add_u32 m0, s69, 39808
    s_cmp_eq_u32 s55, 10
    buffer_load_dwordx4 v246, s[32:35], s56 offen lds
    s_cselect_b32 s55, 1, s55
    s_waitcnt lgkmcnt(4)
    v_mfma_f32_16x16x32_bf16 v[128:131], v[176:179], v[144:147], v[128:131]
    ds_read_b64_tr_b16 v[188:189], v239 offset:12288
    v_mfma_f32_16x16x32_bf16 v[132:135], v[176:179], v[148:151], v[132:135]
    ds_read_b64_tr_b16 v[190:191], v239 offset:13824
    s_waitcnt lgkmcnt(4)
    v_mfma_f32_16x16x32_bf16 v[136:139], v[180:183], v[144:147], v[136:139]
    ds_read_b64_tr_b16 v[176:177], v240 offset:12288
    v_mfma_f32_16x16x32_bf16 v[140:143], v[180:183], v[148:151], v[140:143]
    ds_read_b64_tr_b16 v[178:179], v240 offset:13824
    s_waitcnt vmcnt(15)
    s_waitcnt lgkmcnt(4)
    v_mfma_f32_16x16x32_bf16 v[0:3], v[184:187], v[152:155], v[0:3]
    ds_read_b64_tr_b16 v[180:181], v241 offset:12288
    v_mfma_f32_16x16x32_bf16 v[4:7], v[184:187], v[156:159], v[4:7]
    ds_read_b64_tr_b16 v[182:183], v241 offset:13824
    buffer_load_dwordx4 v[200:203], v248, s[28:31], s64 offen offset:1024 sc1
    s_waitcnt lgkmcnt(4)
    v_mfma_f32_16x16x32_bf16 v[8:11], v[188:191], v[152:155], v[8:11]
    ds_read_b64_tr_b16 v[184:185], v238 offset:12416
    v_mfma_f32_16x16x32_bf16 v[12:15], v[188:191], v[156:159], v[12:15]
    ds_read_b64_tr_b16 v[186:187], v238 offset:13952
    s_waitcnt lgkmcnt(4)
    v_mfma_f32_16x16x32_bf16 v[16:19], v[176:179], v[152:155], v[16:19]
    ds_read_b64_tr_b16 v[188:189], v239 offset:12416
    v_mfma_f32_16x16x32_bf16 v[20:23], v[176:179], v[156:159], v[20:23]
    ds_read_b64_tr_b16 v[190:191], v239 offset:13952
    s_add_u32 m0, s59, 37760
    s_mov_b64 exec, s[62:63]
    buffer_load_dwordx4 v243, s[36:39], s57 offen lds
    s_mov_b64 exec, -1
    s_waitcnt lgkmcnt(4)
    v_mfma_f32_16x16x32_bf16 v[24:27], v[180:183], v[152:155], v[24:27]
    ds_read_b64_tr_b16 v[176:177], v240 offset:12416
    v_mfma_f32_16x16x32_bf16 v[28:31], v[180:183], v[156:159], v[28:31]
    ds_read_b64_tr_b16 v[178:179], v240 offset:13952
    s_waitcnt lgkmcnt(4)
    v_mfma_f32_16x16x32_bf16 v[32:35], v[184:187], v[152:155], v[32:35]
    ds_read_b64_tr_b16 v[180:181], v241 offset:12416
    v_mfma_f32_16x16x32_bf16 v[36:39], v[184:187], v[156:159], v[36:39]
    ds_read_b64_tr_b16 v[182:183], v241 offset:13952
    s_waitcnt lgkmcnt(4)
    v_mfma_f32_16x16x32_bf16 v[40:43], v[188:191], v[152:155], v[40:43]
    ds_read_b64_tr_b16 v[184:185], v238 offset:12544
    v_mfma_f32_16x16x32_bf16 v[44:47], v[188:191], v[156:159], v[44:47]
    ds_read_b64_tr_b16 v[186:187], v238 offset:14080
    s_waitcnt lgkmcnt(4)
    v_mfma_f32_16x16x32_bf16 v[48:51], v[176:179], v[152:155], v[48:51]
    ds_read_b64_tr_b16 v[188:189], v239 offset:12544
    buffer_load_dwordx4 v[204:207], v248, s[28:31], s65 offen offset:1024 sc1
    v_mfma_f32_16x16x32_bf16 v[52:55], v[176:179], v[156:159], v[52:55]
    ds_read_b64_tr_b16 v[190:191], v239 offset:14080
    s_waitcnt lgkmcnt(4)
    v_mfma_f32_16x16x32_bf16 v[56:59], v[180:183], v[152:155], v[56:59]
    ds_read_b64_tr_b16 v[176:177], v240 offset:12544
    v_mfma_f32_16x16x32_bf16 v[60:63], v[180:183], v[156:159], v[60:63]
    ds_read_b64_tr_b16 v[178:179], v240 offset:14080
    s_add_u32 m0, s59, 39424
    s_mov_b64 exec, s[62:63]
    buffer_load_dwordx4 v243, s[36:39], s58 offen lds
    s_mov_b64 exec, -1
    s_waitcnt lgkmcnt(4)
    v_mfma_f32_16x16x32_bf16 v[64:67], v[184:187], v[152:155], v[64:67]
    ds_read_b64_tr_b16 v[180:181], v241 offset:12544
    v_mfma_f32_16x16x32_bf16 v[68:71], v[184:187], v[156:159], v[68:71]
    ds_read_b64_tr_b16 v[182:183], v241 offset:14080
    s_waitcnt lgkmcnt(4)
    v_mfma_f32_16x16x32_bf16 v[72:75], v[188:191], v[152:155], v[72:75]
    ds_read_b64_tr_b16 v[184:185], v242 offset:6656
    v_mfma_f32_16x16x32_bf16 v[76:79], v[188:191], v[156:159], v[76:79]
    ds_read_b64_tr_b16 v[186:187], v242 offset:7040
    s_waitcnt lgkmcnt(4)
    v_mfma_f32_16x16x32_bf16 v[80:83], v[176:179], v[152:155], v[80:83]
    ds_read_b64_tr_b16 v[188:189], v242 offset:6688
    v_mfma_f32_16x16x32_bf16 v[84:87], v[176:179], v[156:159], v[84:87]
    ds_read_b64_tr_b16 v[190:191], v242 offset:7072
    s_waitcnt lgkmcnt(4)
    v_mfma_f32_16x16x32_bf16 v[88:91], v[180:183], v[152:155], v[88:91]
    ds_read_b64_tr_b16 v[176:177], v242 offset:6720
    v_mfma_f32_16x16x32_bf16 v[92:95], v[180:183], v[156:159], v[92:95]
    ds_read_b64_tr_b16 v[178:179], v242 offset:7104
    s_waitcnt lgkmcnt(4)
    v_mfma_f32_16x16x32_bf16 v[96:99], v[184:187], v[152:155], v[96:99]
    ds_read_b64_tr_b16 v[180:181], v242 offset:7424
    v_mfma_f32_16x16x32_bf16 v[100:103], v[184:187], v[156:159], v[100:103]
    ds_read_b64_tr_b16 v[182:183], v242 offset:7808
    s_waitcnt lgkmcnt(4)
    v_mfma_f32_16x16x32_bf16 v[104:107], v[188:191], v[152:155], v[104:107]
    ds_read_b64_tr_b16 v[184:185], v242 offset:7456
    v_mfma_f32_16x16x32_bf16 v[108:111], v[188:191], v[156:159], v[108:111]
    ds_read_b64_tr_b16 v[186:187], v242 offset:7840
    s_add_u32 m0, s69, 115712
    s_nop 0
    buffer_load_dwordx4 v250, s[40:43], s74 offen lds
    s_waitcnt lgkmcnt(4)
    v_mfma_f32_16x16x32_bf16 v[112:115], v[176:179], v[152:155], v[112:115]
    ds_read_b64_tr_b16 v[188:189], v242 offset:7488
    v_mfma_f32_16x16x32_bf16 v[116:119], v[176:179], v[156:159], v[116:119]
    ds_read_b64_tr_b16 v[190:191], v242 offset:7872
    s_waitcnt vmcnt(11)
    s_waitcnt lgkmcnt(0)
    s_barrier
    v_add_u32 v238, 4294891776, v238
    v_add_u32 v239, 4294891776, v239
    v_add_u32 v240, 4294891776, v240
    v_add_u32 v241, 4294891776, v241
    v_add_u32 v242, 4294891776, v242
    v_mfma_f32_16x16x32_bf16 v[120:123], v[180:183], v[152:155], v[120:123]
    ds_read_b64_tr_b16 v[176:177], v238 offset:0
    v_mfma_f32_16x16x32_bf16 v[124:127], v[180:183], v[156:159], v[124:127]
    ds_read_b64_tr_b16 v[178:179], v238 offset:1536
    v_mfma_f32_16x16x32_bf16 v[128:131], v[184:187], v[152:155], v[128:131]
    ds_read_b64_tr_b16 v[180:181], v239 offset:0
    v_mfma_f32_16x16x32_bf16 v[132:135], v[184:187], v[156:159], v[132:135]
    ds_read_b64_tr_b16 v[182:183], v239 offset:1536
    v_mfma_f32_16x16x32_bf16 v[136:139], v[188:191], v[152:155], v[136:139]
    ds_read_b64_tr_b16 v[184:185], v240 offset:0
    v_mfma_f32_16x16x32_bf16 v[140:143], v[188:191], v[156:159], v[140:143]
    ds_read_b64_tr_b16 v[186:187], v240 offset:1536
    s_waitcnt lgkmcnt(4)
    v_mfma_f32_16x16x32_bf16 v[0:3], v[176:179], v[160:163], v[0:3]
    ds_read_b64_tr_b16 v[188:189], v241 offset:0
    s_mul_i32 s56, s55, 786432
    s_mul_i32 s57, s55, 196608
    v_mfma_f32_16x16x32_bf16 v[4:7], v[176:179], v[164:167], v[4:7]
    ds_read_b64_tr_b16 v[190:191], v241 offset:1536
    s_waitcnt lgkmcnt(4)
    v_mfma_f32_16x16x32_bf16 v[8:11], v[180:183], v[160:163], v[8:11]
    ds_read_b64_tr_b16 v[176:177], v238 offset:128
    v_mfma_f32_16x16x32_bf16 v[12:15], v[180:183], v[164:167], v[12:15]
    ds_read_b64_tr_b16 v[178:179], v238 offset:1664
    s_lshl_b32 s64, s60, 11
    s_add_u32 s60, s60, 1
    s_add_u32 s65, s64, 20480
    s_cmp_eq_u32 s60, 10
    s_cselect_b32 s60, 1, s60
    s_waitcnt lgkmcnt(4)
    v_mfma_f32_16x16x32_bf16 v[16:19], v[184:187], v[160:163], v[16:19]
    ds_read_b64_tr_b16 v[180:181], v239 offset:128
    v_mfma_f32_16x16x32_bf16 v[20:23], v[184:187], v[164:167], v[20:23]
    ds_read_b64_tr_b16 v[182:183], v239 offset:1664
    s_waitcnt lgkmcnt(4)
    v_mfma_f32_16x16x32_bf16 v[24:27], v[188:191], v[160:163], v[24:27]
    ds_read_b64_tr_b16 v[184:185], v240 offset:128
    v_mfma_f32_16x16x32_bf16 v[28:31], v[188:191], v[164:167], v[28:31]
    ds_read_b64_tr_b16 v[186:187], v240 offset:1664
    s_waitcnt lgkmcnt(4)
    v_mfma_f32_16x16x32_bf16 v[32:35], v[176:179], v[160:163], v[32:35]
    ds_read_b64_tr_b16 v[188:189], v241 offset:128
    v_mfma_f32_16x16x32_bf16 v[36:39], v[176:179], v[164:167], v[36:39]
    ds_read_b64_tr_b16 v[190:191], v241 offset:1664
    s_waitcnt lgkmcnt(4)
    v_mfma_f32_16x16x32_bf16 v[40:43], v[180:183], v[160:163], v[40:43]
    ds_read_b64_tr_b16 v[176:177], v238 offset:256
    s_add_u32 m0, s69, 75520
    s_add_u32 s58, s57, 24576
    buffer_load_dwordx4 v244, s[32:35], s56 offen lds
    v_mfma_f32_16x16x32_bf16 v[44:47], v[180:183], v[164:167], v[44:47]
    ds_read_b64_tr_b16 v[178:179], v238 offset:1792
    s_waitcnt lgkmcnt(4)
    v_mfma_f32_16x16x32_bf16 v[48:51], v[184:187], v[160:163], v[48:51]
    ds_read_b64_tr_b16 v[180:181], v239 offset:256
    v_mfma_f32_16x16x32_bf16 v[52:55], v[184:187], v[164:167], v[52:55]
    ds_read_b64_tr_b16 v[182:183], v239 offset:1792
    s_waitcnt lgkmcnt(4)
    v_mfma_f32_16x16x32_bf16 v[56:59], v[188:191], v[160:163], v[56:59]
    ds_read_b64_tr_b16 v[184:185], v240 offset:256
    buffer_load_dwordx4 v[144:147], v248, s[28:31], s64 offen offset:0 sc1
    v_mfma_f32_16x16x32_bf16 v[60:63], v[188:191], v[164:167], v[60:63]
    ds_read_b64_tr_b16 v[186:187], v240 offset:1792
    s_waitcnt lgkmcnt(4)
    v_mfma_f32_16x16x32_bf16 v[64:67], v[176:179], v[160:163], v[64:67]
    ds_read_b64_tr_b16 v[188:189], v241 offset:256
    v_mfma_f32_16x16x32_bf16 v[68:71], v[176:179], v[164:167], v[68:71]
    ds_read_b64_tr_b16 v[190:191], v241 offset:1792
    s_waitcnt lgkmcnt(4)
    v_mfma_f32_16x16x32_bf16 v[72:75], v[180:183], v[160:163], v[72:75]
    ds_read_b64_tr_b16 v[176:177], v242 offset:0
    v_mfma_f32_16x16x32_bf16 v[76:79], v[180:183], v[164:167], v[76:79]
    ds_read_b64_tr_b16 v[178:179], v242 offset:384
    s_waitcnt lgkmcnt(4)
    v_mfma_f32_16x16x32_bf16 v[80:83], v[184:187], v[160:163], v[80:83]
    ds_read_b64_tr_b16 v[180:181], v242 offset:32
    s_add_u32 m0, s69, 76544
    s_add_u32 s55, s55, 1
    buffer_load_dwordx4 v245, s[32:35], s56 offen lds
    v_mfma_f32_16x16x32_bf16 v[84:87], v[184:187], v[164:167], v[84:87]
    ds_read_b64_tr_b16 v[182:183], v242 offset:416
    s_waitcnt lgkmcnt(4)
    v_mfma_f32_16x16x32_bf16 v[88:91], v[188:191], v[160:163], v[88:91]
    ds_read_b64_tr_b16 v[184:185], v242 offset:64
    v_mfma_f32_16x16x32_bf16 v[92:95], v[188:191], v[164:167], v[92:95]
    ds_read_b64_tr_b16 v[186:187], v242 offset:448
    s_waitcnt lgkmcnt(4)
    v_mfma_f32_16x16x32_bf16 v[96:99], v[176:179], v[160:163], v[96:99]
    ds_read_b64_tr_b16 v[188:189], v242 offset:768
    v_mfma_f32_16x16x32_bf16 v[100:103], v[176:179], v[164:167], v[100:103]
    ds_read_b64_tr_b16 v[190:191], v242 offset:1152
    buffer_load_dwordx4 v[148:151], v248, s[28:31], s65 offen offset:0 sc1
    s_waitcnt lgkmcnt(4)
    v_mfma_f32_16x16x32_bf16 v[104:107], v[180:183], v[160:163], v[104:107]
    ds_read_b64_tr_b16 v[176:177], v242 offset:800
    v_mfma_f32_16x16x32_bf16 v[108:111], v[180:183], v[164:167], v[108:111]
    ds_read_b64_tr_b16 v[178:179], v242 offset:1184
    s_waitcnt lgkmcnt(4)
    v_mfma_f32_16x16x32_bf16 v[112:115], v[184:187], v[160:163], v[112:115]
    ds_read_b64_tr_b16 v[180:181], v242 offset:832
    v_mfma_f32_16x16x32_bf16 v[116:119], v[184:187], v[164:167], v[116:119]
    ds_read_b64_tr_b16 v[182:183], v242 offset:1216
    s_waitcnt lgkmcnt(4)
    v_mfma_f32_16x16x32_bf16 v[120:123], v[188:191], v[160:163], v[120:123]
    ds_read_b64_tr_b16 v[184:185], v238 offset:12288
    v_mfma_f32_16x16x32_bf16 v[124:127], v[188:191], v[164:167], v[124:127]
    ds_read_b64_tr_b16 v[186:187], v238 offset:13824
    s_add_u32 m0, s69, 77568
    s_cmp_eq_u32 s55, 10
    buffer_load_dwordx4 v246, s[32:35], s56 offen lds
    s_cselect_b32 s55, 1, s55
    s_waitcnt lgkmcnt(4)
    v_mfma_f32_16x16x32_bf16 v[128:131], v[176:179], v[160:163], v[128:131]
    ds_read_b64_tr_b16 v[188:189], v239 offset:12288
    v_mfma_f32_16x16x32_bf16 v[132:135], v[176:179], v[164:167], v[132:135]
    ds_read_b64_tr_b16 v[190:191], v239 offset:13824
    s_waitcnt lgkmcnt(4)
    v_mfma_f32_16x16x32_bf16 v[136:139], v[180:183], v[160:163], v[136:139]
    ds_read_b64_tr_b16 v[176:177], v240 offset:12288
    v_mfma_f32_16x16x32_bf16 v[140:143], v[180:183], v[164:167], v[140:143]
    ds_read_b64_tr_b16 v[178:179], v240 offset:13824
    s_waitcnt lgkmcnt(4)
    v_mfma_f32_16x16x32_bf16 v[0:3], v[184:187], v[168:171], v[0:3]
    ds_read_b64_tr_b16 v[180:181], v241 offset:12288
    v_mfma_f32_16x16x32_bf16 v[4:7], v[184:187], v[172:175], v[4:7]
    ds_read_b64_tr_b16 v[182:183], v241 offset:13824
    buffer_load_dwordx4 v[152:155], v248, s[28:31], s64 offen offset:1024 sc1
    s_waitcnt lgkmcnt(4)
    v_mfma_f32_16x16x32_bf16 v[8:11], v[188:191], v[168:171], v[8:11]
    ds_read_b64_tr_b16 v[184:185], v238 offset:12416
    v_mfma_f32_16x16x32_bf16 v[12:15], v[188:191], v[172:175], v[12:15]
    ds_read_b64_tr_b16 v[186:187], v238 offset:13952
    s_waitcnt lgkmcnt(4)
    v_mfma_f32_16x16x32_bf16 v[16:19], v[176:179], v[168:171], v[16:19]
    ds_read_b64_tr_b16 v[188:189], v239 offset:12416
    v_mfma_f32_16x16x32_bf16 v[20:23], v[176:179], v[172:175], v[20:23]
    ds_read_b64_tr_b16 v[190:191], v239 offset:13952
    s_add_u32 m0, s59, 75520
    s_mov_b64 exec, s[62:63]
    buffer_load_dwordx4 v243, s[36:39], s57 offen lds
    s_mov_b64 exec, -1
    s_waitcnt lgkmcnt(4)
    v_mfma_f32_16x16x32_bf16 v[24:27], v[180:183], v[168:171], v[24:27]
    ds_read_b64_tr_b16 v[176:177], v240 offset:12416
    v_mfma_f32_16x16x32_bf16 v[28:31], v[180:183], v[172:175], v[28:31]
    ds_read_b64_tr_b16 v[178:179], v240 offset:13952
    s_waitcnt lgkmcnt(4)
    v_mfma_f32_16x16x32_bf16 v[32:35], v[184:187], v[168:171], v[32:35]
    ds_read_b64_tr_b16 v[180:181], v241 offset:12416
    v_mfma_f32_16x16x32_bf16 v[36:39], v[184:187], v[172:175], v[36:39]
    ds_read_b64_tr_b16 v[182:183], v241 offset:13952
    s_waitcnt lgkmcnt(4)
    v_mfma_f32_16x16x32_bf16 v[40:43], v[188:191], v[168:171], v[40:43]
    ds_read_b64_tr_b16 v[184:185], v238 offset:12544
    v_mfma_f32_16x16x32_bf16 v[44:47], v[188:191], v[172:175], v[44:47]
    ds_read_b64_tr_b16 v[186:187], v238 offset:14080
    s_waitcnt lgkmcnt(4)
    v_mfma_f32_16x16x32_bf16 v[48:51], v[176:179], v[168:171], v[48:51]
    ds_read_b64_tr_b16 v[188:189], v239 offset:12544
    buffer_load_dwordx4 v[156:159], v248, s[28:31], s65 offen offset:1024 sc1
    v_mfma_f32_16x16x32_bf16 v[52:55], v[176:179], v[172:175], v[52:55]
    ds_read_b64_tr_b16 v[190:191], v239 offset:14080
    s_waitcnt lgkmcnt(4)
    v_mfma_f32_16x16x32_bf16 v[56:59], v[180:183], v[168:171], v[56:59]
    ds_read_b64_tr_b16 v[176:177], v240 offset:12544
    v_mfma_f32_16x16x32_bf16 v[60:63], v[180:183], v[172:175], v[60:63]
    ds_read_b64_tr_b16 v[178:179], v240 offset:14080
    s_add_u32 m0, s59, 77184
    s_mov_b64 exec, s[62:63]
    buffer_load_dwordx4 v243, s[36:39], s58 offen lds
    s_mov_b64 exec, -1
    s_waitcnt lgkmcnt(4)
    v_mfma_f32_16x16x32_bf16 v[64:67], v[184:187], v[168:171], v[64:67]
    ds_read_b64_tr_b16 v[180:181], v241 offset:12544
    v_mfma_f32_16x16x32_bf16 v[68:71], v[184:187], v[172:175], v[68:71]
    ds_read_b64_tr_b16 v[182:183], v241 offset:14080
    s_waitcnt lgkmcnt(4)
    v_mfma_f32_16x16x32_bf16 v[72:75], v[188:191], v[168:171], v[72:75]
    ds_read_b64_tr_b16 v[184:185], v242 offset:6656
    v_mfma_f32_16x16x32_bf16 v[76:79], v[188:191], v[172:175], v[76:79]
    ds_read_b64_tr_b16 v[186:187], v242 offset:7040
    s_waitcnt lgkmcnt(4)
    v_mfma_f32_16x16x32_bf16 v[80:83], v[176:179], v[168:171], v[80:83]
    ds_read_b64_tr_b16 v[188:189], v242 offset:6688
    v_mfma_f32_16x16x32_bf16 v[84:87], v[176:179], v[172:175], v[84:87]
    ds_read_b64_tr_b16 v[190:191], v242 offset:7072
    s_waitcnt lgkmcnt(4)
    v_mfma_f32_16x16x32_bf16 v[88:91], v[180:183], v[168:171], v[88:91]
    ds_read_b64_tr_b16 v[176:177], v242 offset:6720
    v_mfma_f32_16x16x32_bf16 v[92:95], v[180:183], v[172:175], v[92:95]
    ds_read_b64_tr_b16 v[178:179], v242 offset:7104
    s_waitcnt lgkmcnt(4)
    v_mfma_f32_16x16x32_bf16 v[96:99], v[184:187], v[168:171], v[96:99]
    ds_read_b64_tr_b16 v[180:181], v242 offset:7424
    v_mfma_f32_16x16x32_bf16 v[100:103], v[184:187], v[172:175], v[100:103]
    ds_read_b64_tr_b16 v[182:183], v242 offset:7808
    s_waitcnt lgkmcnt(4)
    v_mfma_f32_16x16x32_bf16 v[104:107], v[188:191], v[168:171], v[104:107]
    ds_read_b64_tr_b16 v[184:185], v242 offset:7456
    v_mfma_f32_16x16x32_bf16 v[108:111], v[188:191], v[172:175], v[108:111]
    ds_read_b64_tr_b16 v[186:187], v242 offset:7840
    s_add_u32 m0, s69, 116736
    s_nop 0
    buffer_load_dwordx4 v251, s[40:43], s74 offen lds
    s_waitcnt lgkmcnt(4)
    v_mfma_f32_16x16x32_bf16 v[112:115], v[176:179], v[168:171], v[112:115]
    ds_read_b64_tr_b16 v[188:189], v242 offset:7488
    v_mfma_f32_16x16x32_bf16 v[116:119], v[176:179], v[172:175], v[116:119]
    ds_read_b64_tr_b16 v[190:191], v242 offset:7872
    s_waitcnt vmcnt(11)
    s_waitcnt lgkmcnt(0)
    s_barrier
    v_mfma_f32_16x16x32_bf16 v[120:123], v[180:183], v[168:171], v[120:123]
    ds_read_b64_tr_b16 v[176:177], v238 offset:37760
    v_mfma_f32_16x16x32_bf16 v[124:127], v[180:183], v[172:175], v[124:127]
    ds_read_b64_tr_b16 v[178:179], v238 offset:39296
    v_mfma_f32_16x16x32_bf16 v[128:131], v[184:187], v[168:171], v[128:131]
    ds_read_b64_tr_b16 v[180:181], v239 offset:37760
    v_mfma_f32_16x16x32_bf16 v[132:135], v[184:187], v[172:175], v[132:135]
    ds_read_b64_tr_b16 v[182:183], v239 offset:39296
    v_mfma_f32_16x16x32_bf16 v[136:139], v[188:191], v[168:171], v[136:139]
    ds_read_b64_tr_b16 v[184:185], v240 offset:37760
    v_mfma_f32_16x16x32_bf16 v[140:143], v[188:191], v[172:175], v[140:143]
    ds_read_b64_tr_b16 v[186:187], v240 offset:39296
    s_waitcnt lgkmcnt(4)
    v_mfma_f32_16x16x32_bf16 v[0:3], v[176:179], v[192:195], v[0:3]
    ds_read_b64_tr_b16 v[188:189], v241 offset:37760
    s_mul_i32 s56, s55, 786432
    s_mul_i32 s57, s55, 196608
    v_mfma_f32_16x16x32_bf16 v[4:7], v[176:179], v[196:199], v[4:7]
    ds_read_b64_tr_b16 v[190:191], v241 offset:39296
    s_waitcnt lgkmcnt(4)
    v_mfma_f32_16x16x32_bf16 v[8:11], v[180:183], v[192:195], v[8:11]
    ds_read_b64_tr_b16 v[176:177], v238 offset:37888
    v_mfma_f32_16x16x32_bf16 v[12:15], v[180:183], v[196:199], v[12:15]
    ds_read_b64_tr_b16 v[178:179], v238 offset:39424
    s_lshl_b32 s64, s60, 11
    s_add_u32 s60, s60, 1
    s_add_u32 s65, s64, 20480
    s_cmp_eq_u32 s60, 10
    s_cselect_b32 s60, 1, s60
    s_waitcnt lgkmcnt(4)
    v_mfma_f32_16x16x32_bf16 v[16:19], v[184:187], v[192:195], v[16:19]
    ds_read_b64_tr_b16 v[180:181], v239 offset:37888
    v_mfma_f32_16x16x32_bf16 v[20:23], v[184:187], v[196:199], v[20:23]
    ds_read_b64_tr_b16 v[182:183], v239 offset:39424
    s_waitcnt lgkmcnt(4)
    v_mfma_f32_16x16x32_bf16 v[24:27], v[188:191], v[192:195], v[24:27]
    ds_read_b64_tr_b16 v[184:185], v240 offset:37888
    v_mfma_f32_16x16x32_bf16 v[28:31], v[188:191], v[196:199], v[28:31]
    ds_read_b64_tr_b16 v[186:187], v240 offset:39424
    s_waitcnt lgkmcnt(4)
    v_mfma_f32_16x16x32_bf16 v[32:35], v[176:179], v[192:195], v[32:35]
    ds_read_b64_tr_b16 v[188:189], v241 offset:37888
    v_mfma_f32_16x16x32_bf16 v[36:39], v[176:179], v[196:199], v[36:39]
    ds_read_b64_tr_b16 v[190:191], v241 offset:39424
    s_waitcnt lgkmcnt(4)
    v_mfma_f32_16x16x32_bf16 v[40:43], v[180:183], v[192:195], v[40:43]
    ds_read_b64_tr_b16 v[176:177], v238 offset:38016
    s_add_u32 m0, s69, 0
    s_add_u32 s58, s57, 24576
    buffer_load_dwordx4 v244, s[32:35], s56 offen lds
    v_mfma_f32_16x16x32_bf16 v[44:47], v[180:183], v[196:199], v[44:47]
    ds_read_b64_tr_b16 v[178:179], v238 offset:39552
    s_waitcnt lgkmcnt(4)
    v_mfma_f32_16x16x32_bf16 v[48:51], v[184:187], v[192:195], v[48:51]
    ds_read_b64_tr_b16 v[180:181], v239 offset:38016
    v_mfma_f32_16x16x32_bf16 v[52:55], v[184:187], v[196:199], v[52:55]
    ds_read_b64_tr_b16 v[182:183], v239 offset:39552
    s_waitcnt lgkmcnt(4)
    v_mfma_f32_16x16x32_bf16 v[56:59], v[188:191], v[192:195], v[56:59]
    ds_read_b64_tr_b16 v[184:185], v240 offset:38016
    buffer_load_dwordx4 v[160:163], v248, s[28:31], s64 offen offset:0 sc1
    v_mfma_f32_16x16x32_bf16 v[60:63], v[188:191], v[196:199], v[60:63]
    ds_read_b64_tr_b16 v[186:187], v240 offset:39552
    s_waitcnt lgkmcnt(4)
    v_mfma_f32_16x16x32_bf16 v[64:67], v[176:179], v[192:195], v[64:67]
    ds_read_b64_tr_b16 v[188:189], v241 offset:38016
    v_mfma_f32_16x16x32_bf16 v[68:71], v[176:179], v[196:199], v[68:71]
    ds_read_b64_tr_b16 v[190:191], v241 offset:39552
    s_waitcnt lgkmcnt(4)
    v_mfma_f32_16x16x32_bf16 v[72:75], v[180:183], v[192:195], v[72:75]
    ds_read_b64_tr_b16 v[176:177], v242 offset:37760
    v_mfma_f32_16x16x32_bf16 v[76:79], v[180:183], v[196:199], v[76:79]
    ds_read_b64_tr_b16 v[178:179], v242 offset:38144
    s_waitcnt lgkmcnt(4)
    v_mfma_f32_16x16x32_bf16 v[80:83], v[184:187], v[192:195], v[80:83]
    ds_read_b64_tr_b16 v[180:181], v242 offset:37792
    s_add_u32 m0, s69, 1024
    s_add_u32 s55, s55, 1
    buffer_load_dwordx4 v245, s[32:35], s56 offen lds
    v_mfma_f32_16x16x32_bf16 v[84:87], v[184:187], v[196:199], v[84:87]
    ds_read_b64_tr_b16 v[182:183], v242 offset:38176
    s_waitcnt lgkmcnt(4)
    v_mfma_f32_16x16x32_bf16 v[88:91], v[188:191], v[192:195], v[88:91]
    ds_read_b64_tr_b16 v[184:185], v242 offset:37824
    v_mfma_f32_16x16x32_bf16 v[92:95], v[188:191], v[196:199], v[92:95]
    ds_read_b64_tr_b16 v[186:187], v242 offset:38208
    s_waitcnt lgkmcnt(4)
    v_mfma_f32_16x16x32_bf16 v[96:99], v[176:179], v[192:195], v[96:99]
    ds_read_b64_tr_b16 v[188:189], v242 offset:38528
    v_mfma_f32_16x16x32_bf16 v[100:103], v[176:179], v[196:199], v[100:103]
    ds_read_b64_tr_b16 v[190:191], v242 offset:38912
    buffer_load_dwordx4 v[164:167], v248, s[28:31], s65 offen offset:0 sc1
    s_waitcnt lgkmcnt(4)
    v_mfma_f32_16x16x32_bf16 v[104:107], v[180:183], v[192:195], v[104:107]
    ds_read_b64_tr_b16 v[176:177], v242 offset:38560
    v_mfma_f32_16x16x32_bf16 v[108:111], v[180:183], v[196:199], v[108:111]
    ds_read_b64_tr_b16 v[178:179], v242 offset:38944
    s_waitcnt lgkmcnt(4)
    v_mfma_f32_16x16x32_bf16 v[112:115], v[184:187], v[192:195], v[112:115]
    ds_read_b64_tr_b16 v[180:181], v242 offset:38592
    v_mfma_f32_16x16x32_bf16 v[116:119], v[184:187], v[196:199], v[116:119]
    ds_read_b64_tr_b16 v[182:183], v242 offset:38976
    s_waitcnt lgkmcnt(4)
    v_mfma_f32_16x16x32_bf16 v[120:123], v[188:191], v[192:195], v[120:123]
    ds_read_b64_tr_b16 v[184:185], v238 offset:50048
    v_mfma_f32_16x16x32_bf16 v[124:127], v[188:191], v[196:199], v[124:127]
    ds_read_b64_tr_b16 v[186:187], v238 offset:51584
    s_add_u32 m0, s69, 2048
    s_cmp_eq_u32 s55, 10
    buffer_load_dwordx4 v246, s[32:35], s56 offen lds
    s_cselect_b32 s55, 1, s55
    s_waitcnt lgkmcnt(4)
    v_mfma_f32_16x16x32_bf16 v[128:131], v[176:179], v[192:195], v[128:131]
    ds_read_b64_tr_b16 v[188:189], v239 offset:50048
    v_mfma_f32_16x16x32_bf16 v[132:135], v[176:179], v[196:199], v[132:135]
    ds_read_b64_tr_b16 v[190:191], v239 offset:51584
    s_waitcnt lgkmcnt(4)
    v_mfma_f32_16x16x32_bf16 v[136:139], v[180:183], v[192:195], v[136:139]
    ds_read_b64_tr_b16 v[176:177], v240 offset:50048
    v_mfma_f32_16x16x32_bf16 v[140:143], v[180:183], v[196:199], v[140:143]
    ds_read_b64_tr_b16 v[178:179], v240 offset:51584
    s_waitcnt lgkmcnt(4)
    v_mfma_f32_16x16x32_bf16 v[0:3], v[184:187], v[200:203], v[0:3]
    ds_read_b64_tr_b16 v[180:181], v241 offset:50048
    v_mfma_f32_16x16x32_bf16 v[4:7], v[184:187], v[204:207], v[4:7]
    ds_read_b64_tr_b16 v[182:183], v241 offset:51584
    buffer_load_dwordx4 v[168:171], v248, s[28:31], s64 offen offset:1024 sc1
    s_waitcnt lgkmcnt(4)
    v_mfma_f32_16x16x32_bf16 v[8:11], v[188:191], v[200:203], v[8:11]
    ds_read_b64_tr_b16 v[184:185], v238 offset:50176
    v_mfma_f32_16x16x32_bf16 v[12:15], v[188:191], v[204:207], v[12:15]
    ds_read_b64_tr_b16 v[186:187], v238 offset:51712
    s_waitcnt lgkmcnt(4)
    v_mfma_f32_16x16x32_bf16 v[16:19], v[176:179], v[200:203], v[16:19]
    ds_read_b64_tr_b16 v[188:189], v239 offset:50176
    v_mfma_f32_16x16x32_bf16 v[20:23], v[176:179], v[204:207], v[20:23]
    ds_read_b64_tr_b16 v[190:191], v239 offset:51712
    s_add_u32 m0, s59, 0
    s_mov_b64 exec, s[62:63]
    buffer_load_dwordx4 v243, s[36:39], s57 offen lds
    s_mov_b64 exec, -1
    s_waitcnt lgkmcnt(4)
    v_mfma_f32_16x16x32_bf16 v[24:27], v[180:183], v[200:203], v[24:27]
    ds_read_b64_tr_b16 v[176:177], v240 offset:50176
    v_mfma_f32_16x16x32_bf16 v[28:31], v[180:183], v[204:207], v[28:31]
    ds_read_b64_tr_b16 v[178:179], v240 offset:51712
    s_waitcnt lgkmcnt(4)
    v_mfma_f32_16x16x32_bf16 v[32:35], v[184:187], v[200:203], v[32:35]
    ds_read_b64_tr_b16 v[180:181], v241 offset:50176
    v_mfma_f32_16x16x32_bf16 v[36:39], v[184:187], v[204:207], v[36:39]
    ds_read_b64_tr_b16 v[182:183], v241 offset:51712
    s_waitcnt lgkmcnt(4)
    v_mfma_f32_16x16x32_bf16 v[40:43], v[188:191], v[200:203], v[40:43]
    ds_read_b64_tr_b16 v[184:185], v238 offset:50304
    v_mfma_f32_16x16x32_bf16 v[44:47], v[188:191], v[204:207], v[44:47]
    ds_read_b64_tr_b16 v[186:187], v238 offset:51840
    s_waitcnt lgkmcnt(4)
    v_mfma_f32_16x16x32_bf16 v[48:51], v[176:179], v[200:203], v[48:51]
    ds_read_b64_tr_b16 v[188:189], v239 offset:50304
    buffer_load_dwordx4 v[172:175], v248, s[28:31], s65 offen offset:1024 sc1
    v_mfma_f32_16x16x32_bf16 v[52:55], v[176:179], v[204:207], v[52:55]
    ds_read_b64_tr_b16 v[190:191], v239 offset:51840
    s_waitcnt lgkmcnt(4)
    v_mfma_f32_16x16x32_bf16 v[56:59], v[180:183], v[200:203], v[56:59]
    ds_read_b64_tr_b16 v[176:177], v240 offset:50304
    v_mfma_f32_16x16x32_bf16 v[60:63], v[180:183], v[204:207], v[60:63]
    ds_read_b64_tr_b16 v[178:179], v240 offset:51840
    s_add_u32 m0, s59, 1664
    s_mov_b64 exec, s[62:63]
    buffer_load_dwordx4 v243, s[36:39], s58 offen lds
    s_mov_b64 exec, -1
    s_waitcnt lgkmcnt(4)
    v_mfma_f32_16x16x32_bf16 v[64:67], v[184:187], v[200:203], v[64:67]
    ds_read_b64_tr_b16 v[180:181], v241 offset:50304
    v_mfma_f32_16x16x32_bf16 v[68:71], v[184:187], v[204:207], v[68:71]
    ds_read_b64_tr_b16 v[182:183], v241 offset:51840
    s_waitcnt lgkmcnt(4)
    v_mfma_f32_16x16x32_bf16 v[72:75], v[188:191], v[200:203], v[72:75]
    ds_read_b64_tr_b16 v[184:185], v242 offset:44416
    v_mfma_f32_16x16x32_bf16 v[76:79], v[188:191], v[204:207], v[76:79]
    ds_read_b64_tr_b16 v[186:187], v242 offset:44800
    s_waitcnt lgkmcnt(4)
    v_mfma_f32_16x16x32_bf16 v[80:83], v[176:179], v[200:203], v[80:83]
    ds_read_b64_tr_b16 v[188:189], v242 offset:44448
    v_mfma_f32_16x16x32_bf16 v[84:87], v[176:179], v[204:207], v[84:87]
    ds_read_b64_tr_b16 v[190:191], v242 offset:44832
    s_waitcnt lgkmcnt(4)
    v_mfma_f32_16x16x32_bf16 v[88:91], v[180:183], v[200:203], v[88:91]
    ds_read_b64_tr_b16 v[176:177], v242 offset:44480
    v_mfma_f32_16x16x32_bf16 v[92:95], v[180:183], v[204:207], v[92:95]
    ds_read_b64_tr_b16 v[178:179], v242 offset:44864
    s_waitcnt lgkmcnt(4)
    v_mfma_f32_16x16x32_bf16 v[96:99], v[184:187], v[200:203], v[96:99]
    ds_read_b64_tr_b16 v[180:181], v242 offset:45184
    v_mfma_f32_16x16x32_bf16 v[100:103], v[184:187], v[204:207], v[100:103]
    ds_read_b64_tr_b16 v[182:183], v242 offset:45568
    s_waitcnt lgkmcnt(4)
    v_mfma_f32_16x16x32_bf16 v[104:107], v[188:191], v[200:203], v[104:107]
    ds_read_b64_tr_b16 v[184:185], v242 offset:45216
    v_mfma_f32_16x16x32_bf16 v[108:111], v[188:191], v[204:207], v[108:111]
    ds_read_b64_tr_b16 v[186:187], v242 offset:45600
    s_add_u32 s75, s54, 0
    s_and_b32 s75, s75, 7
    s_mul_i32 s75, s75, 24576
    s_waitcnt lgkmcnt(4)
    v_mfma_f32_16x16x32_bf16 v[112:115], v[176:179], v[200:203], v[112:115]
    ds_read_b64_tr_b16 v[188:189], v242 offset:45248
    s_add_u32 m0, s69, 139264
    s_nop 0
    buffer_load_dwordx4 v252, s[44:47], s75 offen lds
    v_mfma_f32_16x16x32_bf16 v[116:119], v[176:179], v[204:207], v[116:119]
    ds_read_b64_tr_b16 v[190:191], v242 offset:45632
    s_waitcnt vmcnt(11)
    s_waitcnt lgkmcnt(0)
    s_barrier
    v_add_u32 v238, 75520, v238
    v_add_u32 v239, 75520, v239
    v_add_u32 v240, 75520, v240
    v_add_u32 v241, 75520, v241
    v_add_u32 v242, 75520, v242
    v_mfma_f32_16x16x32_bf16 v[120:123], v[180:183], v[200:203], v[120:123]
    ds_read_b64_tr_b16 v[176:177], v238 offset:0
    v_mfma_f32_16x16x32_bf16 v[124:127], v[180:183], v[204:207], v[124:127]
    ds_read_b64_tr_b16 v[178:179], v238 offset:1536
    v_mfma_f32_16x16x32_bf16 v[128:131], v[184:187], v[200:203], v[128:131]
    ds_read_b64_tr_b16 v[180:181], v239 offset:0
    v_mfma_f32_16x16x32_bf16 v[132:135], v[184:187], v[204:207], v[132:135]
    ds_read_b64_tr_b16 v[182:183], v239 offset:1536
    v_mfma_f32_16x16x32_bf16 v[136:139], v[188:191], v[200:203], v[136:139]
    ds_read_b64_tr_b16 v[184:185], v240 offset:0
    v_mfma_f32_16x16x32_bf16 v[140:143], v[188:191], v[204:207], v[140:143]
    ds_read_b64_tr_b16 v[186:187], v240 offset:1536
    s_waitcnt lgkmcnt(4)
    v_mfma_f32_16x16x32_bf16 v[0:3], v[176:179], v[144:147], v[0:3]
    ds_read_b64_tr_b16 v[188:189], v241 offset:0
    s_mul_i32 s56, s55, 786432
    s_mul_i32 s57, s55, 196608
    v_mfma_f32_16x16x32_bf16 v[4:7], v[176:179], v[148:151], v[4:7]
    ds_read_b64_tr_b16 v[190:191], v241 offset:1536
    s_waitcnt lgkmcnt(4)
    v_mfma_f32_16x16x32_bf16 v[8:11], v[180:183], v[144:147], v[8:11]
    ds_read_b64_tr_b16 v[176:177], v238 offset:128
    v_mfma_f32_16x16x32_bf16 v[12:15], v[180:183], v[148:151], v[12:15]
    ds_read_b64_tr_b16 v[178:179], v238 offset:1664
    s_lshl_b32 s64, s60, 11
    s_add_u32 s60, s60, 1
    s_add_u32 s65, s64, 20480
    s_cmp_eq_u32 s60, 10
    s_cselect_b32 s60, 1, s60
    s_waitcnt lgkmcnt(4)
    v_mfma_f32_16x16x32_bf16 v[16:19], v[184:187], v[144:147], v[16:19]
    ds_read_b64_tr_b16 v[180:181], v239 offset:128
    v_mfma_f32_16x16x32_bf16 v[20:23], v[184:187], v[148:151], v[20:23]
    ds_read_b64_tr_b16 v[182:183], v239 offset:1664
    s_waitcnt lgkmcnt(4)
    v_mfma_f32_16x16x32_bf16 v[24:27], v[188:191], v[144:147], v[24:27]
    ds_read_b64_tr_b16 v[184:185], v240 offset:128
    v_mfma_f32_16x16x32_bf16 v[28:31], v[188:191], v[148:151], v[28:31]
    ds_read_b64_tr_b16 v[186:187], v240 offset:1664
    s_waitcnt lgkmcnt(4)
    v_mfma_f32_16x16x32_bf16 v[32:35], v[176:179], v[144:147], v[32:35]
    ds_read_b64_tr_b16 v[188:189], v241 offset:128
    v_mfma_f32_16x16x32_bf16 v[36:39], v[176:179], v[148:151], v[36:39]
    ds_read_b64_tr_b16 v[190:191], v241 offset:1664
    s_waitcnt lgkmcnt(4)
    v_mfma_f32_16x16x32_bf16 v[40:43], v[180:183], v[144:147], v[40:43]
    ds_read_b64_tr_b16 v[176:177], v238 offset:256
    s_add_u32 m0, s69, 37760
    s_add_u32 s58, s57, 24576
    buffer_load_dwordx4 v244, s[32:35], s56 offen lds
    v_mfma_f32_16x16x32_bf16 v[44:47], v[180:183], v[148:151], v[44:47]
    ds_read_b64_tr_b16 v[178:179], v238 offset:1792
    s_waitcnt lgkmcnt(4)
    v_mfma_f32_16x16x32_bf16 v[48:51], v[184:187], v[144:147], v[48:51]
    ds_read_b64_tr_b16 v[180:181], v239 offset:256
    v_mfma_f32_16x16x32_bf16 v[52:55], v[184:187], v[148:151], v[52:55]
    ds_read_b64_tr_b16 v[182:183], v239 offset:1792
    s_waitcnt lgkmcnt(4)
    v_mfma_f32_16x16x32_bf16 v[56:59], v[188:191], v[144:147], v[56:59]
    ds_read_b64_tr_b16 v[184:185], v240 offset:256
    buffer_load_dwordx4 v[192:195], v248, s[28:31], s64 offen offset:0 sc1
    v_mfma_f32_16x16x32_bf16 v[60:63], v[188:191], v[148:151], v[60:63]
    ds_read_b64_tr_b16 v[186:187], v240 offset:1792
    s_waitcnt lgkmcnt(4)
    v_mfma_f32_16x16x32_bf16 v[64:67], v[176:179], v[144:147], v[64:67]
    ds_read_b64_tr_b16 v[188:189], v241 offset:256
    v_mfma_f32_16x16x32_bf16 v[68:71], v[176:179], v[148:151], v[68:71]
    ds_read_b64_tr_b16 v[190:191], v241 offset:1792
    s_waitcnt lgkmcnt(4)
    v_mfma_f32_16x16x32_bf16 v[72:75], v[180:183], v[144:147], v[72:75]
    ds_read_b64_tr_b16 v[176:177], v242 offset:0
    v_mfma_f32_16x16x32_bf16 v[76:79], v[180:183], v[148:151], v[76:79]
    ds_read_b64_tr_b16 v[178:179], v242 offset:384
    s_waitcnt lgkmcnt(4)
    v_mfma_f32_16x16x32_bf16 v[80:83], v[184:187], v[144:147], v[80:83]
    ds_read_b64_tr_b16 v[180:181], v242 offset:32
    s_add_u32 m0, s69, 38784
    s_add_u32 s55, s55, 1
    buffer_load_dwordx4 v245, s[32:35], s56 offen lds
    v_mfma_f32_16x16x32_bf16 v[84:87], v[184:187], v[148:151], v[84:87]
    ds_read_b64_tr_b16 v[182:183], v242 offset:416
    s_waitcnt lgkmcnt(4)
    v_mfma_f32_16x16x32_bf16 v[88:91], v[188:191], v[144:147], v[88:91]
    ds_read_b64_tr_b16 v[184:185], v242 offset:64
    v_mfma_f32_16x16x32_bf16 v[92:95], v[188:191], v[148:151], v[92:95]
    ds_read_b64_tr_b16 v[186:187], v242 offset:448
    s_waitcnt lgkmcnt(4)
    v_mfma_f32_16x16x32_bf16 v[96:99], v[176:179], v[144:147], v[96:99]
    ds_read_b64_tr_b16 v[188:189], v242 offset:768
    v_mfma_f32_16x16x32_bf16 v[100:103], v[176:179], v[148:151], v[100:103]
    ds_read_b64_tr_b16 v[190:191], v242 offset:1152
    buffer_load_dwordx4 v[196:199], v248, s[28:31], s65 offen offset:0 sc1
    s_waitcnt lgkmcnt(4)
    v_mfma_f32_16x16x32_bf16 v[104:107], v[180:183], v[144:147], v[104:107]
    ds_read_b64_tr_b16 v[176:177], v242 offset:800
    v_mfma_f32_16x16x32_bf16 v[108:111], v[180:183], v[148:151], v[108:111]
    ds_read_b64_tr_b16 v[178:179], v242 offset:1184
    s_waitcnt lgkmcnt(4)
    v_mfma_f32_16x16x32_bf16 v[112:115], v[184:187], v[144:147], v[112:115]
    ds_read_b64_tr_b16 v[180:181], v242 offset:832
    v_mfma_f32_16x16x32_bf16 v[116:119], v[184:187], v[148:151], v[116:119]
    ds_read_b64_tr_b16 v[182:183], v242 offset:1216
    s_waitcnt lgkmcnt(4)
    v_mfma_f32_16x16x32_bf16 v[120:123], v[188:191], v[144:147], v[120:123]
    ds_read_b64_tr_b16 v[184:185], v238 offset:12288
    v_mfma_f32_16x16x32_bf16 v[124:127], v[188:191], v[148:151], v[124:127]
    ds_read_b64_tr_b16 v[186:187], v238 offset:13824
    s_add_u32 m0, s69, 39808
    s_cmp_eq_u32 s55, 10
    buffer_load_dwordx4 v246, s[32:35], s56 offen lds
    s_cselect_b32 s55, 1, s55
    s_waitcnt lgkmcnt(4)
    v_mfma_f32_16x16x32_bf16 v[128:131], v[176:179], v[144:147], v[128:131]
    ds_read_b64_tr_b16 v[188:189], v239 offset:12288
    v_mfma_f32_16x16x32_bf16 v[132:135], v[176:179], v[148:151], v[132:135]
    ds_read_b64_tr_b16 v[190:191], v239 offset:13824
    s_waitcnt lgkmcnt(4)
    v_mfma_f32_16x16x32_bf16 v[136:139], v[180:183], v[144:147], v[136:139]
    ds_read_b64_tr_b16 v[176:177], v240 offset:12288
    v_mfma_f32_16x16x32_bf16 v[140:143], v[180:183], v[148:151], v[140:143]
    ds_read_b64_tr_b16 v[178:179], v240 offset:13824
    s_waitcnt lgkmcnt(4)
    v_mfma_f32_16x16x32_bf16 v[0:3], v[184:187], v[152:155], v[0:3]
    ds_read_b64_tr_b16 v[180:181], v241 offset:12288
    v_mfma_f32_16x16x32_bf16 v[4:7], v[184:187], v[156:159], v[4:7]
    ds_read_b64_tr_b16 v[182:183], v241 offset:13824
    buffer_load_dwordx4 v[200:203], v248, s[28:31], s64 offen offset:1024 sc1
    s_waitcnt lgkmcnt(4)
    v_mfma_f32_16x16x32_bf16 v[8:11], v[188:191], v[152:155], v[8:11]
    ds_read_b64_tr_b16 v[184:185], v238 offset:12416
    v_mfma_f32_16x16x32_bf16 v[12:15], v[188:191], v[156:159], v[12:15]
    ds_read_b64_tr_b16 v[186:187], v238 offset:13952
    s_waitcnt lgkmcnt(4)
    v_mfma_f32_16x16x32_bf16 v[16:19], v[176:179], v[152:155], v[16:19]
    ds_read_b64_tr_b16 v[188:189], v239 offset:12416
    v_mfma_f32_16x16x32_bf16 v[20:23], v[176:179], v[156:159], v[20:23]
    ds_read_b64_tr_b16 v[190:191], v239 offset:13952
    s_add_u32 m0, s59, 37760
    s_mov_b64 exec, s[62:63]
    buffer_load_dwordx4 v243, s[36:39], s57 offen lds
    s_mov_b64 exec, -1
    s_waitcnt lgkmcnt(4)
    v_mfma_f32_16x16x32_bf16 v[24:27], v[180:183], v[152:155], v[24:27]
    ds_read_b64_tr_b16 v[176:177], v240 offset:12416
    v_mfma_f32_16x16x32_bf16 v[28:31], v[180:183], v[156:159], v[28:31]
    ds_read_b64_tr_b16 v[178:179], v240 offset:13952
    s_waitcnt lgkmcnt(4)
    v_mfma_f32_16x16x32_bf16 v[32:35], v[184:187], v[152:155], v[32:35]
    ds_read_b64_tr_b16 v[180:181], v241 offset:12416
    v_mfma_f32_16x16x32_bf16 v[36:39], v[184:187], v[156:159], v[36:39]
    ds_read_b64_tr_b16 v[182:183], v241 offset:13952
    s_waitcnt lgkmcnt(4)
    v_mfma_f32_16x16x32_bf16 v[40:43], v[188:191], v[152:155], v[40:43]
    ds_read_b64_tr_b16 v[184:185], v238 offset:12544
    v_mfma_f32_16x16x32_bf16 v[44:47], v[188:191], v[156:159], v[44:47]
    ds_read_b64_tr_b16 v[186:187], v238 offset:14080
    s_waitcnt lgkmcnt(4)
    v_mfma_f32_16x16x32_bf16 v[48:51], v[176:179], v[152:155], v[48:51]
    ds_read_b64_tr_b16 v[188:189], v239 offset:12544
    buffer_load_dwordx4 v[204:207], v248, s[28:31], s65 offen offset:1024 sc1
    v_mfma_f32_16x16x32_bf16 v[52:55], v[176:179], v[156:159], v[52:55]
    ds_read_b64_tr_b16 v[190:191], v239 offset:14080
    s_waitcnt lgkmcnt(4)
    v_mfma_f32_16x16x32_bf16 v[56:59], v[180:183], v[152:155], v[56:59]
    ds_read_b64_tr_b16 v[176:177], v240 offset:12544
    v_mfma_f32_16x16x32_bf16 v[60:63], v[180:183], v[156:159], v[60:63]
    ds_read_b64_tr_b16 v[178:179], v240 offset:14080
    s_add_u32 m0, s59, 39424
    s_mov_b64 exec, s[62:63]
    buffer_load_dwordx4 v243, s[36:39], s58 offen lds
    s_mov_b64 exec, -1
    s_waitcnt lgkmcnt(4)
    v_mfma_f32_16x16x32_bf16 v[64:67], v[184:187], v[152:155], v[64:67]
    ds_read_b64_tr_b16 v[180:181], v241 offset:12544
    v_mfma_f32_16x16x32_bf16 v[68:71], v[184:187], v[156:159], v[68:71]
    ds_read_b64_tr_b16 v[182:183], v241 offset:14080
    s_waitcnt lgkmcnt(4)
    v_mfma_f32_16x16x32_bf16 v[72:75], v[188:191], v[152:155], v[72:75]
    ds_read_b64_tr_b16 v[184:185], v242 offset:6656
    v_mfma_f32_16x16x32_bf16 v[76:79], v[188:191], v[156:159], v[76:79]
    ds_read_b64_tr_b16 v[186:187], v242 offset:7040
    s_waitcnt lgkmcnt(4)
    v_mfma_f32_16x16x32_bf16 v[80:83], v[176:179], v[152:155], v[80:83]
    ds_read_b64_tr_b16 v[188:189], v242 offset:6688
    v_mfma_f32_16x16x32_bf16 v[84:87], v[176:179], v[156:159], v[84:87]
    ds_read_b64_tr_b16 v[190:191], v242 offset:7072
    s_waitcnt lgkmcnt(4)
    v_mfma_f32_16x16x32_bf16 v[88:91], v[180:183], v[152:155], v[88:91]
    ds_read_b64_tr_b16 v[176:177], v242 offset:6720
    v_mfma_f32_16x16x32_bf16 v[92:95], v[180:183], v[156:159], v[92:95]
    ds_read_b64_tr_b16 v[178:179], v242 offset:7104
    s_waitcnt lgkmcnt(4)
    v_mfma_f32_16x16x32_bf16 v[96:99], v[184:187], v[152:155], v[96:99]
    ds_read_b64_tr_b16 v[180:181], v242 offset:7424
    v_mfma_f32_16x16x32_bf16 v[100:103], v[184:187], v[156:159], v[100:103]
    ds_read_b64_tr_b16 v[182:183], v242 offset:7808
    s_waitcnt lgkmcnt(4)
    v_mfma_f32_16x16x32_bf16 v[104:107], v[188:191], v[152:155], v[104:107]
    ds_read_b64_tr_b16 v[184:185], v242 offset:7456
    v_mfma_f32_16x16x32_bf16 v[108:111], v[188:191], v[156:159], v[108:111]
    ds_read_b64_tr_b16 v[186:187], v242 offset:7840
    s_add_u32 m0, s69, 140288
    s_nop 0
    buffer_load_dwordx4 v253, s[44:47], s75 offen lds
    s_waitcnt lgkmcnt(4)
    v_mfma_f32_16x16x32_bf16 v[112:115], v[176:179], v[152:155], v[112:115]
    ds_read_b64_tr_b16 v[188:189], v242 offset:7488
    v_mfma_f32_16x16x32_bf16 v[116:119], v[176:179], v[156:159], v[116:119]
    ds_read_b64_tr_b16 v[190:191], v242 offset:7872
    s_waitcnt vmcnt(11)
    s_waitcnt lgkmcnt(0)
    s_barrier
    v_add_u32 v238, 4294891776, v238
    v_add_u32 v239, 4294891776, v239
    v_add_u32 v240, 4294891776, v240
    v_add_u32 v241, 4294891776, v241
    v_add_u32 v242, 4294891776, v242
    v_mfma_f32_16x16x32_bf16 v[120:123], v[180:183], v[152:155], v[120:123]
    ds_read_b64_tr_b16 v[176:177], v238 offset:0
    v_mfma_f32_16x16x32_bf16 v[124:127], v[180:183], v[156:159], v[124:127]
    ds_read_b64_tr_b16 v[178:179], v238 offset:1536
    v_mfma_f32_16x16x32_bf16 v[128:131], v[184:187], v[152:155], v[128:131]
    ds_read_b64_tr_b16 v[180:181], v239 offset:0
    v_mfma_f32_16x16x32_bf16 v[132:135], v[184:187], v[156:159], v[132:135]
    ds_read_b64_tr_b16 v[182:183], v239 offset:1536
    v_mfma_f32_16x16x32_bf16 v[136:139], v[188:191], v[152:155], v[136:139]
    ds_read_b64_tr_b16 v[184:185], v240 offset:0
    v_mfma_f32_16x16x32_bf16 v[140:143], v[188:191], v[156:159], v[140:143]
    ds_read_b64_tr_b16 v[186:187], v240 offset:1536
    s_waitcnt lgkmcnt(4)
    v_mfma_f32_16x16x32_bf16 v[0:3], v[176:179], v[160:163], v[0:3]
    ds_read_b64_tr_b16 v[188:189], v241 offset:0
    s_mul_i32 s56, s55, 786432
    s_mul_i32 s57, s55, 196608
    v_mfma_f32_16x16x32_bf16 v[4:7], v[176:179], v[164:167], v[4:7]
    ds_read_b64_tr_b16 v[190:191], v241 offset:1536
    s_waitcnt lgkmcnt(4)
    v_mfma_f32_16x16x32_bf16 v[8:11], v[180:183], v[160:163], v[8:11]
    ds_read_b64_tr_b16 v[176:177], v238 offset:128
    v_mfma_f32_16x16x32_bf16 v[12:15], v[180:183], v[164:167], v[12:15]
    ds_read_b64_tr_b16 v[178:179], v238 offset:1664
    s_lshl_b32 s64, s60, 11
    s_add_u32 s60, s60, 1
    s_add_u32 s65, s64, 20480
    s_cmp_eq_u32 s60, 10
    s_cselect_b32 s60, 1, s60
    s_waitcnt lgkmcnt(4)
    v_mfma_f32_16x16x32_bf16 v[16:19], v[184:187], v[160:163], v[16:19]
    ds_read_b64_tr_b16 v[180:181], v239 offset:128
    v_mfma_f32_16x16x32_bf16 v[20:23], v[184:187], v[164:167], v[20:23]
    ds_read_b64_tr_b16 v[182:183], v239 offset:1664
    s_waitcnt lgkmcnt(4)
    v_mfma_f32_16x16x32_bf16 v[24:27], v[188:191], v[160:163], v[24:27]
    ds_read_b64_tr_b16 v[184:185], v240 offset:128
    v_mfma_f32_16x16x32_bf16 v[28:31], v[188:191], v[164:167], v[28:31]
    ds_read_b64_tr_b16 v[186:187], v240 offset:1664
    s_waitcnt lgkmcnt(4)
    v_mfma_f32_16x16x32_bf16 v[32:35], v[176:179], v[160:163], v[32:35]
    ds_read_b64_tr_b16 v[188:189], v241 offset:128
    v_mfma_f32_16x16x32_bf16 v[36:39], v[176:179], v[164:167], v[36:39]
    ds_read_b64_tr_b16 v[190:191], v241 offset:1664
    s_waitcnt lgkmcnt(4)
    v_mfma_f32_16x16x32_bf16 v[40:43], v[180:183], v[160:163], v[40:43]
    ds_read_b64_tr_b16 v[176:177], v238 offset:256
    s_add_u32 m0, s69, 75520
    s_add_u32 s58, s57, 24576
    buffer_load_dwordx4 v244, s[32:35], s56 offen lds
    v_mfma_f32_16x16x32_bf16 v[44:47], v[180:183], v[164:167], v[44:47]
    ds_read_b64_tr_b16 v[178:179], v238 offset:1792
    s_waitcnt lgkmcnt(4)
    v_mfma_f32_16x16x32_bf16 v[48:51], v[184:187], v[160:163], v[48:51]
    ds_read_b64_tr_b16 v[180:181], v239 offset:256
    v_mfma_f32_16x16x32_bf16 v[52:55], v[184:187], v[164:167], v[52:55]
    ds_read_b64_tr_b16 v[182:183], v239 offset:1792
    s_waitcnt lgkmcnt(4)
    v_mfma_f32_16x16x32_bf16 v[56:59], v[188:191], v[160:163], v[56:59]
    ds_read_b64_tr_b16 v[184:185], v240 offset:256
    buffer_load_dwordx4 v[144:147], v248, s[28:31], s64 offen offset:0 sc1
    v_mfma_f32_16x16x32_bf16 v[60:63], v[188:191], v[164:167], v[60:63]
    ds_read_b64_tr_b16 v[186:187], v240 offset:1792
    s_waitcnt lgkmcnt(4)
    v_mfma_f32_16x16x32_bf16 v[64:67], v[176:179], v[160:163], v[64:67]
    ds_read_b64_tr_b16 v[188:189], v241 offset:256
    v_mfma_f32_16x16x32_bf16 v[68:71], v[176:179], v[164:167], v[68:71]
    ds_read_b64_tr_b16 v[190:191], v241 offset:1792
    s_waitcnt lgkmcnt(4)
    v_mfma_f32_16x16x32_bf16 v[72:75], v[180:183], v[160:163], v[72:75]
    ds_read_b64_tr_b16 v[176:177], v242 offset:0
    v_mfma_f32_16x16x32_bf16 v[76:79], v[180:183], v[164:167], v[76:79]
    ds_read_b64_tr_b16 v[178:179], v242 offset:384
    s_waitcnt lgkmcnt(4)
    v_mfma_f32_16x16x32_bf16 v[80:83], v[184:187], v[160:163], v[80:83]
    ds_read_b64_tr_b16 v[180:181], v242 offset:32
    s_add_u32 m0, s69, 76544
    s_add_u32 s55, s55, 1
    buffer_load_dwordx4 v245, s[32:35], s56 offen lds
    v_mfma_f32_16x16x32_bf16 v[84:87], v[184:187], v[164:167], v[84:87]
    ds_read_b64_tr_b16 v[182:183], v242 offset:416
    s_waitcnt lgkmcnt(4)
    v_mfma_f32_16x16x32_bf16 v[88:91], v[188:191], v[160:163], v[88:91]
    ds_read_b64_tr_b16 v[184:185], v242 offset:64
    v_mfma_f32_16x16x32_bf16 v[92:95], v[188:191], v[164:167], v[92:95]
    ds_read_b64_tr_b16 v[186:187], v242 offset:448
    s_waitcnt lgkmcnt(4)
    v_mfma_f32_16x16x32_bf16 v[96:99], v[176:179], v[160:163], v[96:99]
    ds_read_b64_tr_b16 v[188:189], v242 offset:768
    v_mfma_f32_16x16x32_bf16 v[100:103], v[176:179], v[164:167], v[100:103]
    ds_read_b64_tr_b16 v[190:191], v242 offset:1152
    buffer_load_dwordx4 v[148:151], v248, s[28:31], s65 offen offset:0 sc1
    s_waitcnt lgkmcnt(4)
    v_mfma_f32_16x16x32_bf16 v[104:107], v[180:183], v[160:163], v[104:107]
    ds_read_b64_tr_b16 v[176:177], v242 offset:800
    v_mfma_f32_16x16x32_bf16 v[108:111], v[180:183], v[164:167], v[108:111]
    ds_read_b64_tr_b16 v[178:179], v242 offset:1184
    s_waitcnt lgkmcnt(4)
    v_mfma_f32_16x16x32_bf16 v[112:115], v[184:187], v[160:163], v[112:115]
    ds_read_b64_tr_b16 v[180:181], v242 offset:832
    v_mfma_f32_16x16x32_bf16 v[116:119], v[184:187], v[164:167], v[116:119]
    ds_read_b64_tr_b16 v[182:183], v242 offset:1216
    s_waitcnt lgkmcnt(4)
    v_mfma_f32_16x16x32_bf16 v[120:123], v[188:191], v[160:163], v[120:123]
    ds_read_b64_tr_b16 v[184:185], v238 offset:12288
    v_mfma_f32_16x16x32_bf16 v[124:127], v[188:191], v[164:167], v[124:127]
    ds_read_b64_tr_b16 v[186:187], v238 offset:13824
    s_add_u32 m0, s69, 77568
    s_cmp_eq_u32 s55, 10
    buffer_load_dwordx4 v246, s[32:35], s56 offen lds
    s_cselect_b32 s55, 1, s55
    s_waitcnt lgkmcnt(4)
    v_mfma_f32_16x16x32_bf16 v[128:131], v[176:179], v[160:163], v[128:131]
    ds_read_b64_tr_b16 v[188:189], v239 offset:12288
    v_mfma_f32_16x16x32_bf16 v[132:135], v[176:179], v[164:167], v[132:135]
    ds_read_b64_tr_b16 v[190:191], v239 offset:13824
    s_waitcnt lgkmcnt(4)
    v_mfma_f32_16x16x32_bf16 v[136:139], v[180:183], v[160:163], v[136:139]
    ds_read_b64_tr_b16 v[176:177], v240 offset:12288
    v_mfma_f32_16x16x32_bf16 v[140:143], v[180:183], v[164:167], v[140:143]
    ds_read_b64_tr_b16 v[178:179], v240 offset:13824
    s_waitcnt lgkmcnt(4)
    v_mfma_f32_16x16x32_bf16 v[0:3], v[184:187], v[168:171], v[0:3]
    ds_read_b64_tr_b16 v[180:181], v241 offset:12288
    v_mfma_f32_16x16x32_bf16 v[4:7], v[184:187], v[172:175], v[4:7]
    ds_read_b64_tr_b16 v[182:183], v241 offset:13824
    buffer_load_dwordx4 v[152:155], v248, s[28:31], s64 offen offset:1024 sc1
    s_waitcnt lgkmcnt(4)
    v_mfma_f32_16x16x32_bf16 v[8:11], v[188:191], v[168:171], v[8:11]
    ds_read_b64_tr_b16 v[184:185], v238 offset:12416
    v_mfma_f32_16x16x32_bf16 v[12:15], v[188:191], v[172:175], v[12:15]
    ds_read_b64_tr_b16 v[186:187], v238 offset:13952
    s_waitcnt lgkmcnt(4)
    v_mfma_f32_16x16x32_bf16 v[16:19], v[176:179], v[168:171], v[16:19]
    ds_read_b64_tr_b16 v[188:189], v239 offset:12416
    v_mfma_f32_16x16x32_bf16 v[20:23], v[176:179], v[172:175], v[20:23]
    ds_read_b64_tr_b16 v[190:191], v239 offset:13952
    s_add_u32 m0, s59, 75520
    s_mov_b64 exec, s[62:63]
    buffer_load_dwordx4 v243, s[36:39], s57 offen lds
    s_mov_b64 exec, -1
    s_waitcnt lgkmcnt(4)
    v_mfma_f32_16x16x32_bf16 v[24:27], v[180:183], v[168:171], v[24:27]
    ds_read_b64_tr_b16 v[176:177], v240 offset:12416
    v_mfma_f32_16x16x32_bf16 v[28:31], v[180:183], v[172:175], v[28:31]
    ds_read_b64_tr_b16 v[178:179], v240 offset:13952
    s_waitcnt lgkmcnt(4)
    v_mfma_f32_16x16x32_bf16 v[32:35], v[184:187], v[168:171], v[32:35]
    ds_read_b64_tr_b16 v[180:181], v241 offset:12416
    v_mfma_f32_16x16x32_bf16 v[36:39], v[184:187], v[172:175], v[36:39]
    ds_read_b64_tr_b16 v[182:183], v241 offset:13952
    s_waitcnt lgkmcnt(4)
    v_mfma_f32_16x16x32_bf16 v[40:43], v[188:191], v[168:171], v[40:43]
    ds_read_b64_tr_b16 v[184:185], v238 offset:12544
    v_mfma_f32_16x16x32_bf16 v[44:47], v[188:191], v[172:175], v[44:47]
    ds_read_b64_tr_b16 v[186:187], v238 offset:14080
    s_waitcnt lgkmcnt(4)
    v_mfma_f32_16x16x32_bf16 v[48:51], v[176:179], v[168:171], v[48:51]
    ds_read_b64_tr_b16 v[188:189], v239 offset:12544
    buffer_load_dwordx4 v[156:159], v248, s[28:31], s65 offen offset:1024 sc1
    v_mfma_f32_16x16x32_bf16 v[52:55], v[176:179], v[172:175], v[52:55]
    ds_read_b64_tr_b16 v[190:191], v239 offset:14080
    s_waitcnt lgkmcnt(4)
    v_mfma_f32_16x16x32_bf16 v[56:59], v[180:183], v[168:171], v[56:59]
    ds_read_b64_tr_b16 v[176:177], v240 offset:12544
    v_mfma_f32_16x16x32_bf16 v[60:63], v[180:183], v[172:175], v[60:63]
    ds_read_b64_tr_b16 v[178:179], v240 offset:14080
    s_add_u32 m0, s59, 77184
    s_mov_b64 exec, s[62:63]
    buffer_load_dwordx4 v243, s[36:39], s58 offen lds
    s_mov_b64 exec, -1
    s_waitcnt lgkmcnt(4)
    v_mfma_f32_16x16x32_bf16 v[64:67], v[184:187], v[168:171], v[64:67]
    ds_read_b64_tr_b16 v[180:181], v241 offset:12544
    v_mfma_f32_16x16x32_bf16 v[68:71], v[184:187], v[172:175], v[68:71]
    ds_read_b64_tr_b16 v[182:183], v241 offset:14080
    s_waitcnt lgkmcnt(4)
    v_mfma_f32_16x16x32_bf16 v[72:75], v[188:191], v[168:171], v[72:75]
    ds_read_b64_tr_b16 v[184:185], v242 offset:6656
    v_mfma_f32_16x16x32_bf16 v[76:79], v[188:191], v[172:175], v[76:79]
    ds_read_b64_tr_b16 v[186:187], v242 offset:7040
    s_waitcnt lgkmcnt(4)
    v_mfma_f32_16x16x32_bf16 v[80:83], v[176:179], v[168:171], v[80:83]
    ds_read_b64_tr_b16 v[188:189], v242 offset:6688
    v_mfma_f32_16x16x32_bf16 v[84:87], v[176:179], v[172:175], v[84:87]
    ds_read_b64_tr_b16 v[190:191], v242 offset:7072
    s_waitcnt lgkmcnt(4)
    v_mfma_f32_16x16x32_bf16 v[88:91], v[180:183], v[168:171], v[88:91]
    ds_read_b64_tr_b16 v[176:177], v242 offset:6720
    v_mfma_f32_16x16x32_bf16 v[92:95], v[180:183], v[172:175], v[92:95]
    ds_read_b64_tr_b16 v[178:179], v242 offset:7104
    s_waitcnt lgkmcnt(4)
    v_mfma_f32_16x16x32_bf16 v[96:99], v[184:187], v[168:171], v[96:99]
    ds_read_b64_tr_b16 v[180:181], v242 offset:7424
    v_mfma_f32_16x16x32_bf16 v[100:103], v[184:187], v[172:175], v[100:103]
    ds_read_b64_tr_b16 v[182:183], v242 offset:7808
    s_waitcnt lgkmcnt(4)
    v_mfma_f32_16x16x32_bf16 v[104:107], v[188:191], v[168:171], v[104:107]
    ds_read_b64_tr_b16 v[184:185], v242 offset:7456
    v_mfma_f32_16x16x32_bf16 v[108:111], v[188:191], v[172:175], v[108:111]
    ds_read_b64_tr_b16 v[186:187], v242 offset:7840
    s_add_u32 m0, s69, 141312
    s_nop 0
    buffer_load_dwordx4 v254, s[44:47], s75 offen lds
    s_waitcnt lgkmcnt(4)
    v_mfma_f32_16x16x32_bf16 v[112:115], v[176:179], v[168:171], v[112:115]
    ds_read_b64_tr_b16 v[188:189], v242 offset:7488
    v_mfma_f32_16x16x32_bf16 v[116:119], v[176:179], v[172:175], v[116:119]
    ds_read_b64_tr_b16 v[190:191], v242 offset:7872
    s_waitcnt vmcnt(11)
    s_waitcnt lgkmcnt(0)
    s_barrier
    v_mfma_f32_16x16x32_bf16 v[120:123], v[180:183], v[168:171], v[120:123]
    ds_read_b64_tr_b16 v[176:177], v238 offset:37760
    v_mfma_f32_16x16x32_bf16 v[124:127], v[180:183], v[172:175], v[124:127]
    ds_read_b64_tr_b16 v[178:179], v238 offset:39296
    v_mfma_f32_16x16x32_bf16 v[128:131], v[184:187], v[168:171], v[128:131]
    ds_read_b64_tr_b16 v[180:181], v239 offset:37760
    v_mfma_f32_16x16x32_bf16 v[132:135], v[184:187], v[172:175], v[132:135]
    ds_read_b64_tr_b16 v[182:183], v239 offset:39296
    v_mfma_f32_16x16x32_bf16 v[136:139], v[188:191], v[168:171], v[136:139]
    ds_read_b64_tr_b16 v[184:185], v240 offset:37760
    v_mfma_f32_16x16x32_bf16 v[140:143], v[188:191], v[172:175], v[140:143]
    ds_read_b64_tr_b16 v[186:187], v240 offset:39296
    s_waitcnt lgkmcnt(4)
    v_mfma_f32_16x16x32_bf16 v[0:3], v[176:179], v[192:195], v[0:3]
    ds_read_b64_tr_b16 v[188:189], v241 offset:37760
    v_mfma_f32_16x16x32_bf16 v[4:7], v[176:179], v[196:199], v[4:7]
    ds_read_b64_tr_b16 v[190:191], v241 offset:39296
    s_waitcnt lgkmcnt(4)
    v_mfma_f32_16x16x32_bf16 v[8:11], v[180:183], v[192:195], v[8:11]
    ds_read_b64_tr_b16 v[176:177], v238 offset:37888
    v_mfma_f32_16x16x32_bf16 v[12:15], v[180:183], v[196:199], v[12:15]
    ds_read_b64_tr_b16 v[178:179], v238 offset:39424
    s_waitcnt lgkmcnt(4)
    v_mfma_f32_16x16x32_bf16 v[16:19], v[184:187], v[192:195], v[16:19]
    ds_read_b64_tr_b16 v[180:181], v239 offset:37888
    v_mfma_f32_16x16x32_bf16 v[20:23], v[184:187], v[196:199], v[20:23]
    ds_read_b64_tr_b16 v[182:183], v239 offset:39424
    s_waitcnt lgkmcnt(4)
    v_mfma_f32_16x16x32_bf16 v[24:27], v[188:191], v[192:195], v[24:27]
    ds_read_b64_tr_b16 v[184:185], v240 offset:37888
    v_mfma_f32_16x16x32_bf16 v[28:31], v[188:191], v[196:199], v[28:31]
    ds_read_b64_tr_b16 v[186:187], v240 offset:39424
    s_waitcnt lgkmcnt(4)
    v_mfma_f32_16x16x32_bf16 v[32:35], v[176:179], v[192:195], v[32:35]
    ds_read_b64_tr_b16 v[188:189], v241 offset:37888
    v_mfma_f32_16x16x32_bf16 v[36:39], v[176:179], v[196:199], v[36:39]
    ds_read_b64_tr_b16 v[190:191], v241 offset:39424
    s_waitcnt lgkmcnt(4)
    v_mfma_f32_16x16x32_bf16 v[40:43], v[180:183], v[192:195], v[40:43]
    ds_read_b64_tr_b16 v[176:177], v238 offset:38016
    v_mfma_f32_16x16x32_bf16 v[44:47], v[180:183], v[196:199], v[44:47]
    ds_read_b64_tr_b16 v[178:179], v238 offset:39552
    s_waitcnt lgkmcnt(4)
    v_mfma_f32_16x16x32_bf16 v[48:51], v[184:187], v[192:195], v[48:51]
    ds_read_b64_tr_b16 v[180:181], v239 offset:38016
    v_mfma_f32_16x16x32_bf16 v[52:55], v[184:187], v[196:199], v[52:55]
    ds_read_b64_tr_b16 v[182:183], v239 offset:39552
    s_waitcnt lgkmcnt(4)
    v_mfma_f32_16x16x32_bf16 v[56:59], v[188:191], v[192:195], v[56:59]
    ds_read_b64_tr_b16 v[184:185], v240 offset:38016
    v_mfma_f32_16x16x32_bf16 v[60:63], v[188:191], v[196:199], v[60:63]
    ds_read_b64_tr_b16 v[186:187], v240 offset:39552
    s_waitcnt lgkmcnt(4)
    v_mfma_f32_16x16x32_bf16 v[64:67], v[176:179], v[192:195], v[64:67]
    ds_read_b64_tr_b16 v[188:189], v241 offset:38016
    v_mfma_f32_16x16x32_bf16 v[68:71], v[176:179], v[196:199], v[68:71]
    ds_read_b64_tr_b16 v[190:191], v241 offset:39552
    s_waitcnt lgkmcnt(4)
    v_mfma_f32_16x16x32_bf16 v[72:75], v[180:183], v[192:195], v[72:75]
    ds_read_b64_tr_b16 v[176:177], v242 offset:37760
    v_mfma_f32_16x16x32_bf16 v[76:79], v[180:183], v[196:199], v[76:79]
    ds_read_b64_tr_b16 v[178:179], v242 offset:38144
    s_waitcnt lgkmcnt(4)
    v_mfma_f32_16x16x32_bf16 v[80:83], v[184:187], v[192:195], v[80:83]
    ds_read_b64_tr_b16 v[180:181], v242 offset:37792
    v_mfma_f32_16x16x32_bf16 v[84:87], v[184:187], v[196:199], v[84:87]
    ds_read_b64_tr_b16 v[182:183], v242 offset:38176
    s_waitcnt lgkmcnt(4)
    v_mfma_f32_16x16x32_bf16 v[88:91], v[188:191], v[192:195], v[88:91]
    ds_read_b64_tr_b16 v[184:185], v242 offset:37824
    v_mfma_f32_16x16x32_bf16 v[92:95], v[188:191], v[196:199], v[92:95]
    ds_read_b64_tr_b16 v[186:187], v242 offset:38208
    s_waitcnt lgkmcnt(4)
    v_mfma_f32_16x16x32_bf16 v[96:99], v[176:179], v[192:195], v[96:99]
    ds_read_b64_tr_b16 v[188:189], v242 offset:38528
    v_mfma_f32_16x16x32_bf16 v[100:103], v[176:179], v[196:199], v[100:103]
    ds_read_b64_tr_b16 v[190:191], v242 offset:38912
    s_waitcnt lgkmcnt(4)
    v_mfma_f32_16x16x32_bf16 v[104:107], v[180:183], v[192:195], v[104:107]
    ds_read_b64_tr_b16 v[176:177], v242 offset:38560
    v_mfma_f32_16x16x32_bf16 v[108:111], v[180:183], v[196:199], v[108:111]
    ds_read_b64_tr_b16 v[178:179], v242 offset:38944
    s_waitcnt lgkmcnt(4)
    v_mfma_f32_16x16x32_bf16 v[112:115], v[184:187], v[192:195], v[112:115]
    ds_read_b64_tr_b16 v[180:181], v242 offset:38592
    v_mfma_f32_16x16x32_bf16 v[116:119], v[184:187], v[196:199], v[116:119]
    ds_read_b64_tr_b16 v[182:183], v242 offset:38976
    s_waitcnt lgkmcnt(4)
    v_mfma_f32_16x16x32_bf16 v[120:123], v[188:191], v[192:195], v[120:123]
    ds_read_b64_tr_b16 v[184:185], v238 offset:50048
    v_mfma_f32_16x16x32_bf16 v[124:127], v[188:191], v[196:199], v[124:127]
    ds_read_b64_tr_b16 v[186:187], v238 offset:51584
    s_waitcnt lgkmcnt(4)
    v_mfma_f32_16x16x32_bf16 v[128:131], v[176:179], v[192:195], v[128:131]
    ds_read_b64_tr_b16 v[188:189], v239 offset:50048
    v_mfma_f32_16x16x32_bf16 v[132:135], v[176:179], v[196:199], v[132:135]
    ds_read_b64_tr_b16 v[190:191], v239 offset:51584
    s_waitcnt lgkmcnt(4)
    v_mfma_f32_16x16x32_bf16 v[136:139], v[180:183], v[192:195], v[136:139]
    ds_read_b64_tr_b16 v[176:177], v240 offset:50048
    v_mfma_f32_16x16x32_bf16 v[140:143], v[180:183], v[196:199], v[140:143]
    ds_read_b64_tr_b16 v[178:179], v240 offset:51584
    s_waitcnt lgkmcnt(4)
    v_mfma_f32_16x16x32_bf16 v[0:3], v[184:187], v[200:203], v[0:3]
    ds_read_b64_tr_b16 v[180:181], v241 offset:50048
    v_mfma_f32_16x16x32_bf16 v[4:7], v[184:187], v[204:207], v[4:7]
    ds_read_b64_tr_b16 v[182:183], v241 offset:51584
    s_waitcnt lgkmcnt(4)
    v_mfma_f32_16x16x32_bf16 v[8:11], v[188:191], v[200:203], v[8:11]
    ds_read_b64_tr_b16 v[184:185], v238 offset:50176
    v_mfma_f32_16x16x32_bf16 v[12:15], v[188:191], v[204:207], v[12:15]
    ds_read_b64_tr_b16 v[186:187], v238 offset:51712
    s_waitcnt lgkmcnt(4)
    v_mfma_f32_16x16x32_bf16 v[16:19], v[176:179], v[200:203], v[16:19]
    ds_read_b64_tr_b16 v[188:189], v239 offset:50176
    v_mfma_f32_16x16x32_bf16 v[20:23], v[176:179], v[204:207], v[20:23]
    ds_read_b64_tr_b16 v[190:191], v239 offset:51712
    s_waitcnt lgkmcnt(4)
    v_mfma_f32_16x16x32_bf16 v[24:27], v[180:183], v[200:203], v[24:27]
    ds_read_b64_tr_b16 v[176:177], v240 offset:50176
    v_mfma_f32_16x16x32_bf16 v[28:31], v[180:183], v[204:207], v[28:31]
    ds_read_b64_tr_b16 v[178:179], v240 offset:51712
    s_waitcnt lgkmcnt(4)
    v_mfma_f32_16x16x32_bf16 v[32:35], v[184:187], v[200:203], v[32:35]
    ds_read_b64_tr_b16 v[180:181], v241 offset:50176
    v_mfma_f32_16x16x32_bf16 v[36:39], v[184:187], v[204:207], v[36:39]
    ds_read_b64_tr_b16 v[182:183], v241 offset:51712
    s_waitcnt lgkmcnt(4)
    v_mfma_f32_16x16x32_bf16 v[40:43], v[188:191], v[200:203], v[40:43]
    ds_read_b64_tr_b16 v[184:185], v238 offset:50304
    v_mfma_f32_16x16x32_bf16 v[44:47], v[188:191], v[204:207], v[44:47]
    ds_read_b64_tr_b16 v[186:187], v238 offset:51840
    s_waitcnt lgkmcnt(4)
    v_mfma_f32_16x16x32_bf16 v[48:51], v[176:179], v[200:203], v[48:51]
    ds_read_b64_tr_b16 v[188:189], v239 offset:50304
    v_mfma_f32_16x16x32_bf16 v[52:55], v[176:179], v[204:207], v[52:55]
    ds_read_b64_tr_b16 v[190:191], v239 offset:51840
    s_waitcnt lgkmcnt(4)
    v_mfma_f32_16x16x32_bf16 v[56:59], v[180:183], v[200:203], v[56:59]
    ds_read_b64_tr_b16 v[176:177], v240 offset:50304
    v_mfma_f32_16x16x32_bf16 v[60:63], v[180:183], v[204:207], v[60:63]
    ds_read_b64_tr_b16 v[178:179], v240 offset:51840
    s_waitcnt lgkmcnt(4)
    v_mfma_f32_16x16x32_bf16 v[64:67], v[184:187], v[200:203], v[64:67]
    ds_read_b64_tr_b16 v[180:181], v241 offset:50304
    v_mfma_f32_16x16x32_bf16 v[68:71], v[184:187], v[204:207], v[68:71]
    ds_read_b64_tr_b16 v[182:183], v241 offset:51840
    s_waitcnt lgkmcnt(4)
    v_mfma_f32_16x16x32_bf16 v[72:75], v[188:191], v[200:203], v[72:75]
    ds_read_b64_tr_b16 v[184:185], v242 offset:44416
    v_mfma_f32_16x16x32_bf16 v[76:79], v[188:191], v[204:207], v[76:79]
    ds_read_b64_tr_b16 v[186:187], v242 offset:44800
    s_waitcnt lgkmcnt(4)
    v_mfma_f32_16x16x32_bf16 v[80:83], v[176:179], v[200:203], v[80:83]
    ds_read_b64_tr_b16 v[188:189], v242 offset:44448
    v_mfma_f32_16x16x32_bf16 v[84:87], v[176:179], v[204:207], v[84:87]
    ds_read_b64_tr_b16 v[190:191], v242 offset:44832
    s_waitcnt lgkmcnt(4)
    v_mfma_f32_16x16x32_bf16 v[88:91], v[180:183], v[200:203], v[88:91]
    ds_read_b64_tr_b16 v[176:177], v242 offset:44480
    v_mfma_f32_16x16x32_bf16 v[92:95], v[180:183], v[204:207], v[92:95]
    ds_read_b64_tr_b16 v[178:179], v242 offset:44864
    s_waitcnt lgkmcnt(4)
    v_mfma_f32_16x16x32_bf16 v[96:99], v[184:187], v[200:203], v[96:99]
    ds_read_b64_tr_b16 v[180:181], v242 offset:45184
    v_mfma_f32_16x16x32_bf16 v[100:103], v[184:187], v[204:207], v[100:103]
    ds_read_b64_tr_b16 v[182:183], v242 offset:45568
    s_waitcnt lgkmcnt(4)
    v_mfma_f32_16x16x32_bf16 v[104:107], v[188:191], v[200:203], v[104:107]
    ds_read_b64_tr_b16 v[184:185], v242 offset:45216
    v_mfma_f32_16x16x32_bf16 v[108:111], v[188:191], v[204:207], v[108:111]
    ds_read_b64_tr_b16 v[186:187], v242 offset:45600
    s_waitcnt lgkmcnt(4)
    v_mfma_f32_16x16x32_bf16 v[112:115], v[176:179], v[200:203], v[112:115]
    ds_read_b64_tr_b16 v[188:189], v242 offset:45248
    v_mfma_f32_16x16x32_bf16 v[116:119], v[176:179], v[204:207], v[116:119]
    ds_read_b64_tr_b16 v[190:191], v242 offset:45632
    s_waitcnt vmcnt(1)
    s_waitcnt lgkmcnt(0)
    s_barrier
    v_add_u32 v238, 75520, v238
    v_add_u32 v239, 75520, v239
    v_add_u32 v240, 75520, v240
    v_add_u32 v241, 75520, v241
    v_add_u32 v242, 75520, v242
    v_mfma_f32_16x16x32_bf16 v[120:123], v[180:183], v[200:203], v[120:123]
    ds_read_b64_tr_b16 v[176:177], v242 offset:0
    v_mfma_f32_16x16x32_bf16 v[124:127], v[180:183], v[204:207], v[124:127]
    ds_read_b64_tr_b16 v[178:179], v242 offset:384
    v_mfma_f32_16x16x32_bf16 v[128:131], v[184:187], v[200:203], v[128:131]
    ds_read_b64_tr_b16 v[180:181], v242 offset:6656
    v_mfma_f32_16x16x32_bf16 v[132:135], v[184:187], v[204:207], v[132:135]
    ds_read_b64_tr_b16 v[182:183], v242 offset:7040
    v_mfma_f32_16x16x32_bf16 v[136:139], v[188:191], v[200:203], v[136:139]
    ds_read_b64_tr_b16 v[184:185], v242 offset:768
    v_mfma_f32_16x16x32_bf16 v[140:143], v[188:191], v[204:207], v[140:143]
    ds_read_b64_tr_b16 v[186:187], v242 offset:1152
    s_waitcnt lgkmcnt(4)
    v_mfma_f32_16x16x32_bf16 v[96:99], v[176:179], v[144:147], v[96:99]
    v_mov_b32 v235, 0xc0135761
    ds_read_b64_tr_b16 v[188:189], v242 offset:7424
    s_mul_i32 s70, s53, 3
    v_mfma_f32_16x16x32_bf16 v[100:103], v[176:179], v[148:151], v[100:103]
    ds_read_b64_tr_b16 v[190:191], v242 offset:7808
    s_add_u32 s74, s54, 1
    s_and_b32 s74, s74, 7
    s_mul_i32 s74, s74, 24576
    s_mov_b32 s72, 0x3dd53b95
    s_waitcnt lgkmcnt(4)
    v_mfma_f32_16x16x32_bf16 v[96:99], v[180:183], v[152:155], v[96:99]
    ds_read_b64_tr_b16 v[176:177], v242 offset:32
    v_mfma_f32_16x16x32_bf16 v[100:103], v[180:183], v[156:159], v[100:103]
    ds_read_b64_tr_b16 v[178:179], v242 offset:416
    s_add_u32 m0, s69, 0
    s_nop 0
    buffer_load_dwordx4 v249, s[40:43], s74 offen lds
    s_waitcnt lgkmcnt(4)
    v_mfma_f32_16x16x32_bf16 v[120:123], v[184:187], v[144:147], v[120:123]
    ds_read_b64_tr_b16 v[180:181], v242 offset:6688
    v_mfma_f32_16x16x32_bf16 v[124:127], v[184:187], v[148:151], v[124:127]
    ds_read_b64_tr_b16 v[182:183], v242 offset:7072
    s_add_u32 m0, s69, 1024
    s_nop 0
    buffer_load_dwordx4 v250, s[40:43], s74 offen lds
    s_waitcnt lgkmcnt(4)
    v_mfma_f32_16x16x32_bf16 v[120:123], v[188:191], v[152:155], v[120:123]
    ds_read_b64_tr_b16 v[184:185], v242 offset:800
    v_mfma_f32_16x16x32_bf16 v[124:127], v[188:191], v[156:159], v[124:127]
    ds_read_b64_tr_b16 v[186:187], v242 offset:1184
    s_add_u32 m0, s69, 2048
    s_nop 0
    buffer_load_dwordx4 v251, s[40:43], s74 offen lds
    s_waitcnt lgkmcnt(4)
    v_mfma_f32_16x16x32_bf16 v[104:107], v[176:179], v[144:147], v[104:107]
    ds_read_b64_tr_b16 v[188:189], v242 offset:7456
    v_mfma_f32_16x16x32_bf16 v[108:111], v[176:179], v[148:151], v[108:111]
    ds_read_b64_tr_b16 v[190:191], v242 offset:7840
    s_add_u32 s75, s54, 1
    s_and_b32 s75, s75, 7
    s_mul_i32 s75, s75, 24576
    s_waitcnt lgkmcnt(4)
    v_mfma_f32_16x16x32_bf16 v[104:107], v[180:183], v[152:155], v[104:107]
    ds_read_b64_tr_b16 v[176:177], v242 offset:64
    v_mfma_f32_16x16x32_bf16 v[108:111], v[180:183], v[156:159], v[108:111]
    ds_read_b64_tr_b16 v[178:179], v242 offset:448
    s_add_u32 m0, s69, 49152
    s_nop 0
    buffer_load_dwordx4 v252, s[44:47], s75 offen lds
    v_mul_f32 v208, v96, v96
    v_mul_f32 v209, v97, v97
    s_waitcnt lgkmcnt(4)
    v_mfma_f32_16x16x32_bf16 v[128:131], v[184:187], v[144:147], v[128:131]
    v_mul_f32 v210, v98, v98
    v_mul_f32 v211, v99, v99
    ds_read_b64_tr_b16 v[180:181], v242 offset:6720
    v_mfma_f32_16x16x32_bf16 v[132:135], v[184:187], v[148:151], v[132:135]
    ds_read_b64_tr_b16 v[182:183], v242 offset:7104
    s_add_u32 m0, s69, 50176
    s_nop 0
    buffer_load_dwordx4 v253, s[44:47], s75 offen lds
    v_mul_f32 v212, v100, v100
    v_mul_f32 v213, v101, v101
    s_waitcnt lgkmcnt(4)
    v_mfma_f32_16x16x32_bf16 v[128:131], v[188:191], v[152:155], v[128:131]
    v_mul_f32 v214, v102, v102
    v_mul_f32 v215, v103, v103
    ds_read_b64_tr_b16 v[184:185], v242 offset:832
    v_mfma_f32_16x16x32_bf16 v[132:135], v[188:191], v[156:159], v[132:135]
    ds_read_b64_tr_b16 v[186:187], v242 offset:1216
    s_add_u32 m0, s69, 51200
    s_nop 0
    buffer_load_dwordx4 v254, s[44:47], s75 offen lds
    v_fma_f32 v208, v208, s71, v235
    v_fma_f32 v209, v209, s71, v235
    s_waitcnt lgkmcnt(4)
    v_mfma_f32_16x16x32_bf16 v[112:115], v[176:179], v[144:147], v[112:115]
    v_fma_f32 v210, v210, s71, v235
    v_fma_f32 v211, v211, s71, v235
    ds_read_b64_tr_b16 v[188:189], v242 offset:7488
    v_mfma_f32_16x16x32_bf16 v[116:119], v[176:179], v[148:151], v[116:119]
    ds_read_b64_tr_b16 v[190:191], v242 offset:7872
    s_add_u32 s74, s54, 2
    s_and_b32 s74, s74, 7
    s_mul_i32 s74, s74, 24576
    v_fma_f32 v212, v212, s71, v235
    v_fma_f32 v213, v213, s71, v235
    s_waitcnt lgkmcnt(4)
    v_mfma_f32_16x16x32_bf16 v[112:115], v[180:183], v[152:155], v[112:115]
    v_fma_f32 v214, v214, s71, v235
    v_fma_f32 v215, v215, s71, v235
    ds_read_b64_tr_b16 v[176:177], v238 offset:0
    v_mfma_f32_16x16x32_bf16 v[116:119], v[180:183], v[156:159], v[116:119]
    ds_read_b64_tr_b16 v[178:179], v238 offset:1536
    s_add_u32 m0, s69, 24576
    s_nop 0
    buffer_load_dwordx4 v249, s[40:43], s74 offen lds
    v_mul_f32 v208, v208, v96
    v_mul_f32 v209, v209, v97
    s_waitcnt lgkmcnt(4)
    v_mfma_f32_16x16x32_bf16 v[136:139], v[184:187], v[144:147], v[136:139]
    v_mul_f32 v210, v210, v98
    v_mul_f32 v211, v211, v99
    ds_read_b64_tr_b16 v[180:181], v238 offset:12288
    v_mfma_f32_16x16x32_bf16 v[140:143], v[184:187], v[148:151], v[140:143]
    ds_read_b64_tr_b16 v[182:183], v238 offset:13824
    s_add_u32 m0, s69, 25600
    s_nop 0
    buffer_load_dwordx4 v250, s[40:43], s74 offen lds
    v_mul_f32 v212, v212, v100
    v_mul_f32 v213, v213, v101
    s_waitcnt lgkmcnt(4)
    v_mfma_f32_16x16x32_bf16 v[136:139], v[188:191], v[152:155], v[136:139]
    v_mul_f32 v214, v214, v102
    v_mul_f32 v215, v215, v103
    ds_read_b64_tr_b16 v[184:185], v239 offset:0
    v_mfma_f32_16x16x32_bf16 v[140:143], v[188:191], v[156:159], v[140:143]
    ds_read_b64_tr_b16 v[186:187], v239 offset:1536
    s_add_u32 m0, s69, 26624
    s_nop 0
    buffer_load_dwordx4 v251, s[40:43], s74 offen lds
    v_exp_f32 v208, v208
    v_exp_f32 v209, v209
    s_waitcnt lgkmcnt(4)
    v_mfma_f32_16x16x32_bf16 v[0:3], v[176:179], v[144:147], v[0:3]
    v_exp_f32 v210, v210
    v_exp_f32 v211, v211
    ds_read_b64_tr_b16 v[188:189], v239 offset:12288
    v_mfma_f32_16x16x32_bf16 v[4:7], v[176:179], v[148:151], v[4:7]
    v_exp_f32 v212, v212
    v_exp_f32 v213, v213
    ds_read_b64_tr_b16 v[190:191], v239 offset:13824
    s_waitcnt lgkmcnt(4)
    v_mfma_f32_16x16x32_bf16 v[0:3], v[180:183], v[152:155], v[0:3]
    v_exp_f32 v214, v214
    v_exp_f32 v215, v215
    ds_read_b64_tr_b16 v[176:177], v240 offset:0
    v_mfma_f32_16x16x32_bf16 v[4:7], v[180:183], v[156:159], v[4:7]
    v_mul_f32 v96, v96, v120
    v_mul_f32 v97, v97, v121
    ds_read_b64_tr_b16 v[178:179], v240 offset:1536
    s_waitcnt lgkmcnt(4)
    v_mfma_f32_16x16x32_bf16 v[8:11], v[184:187], v[144:147], v[8:11]
    v_mul_f32 v98, v98, v122
    v_mul_f32 v99, v99, v123
    ds_read_b64_tr_b16 v[180:181], v240 offset:12288
    v_mfma_f32_16x16x32_bf16 v[12:15], v[184:187], v[148:151], v[12:15]
    v_mul_f32 v100, v100, v124
    v_mul_f32 v101, v101, v125
    ds_read_b64_tr_b16 v[182:183], v240 offset:13824
    s_waitcnt lgkmcnt(4)
    v_mfma_f32_16x16x32_bf16 v[8:11], v[188:191], v[152:155], v[8:11]
    v_mul_f32 v102, v102, v126
    v_mul_f32 v103, v103, v127
    ds_read_b64_tr_b16 v[184:185], v241 offset:0
    v_mfma_f32_16x16x32_bf16 v[12:15], v[188:191], v[156:159], v[12:15]
    v_add_f32 v208, 1.0, v208
    v_add_f32 v209, 1.0, v209
    ds_read_b64_tr_b16 v[186:187], v241 offset:1536
    s_waitcnt lgkmcnt(4)
    v_mfma_f32_16x16x32_bf16 v[16:19], v[176:179], v[144:147], v[16:19]
    v_add_f32 v210, 1.0, v210
    v_add_f32 v211, 1.0, v211
    ds_read_b64_tr_b16 v[188:189], v241 offset:12288
    v_mfma_f32_16x16x32_bf16 v[20:23], v[176:179], v[148:151], v[20:23]
    v_add_f32 v212, 1.0, v212
    v_add_f32 v213, 1.0, v213
    ds_read_b64_tr_b16 v[190:191], v241 offset:13824
    s_waitcnt lgkmcnt(4)
    v_mfma_f32_16x16x32_bf16 v[16:19], v[180:183], v[152:155], v[16:19]
    v_add_f32 v214, 1.0, v214
    v_add_f32 v215, 1.0, v215
    ds_read_b64_tr_b16 v[176:177], v238 offset:128
    v_mfma_f32_16x16x32_bf16 v[20:23], v[180:183], v[156:159], v[20:23]
    v_rcp_f32 v208, v208
    v_rcp_f32 v209, v209
    ds_read_b64_tr_b16 v[178:179], v238 offset:1664
    s_waitcnt lgkmcnt(4)
    v_mfma_f32_16x16x32_bf16 v[24:27], v[184:187], v[144:147], v[24:27]
    v_rcp_f32 v210, v210
    v_rcp_f32 v211, v211
    ds_read_b64_tr_b16 v[180:181], v238 offset:12416
    v_mfma_f32_16x16x32_bf16 v[28:31], v[184:187], v[148:151], v[28:31]
    v_rcp_f32 v212, v212
    v_rcp_f32 v213, v213
    ds_read_b64_tr_b16 v[182:183], v238 offset:13952
    s_waitcnt lgkmcnt(4)
    v_mfma_f32_16x16x32_bf16 v[24:27], v[188:191], v[152:155], v[24:27]
    v_rcp_f32 v214, v214
    v_rcp_f32 v215, v215
    ds_read_b64_tr_b16 v[184:185], v239 offset:128
    v_mfma_f32_16x16x32_bf16 v[28:31], v[188:191], v[156:159], v[28:31]
    ds_read_b64_tr_b16 v[186:187], v239 offset:1664
    s_add_u32 s66, s70, 0
    v_mul_f32 v96, v96, v208
    s_waitcnt lgkmcnt(4)
    v_mfma_f32_16x16x32_bf16 v[32:35], v[176:179], v[144:147], v[32:35]
    v_mul_f32 v97, v97, v209
    v_mul_f32 v98, v98, v210
    ds_read_b64_tr_b16 v[188:189], v239 offset:12416
    v_mfma_f32_16x16x32_bf16 v[36:39], v[176:179], v[148:151], v[36:39]
    v_mul_f32 v99, v99, v211
    v_mul_f32 v100, v100, v212
    ds_read_b64_tr_b16 v[190:191], v239 offset:13952
    s_waitcnt lgkmcnt(4)
    v_mfma_f32_16x16x32_bf16 v[32:35], v[180:183], v[152:155], v[32:35]
    v_mul_f32 v101, v101, v213
    v_mul_f32 v102, v102, v214
    ds_read_b64_tr_b16 v[176:177], v240 offset:128
    v_mfma_f32_16x16x32_bf16 v[36:39], v[180:183], v[156:159], v[36:39]
    v_mul_f32 v103, v103, v215
    v_cvt_pk_bf16_f32 v216, v96, v97
    ds_read_b64_tr_b16 v[178:179], v240 offset:1664
    s_waitcnt lgkmcnt(4)
    v_mfma_f32_16x16x32_bf16 v[40:43], v[184:187], v[144:147], v[40:43]
    v_cvt_pk_bf16_f32 v217, v98, v99
    v_cvt_pk_bf16_f32 v218, v100, v101
    ds_read_b64_tr_b16 v[180:181], v240 offset:12416
    v_mfma_f32_16x16x32_bf16 v[44:47], v[184:187], v[148:151], v[44:47]
    v_cvt_pk_bf16_f32 v219, v102, v103
    ds_read_b64_tr_b16 v[182:183], v240 offset:13952
    s_and_b32 s67, s66, 1
    s_lshr_b32 s66, s66, 1
    s_lshl_b32 s66, s66, 10
    s_lshl_b32 s67, s67, 3
    s_add_u32 s66, s66, s67
    s_add_u32 s66, s66, 196608
    s_add_u32 s67, s66, 245760
    buffer_store_dwordx2 v[216:217], v248, s[48:51], s66 offen sc1
    buffer_store_dwordx2 v[218:219], v248, s[48:51], s67 offen sc1
    s_waitcnt lgkmcnt(4)
    v_mfma_f32_16x16x32_bf16 v[40:43], v[188:191], v[152:155], v[40:43]
    v_mul_f32 v208, v104, v104
    v_mul_f32 v209, v105, v105
    ds_read_b64_tr_b16 v[184:185], v241 offset:128
    v_mfma_f32_16x16x32_bf16 v[44:47], v[188:191], v[156:159], v[44:47]
    v_mul_f32 v210, v106, v106
    v_mul_f32 v211, v107, v107
    ds_read_b64_tr_b16 v[186:187], v241 offset:1664
    s_waitcnt lgkmcnt(4)
    v_mfma_f32_16x16x32_bf16 v[48:51], v[176:179], v[144:147], v[48:51]
    v_mul_f32 v212, v108, v108
    v_mul_f32 v213, v109, v109
    ds_read_b64_tr_b16 v[188:189], v241 offset:12416
    v_mfma_f32_16x16x32_bf16 v[52:55], v[176:179], v[148:151], v[52:55]
    v_mul_f32 v214, v110, v110
    v_mul_f32 v215, v111, v111
    ds_read_b64_tr_b16 v[190:191], v241 offset:13952
    s_waitcnt lgkmcnt(4)
    v_mfma_f32_16x16x32_bf16 v[48:51], v[180:183], v[152:155], v[48:51]
    v_fma_f32 v208, v208, s71, v235
    v_fma_f32 v209, v209, s71, v235
    ds_read_b64_tr_b16 v[176:177], v238 offset:256
    v_mfma_f32_16x16x32_bf16 v[52:55], v[180:183], v[156:159], v[52:55]
    v_fma_f32 v210, v210, s71, v235
    v_fma_f32 v211, v211, s71, v235
    ds_read_b64_tr_b16 v[178:179], v238 offset:1792
    s_waitcnt lgkmcnt(4)
    v_mfma_f32_16x16x32_bf16 v[56:59], v[184:187], v[144:147], v[56:59]
    v_fma_f32 v212, v212, s71, v235
    v_fma_f32 v213, v213, s71, v235
    ds_read_b64_tr_b16 v[180:181], v238 offset:12544
    v_mfma_f32_16x16x32_bf16 v[60:63], v[184:187], v[148:151], v[60:63]
    v_fma_f32 v214, v214, s71, v235
    v_fma_f32 v215, v215, s71, v235
    ds_read_b64_tr_b16 v[182:183], v238 offset:14080
    s_waitcnt lgkmcnt(4)
    v_mfma_f32_16x16x32_bf16 v[56:59], v[188:191], v[152:155], v[56:59]
    v_mul_f32 v208, v208, v104
    v_mul_f32 v209, v209, v105
    ds_read_b64_tr_b16 v[184:185], v239 offset:256
    v_mfma_f32_16x16x32_bf16 v[60:63], v[188:191], v[156:159], v[60:63]
    v_mul_f32 v210, v210, v106
    v_mul_f32 v211, v211, v107
    ds_read_b64_tr_b16 v[186:187], v239 offset:1792
    s_waitcnt lgkmcnt(4)
    v_mfma_f32_16x16x32_bf16 v[64:67], v[176:179], v[144:147], v[64:67]
    v_mul_f32 v212, v212, v108
    v_mul_f32 v213, v213, v109
    ds_read_b64_tr_b16 v[188:189], v239 offset:12544
    v_mfma_f32_16x16x32_bf16 v[68:71], v[176:179], v[148:151], v[68:71]
    v_mul_f32 v214, v214, v110
    v_mul_f32 v215, v215, v111
    ds_read_b64_tr_b16 v[190:191], v239 offset:14080
    s_waitcnt lgkmcnt(4)
    v_mfma_f32_16x16x32_bf16 v[64:67], v[180:183], v[152:155], v[64:67]
    v_exp_f32 v208, v208
    v_exp_f32 v209, v209
    ds_read_b64_tr_b16 v[176:177], v240 offset:256
    v_mfma_f32_16x16x32_bf16 v[68:71], v[180:183], v[156:159], v[68:71]
    v_exp_f32 v210, v210
    v_exp_f32 v211, v211
    ds_read_b64_tr_b16 v[178:179], v240 offset:1792
    s_waitcnt lgkmcnt(4)
    v_mfma_f32_16x16x32_bf16 v[72:75], v[184:187], v[144:147], v[72:75]
    v_exp_f32 v212, v212
    v_exp_f32 v213, v213
    ds_read_b64_tr_b16 v[180:181], v240 offset:12544
    v_mfma_f32_16x16x32_bf16 v[76:79], v[184:187], v[148:151], v[76:79]
    v_exp_f32 v214, v214
    v_exp_f32 v215, v215
    ds_read_b64_tr_b16 v[182:183], v240 offset:14080
    s_waitcnt lgkmcnt(4)
    v_mfma_f32_16x16x32_bf16 v[72:75], v[188:191], v[152:155], v[72:75]
    v_mul_f32 v104, v104, v128
    v_mul_f32 v105, v105, v129
    ds_read_b64_tr_b16 v[184:185], v241 offset:256
    v_mfma_f32_16x16x32_bf16 v[76:79], v[188:191], v[156:159], v[76:79]
    v_mul_f32 v106, v106, v130
    v_mul_f32 v107, v107, v131
    ds_read_b64_tr_b16 v[186:187], v241 offset:1792
    s_waitcnt lgkmcnt(4)
    v_mfma_f32_16x16x32_bf16 v[80:83], v[176:179], v[144:147], v[80:83]
    v_mul_f32 v108, v108, v132
    v_mul_f32 v109, v109, v133
    ds_read_b64_tr_b16 v[188:189], v241 offset:12544
    v_mfma_f32_16x16x32_bf16 v[84:87], v[176:179], v[148:151], v[84:87]
    v_mul_f32 v110, v110, v134
    v_mul_f32 v111, v111, v135
    ds_read_b64_tr_b16 v[190:191], v241 offset:14080
    s_waitcnt lgkmcnt(4)
    v_mfma_f32_16x16x32_bf16 v[80:83], v[180:183], v[152:155], v[80:83]
    v_add_f32 v208, 1.0, v208
    v_add_f32 v209, 1.0, v209
    v_mfma_f32_16x16x32_bf16 v[84:87], v[180:183], v[156:159], v[84:87]
    v_add_f32 v210, 1.0, v210
    v_add_f32 v211, 1.0, v211
    s_waitcnt lgkmcnt(2)
    v_mfma_f32_16x16x32_bf16 v[88:91], v[184:187], v[144:147], v[88:91]
    v_add_f32 v212, 1.0, v212
    v_add_f32 v213, 1.0, v213
    v_mfma_f32_16x16x32_bf16 v[92:95], v[184:187], v[148:151], v[92:95]
    v_add_f32 v214, 1.0, v214
    v_add_f32 v215, 1.0, v215
    s_waitcnt lgkmcnt(0)
    v_mfma_f32_16x16x32_bf16 v[88:91], v[188:191], v[152:155], v[88:91]
    v_rcp_f32 v208, v208
    v_rcp_f32 v209, v209
    v_mfma_f32_16x16x32_bf16 v[92:95], v[188:191], v[156:159], v[92:95]
    s_nop 7
    v_rcp_f32 v210, v210
    v_rcp_f32 v211, v211
    v_rcp_f32 v212, v212
    v_rcp_f32 v213, v213
    v_rcp_f32 v214, v214
    v_rcp_f32 v215, v215
    s_add_u32 s66, s70, 1
    v_mul_f32 v104, v104, v208
    v_mul_f32 v105, v105, v209
    v_mul_f32 v106, v106, v210
    v_mul_f32 v107, v107, v211
    v_mul_f32 v108, v108, v212
    v_mul_f32 v109, v109, v213
    v_mul_f32 v110, v110, v214
    v_mul_f32 v111, v111, v215
    v_cvt_pk_bf16_f32 v220, v104, v105
    v_cvt_pk_bf16_f32 v221, v106, v107
    v_cvt_pk_bf16_f32 v222, v108, v109
    v_cvt_pk_bf16_f32 v223, v110, v111
    s_and_b32 s67, s66, 1
    s_lshr_b32 s66, s66, 1
    s_lshl_b32 s66, s66, 10
    s_lshl_b32 s67, s67, 3
    s_add_u32 s66, s66, s67
    s_add_u32 s66, s66, 196608
    s_add_u32 s67, s66, 245760
    buffer_store_dwordx2 v[220:221], v248, s[48:51], s66 offen sc1
    buffer_store_dwordx2 v[222:223], v248, s[48:51], s67 offen sc1
    v_mul_f32 v208, v112, v112
    v_mul_f32 v209, v113, v113
    v_mul_f32 v210, v114, v114
    v_mul_f32 v211, v115, v115
    v_mul_f32 v212, v116, v116
    v_mul_f32 v213, v117, v117
    v_mul_f32 v214, v118, v118
    v_mul_f32 v215, v119, v119
    v_fma_f32 v208, v208, s71, v235
    v_fma_f32 v209, v209, s71, v235
    v_fma_f32 v210, v210, s71, v235
    v_fma_f32 v211, v211, s71, v235
    v_fma_f32 v212, v212, s71, v235
    v_fma_f32 v213, v213, s71, v235
    v_fma_f32 v214, v214, s71, v235
    v_fma_f32 v215, v215, s71, v235
    v_mul_f32 v208, v208, v112
    v_mul_f32 v209, v209, v113
    v_mul_f32 v210, v210, v114
    v_mul_f32 v211, v211, v115
    v_mul_f32 v212, v212, v116
    v_mul_f32 v213, v213, v117
    v_mul_f32 v214, v214, v118
    v_mul_f32 v215, v215, v119
    v_exp_f32 v208, v208
    v_exp_f32 v209, v209
    v_exp_f32 v210, v210
    v_exp_f32 v211, v211
    v_exp_f32 v212, v212
    v_exp_f32 v213, v213
    v_exp_f32 v214, v214
    v_exp_f32 v215, v215
    v_mul_f32 v112, v112, v136
    v_mul_f32 v113, v113, v137
    v_mul_f32 v114, v114, v138
    v_mul_f32 v115, v115, v139
    v_mul_f32 v116, v116, v140
    v_mul_f32 v117, v117, v141
    v_mul_f32 v118, v118, v142
    v_mul_f32 v119, v119, v143
    v_add_f32 v208, 1.0, v208
    v_add_f32 v209, 1.0, v209
    v_add_f32 v210, 1.0, v210
    v_add_f32 v211, 1.0, v211
    v_add_f32 v212, 1.0, v212
    v_add_f32 v213, 1.0, v213
    v_add_f32 v214, 1.0, v214
    v_add_f32 v215, 1.0, v215
    v_rcp_f32 v208, v208
    v_rcp_f32 v209, v209
    v_rcp_f32 v210, v210
    v_rcp_f32 v211, v211
    v_rcp_f32 v212, v212
    v_rcp_f32 v213, v213
    v_rcp_f32 v214, v214
    v_rcp_f32 v215, v215
    s_add_u32 s66, s70, 2
    v_mul_f32 v112, v112, v208
    v_mul_f32 v113, v113, v209
    v_mul_f32 v114, v114, v210
    v_mul_f32 v115, v115, v211
    v_mul_f32 v116, v116, v212
    v_mul_f32 v117, v117, v213
    v_mul_f32 v118, v118, v214
    v_mul_f32 v119, v119, v215
    v_cvt_pk_bf16_f32 v136, v112, v113
    v_cvt_pk_bf16_f32 v137, v114, v115
    v_cvt_pk_bf16_f32 v138, v116, v117
    v_cvt_pk_bf16_f32 v139, v118, v119
    s_and_b32 s67, s66, 1
    s_lshr_b32 s66, s66, 1
    s_lshl_b32 s66, s66, 10
    s_lshl_b32 s67, s67, 3
    s_add_u32 s66, s66, s67
    s_add_u32 s66, s66, 196608
    s_add_u32 s67, s66, 245760
    buffer_store_dwordx2 v[136:137], v248, s[48:51], s66 offen sc1
    buffer_store_dwordx2 v[138:139], v248, s[48:51], s67 offen sc1
    v_mul_f32 v0, s72, v0
    v_mul_f32 v1, s72, v1
    v_mul_f32 v2, s72, v2
    v_mul_f32 v3, s72, v3
    v_mul_f32 v4, s72, v4
    v_mul_f32 v5, s72, v5
    v_mul_f32 v6, s72, v6
    v_mul_f32 v7, s72, v7
    v_cvt_pk_bf16_f32 v96, v0, v1
    v_cvt_pk_bf16_f32 v97, v2, v3
    v_cvt_pk_bf16_f32 v120, v4, v5
    v_cvt_pk_bf16_f32 v121, v6, v7
    v_mul_f32 v8, s72, v8
    v_mul_f32 v9, s72, v9
    v_mul_f32 v10, s72, v10
    v_mul_f32 v11, s72, v11
    v_mul_f32 v12, s72, v12
    v_mul_f32 v13, s72, v13
    v_mul_f32 v14, s72, v14
    v_mul_f32 v15, s72, v15
    v_cvt_pk_bf16_f32 v98, v8, v9
    v_cvt_pk_bf16_f32 v99, v10, v11
    v_cvt_pk_bf16_f32 v122, v12, v13
    v_cvt_pk_bf16_f32 v123, v14, v15
    s_nop 1
    v_permlane32_swap_b32 v96, v98
    v_permlane32_swap_b32 v97, v99
    v_permlane32_swap_b32 v120, v122
    v_permlane32_swap_b32 v121, v123
    s_nop 0
    v_permlane16_swap_b32 v96, v98
    v_permlane16_swap_b32 v97, v99
    v_permlane16_swap_b32 v120, v122
    v_permlane16_swap_b32 v121, v123
    v_mul_f32 v16, s72, v16
    v_mul_f32 v17, s72, v17
    v_mul_f32 v18, s72, v18
    v_mul_f32 v19, s72, v19
    v_mul_f32 v20, s72, v20
    v_mul_f32 v21, s72, v21
    v_mul_f32 v22, s72, v22
    v_mul_f32 v23, s72, v23
    v_cvt_pk_bf16_f32 v100, v16, v17
    v_cvt_pk_bf16_f32 v101, v18, v19
    v_cvt_pk_bf16_f32 v124, v20, v21
    v_cvt_pk_bf16_f32 v125, v22, v23
    v_mul_f32 v24, s72, v24
    v_mul_f32 v25, s72, v25
    v_mul_f32 v26, s72, v26
    v_mul_f32 v27, s72, v27
    v_mul_f32 v28, s72, v28
    v_mul_f32 v29, s72, v29
    v_mul_f32 v30, s72, v30
    v_mul_f32 v31, s72, v31
    v_cvt_pk_bf16_f32 v102, v24, v25
    v_cvt_pk_bf16_f32 v103, v26, v27
    v_cvt_pk_bf16_f32 v126, v28, v29
    v_cvt_pk_bf16_f32 v127, v30, v31
    s_nop 1
    v_permlane32_swap_b32 v100, v102
    v_permlane32_swap_b32 v101, v103
    v_permlane32_swap_b32 v124, v126
    v_permlane32_swap_b32 v125, v127
    s_nop 0
    v_permlane16_swap_b32 v100, v102
    v_permlane16_swap_b32 v101, v103
    v_permlane16_swap_b32 v124, v126
    v_permlane16_swap_b32 v125, v127
    v_mul_f32 v32, s72, v32
    v_mul_f32 v33, s72, v33
    v_mul_f32 v34, s72, v34
    v_mul_f32 v35, s72, v35
    v_mul_f32 v36, s72, v36
    v_mul_f32 v37, s72, v37
    v_mul_f32 v38, s72, v38
    v_mul_f32 v39, s72, v39
    v_cvt_pk_bf16_f32 v104, v32, v33
    v_cvt_pk_bf16_f32 v105, v34, v35
    v_cvt_pk_bf16_f32 v128, v36, v37
    v_cvt_pk_bf16_f32 v129, v38, v39
    v_mul_f32 v40, s72, v40
    v_mul_f32 v41, s72, v41
    v_mul_f32 v42, s72, v42
    v_mul_f32 v43, s72, v43
    v_mul_f32 v44, s72, v44
    v_mul_f32 v45, s72, v45
    v_mul_f32 v46, s72, v46
    v_mul_f32 v47, s72, v47
    v_cvt_pk_bf16_f32 v106, v40, v41
    v_cvt_pk_bf16_f32 v107, v42, v43
    v_cvt_pk_bf16_f32 v130, v44, v45
    v_cvt_pk_bf16_f32 v131, v46, v47
    s_nop 1
    v_permlane32_swap_b32 v104, v106
    v_permlane32_swap_b32 v105, v107
    v_permlane32_swap_b32 v128, v130
    v_permlane32_swap_b32 v129, v131
    s_nop 0
    v_permlane16_swap_b32 v104, v106
    v_permlane16_swap_b32 v105, v107
    v_permlane16_swap_b32 v128, v130
    v_permlane16_swap_b32 v129, v131
    v_mul_f32 v48, s72, v48
    v_mul_f32 v49, s72, v49
    v_mul_f32 v50, s72, v50
    v_mul_f32 v51, s72, v51
    v_mul_f32 v52, s72, v52
    v_mul_f32 v53, s72, v53
    v_mul_f32 v54, s72, v54
    v_mul_f32 v55, s72, v55
    v_cvt_pk_bf16_f32 v108, v48, v49
    v_cvt_pk_bf16_f32 v109, v50, v51
    v_cvt_pk_bf16_f32 v132, v52, v53
    v_cvt_pk_bf16_f32 v133, v54, v55
    v_mul_f32 v56, s72, v56
    v_mul_f32 v57, s72, v57
    v_mul_f32 v58, s72, v58
    v_mul_f32 v59, s72, v59
    v_mul_f32 v60, s72, v60
    v_mul_f32 v61, s72, v61
    v_mul_f32 v62, s72, v62
    v_mul_f32 v63, s72, v63
    v_cvt_pk_bf16_f32 v110, v56, v57
    v_cvt_pk_bf16_f32 v111, v58, v59
    v_cvt_pk_bf16_f32 v134, v60, v61
    v_cvt_pk_bf16_f32 v135, v62, v63
    s_nop 1
    v_permlane32_swap_b32 v108, v110
    v_permlane32_swap_b32 v109, v111
    v_permlane32_swap_b32 v132, v134
    v_permlane32_swap_b32 v133, v135
    s_nop 0
    v_permlane16_swap_b32 v108, v110
    v_permlane16_swap_b32 v109, v111
    v_permlane16_swap_b32 v132, v134
    v_permlane16_swap_b32 v133, v135
    v_mul_f32 v64, s72, v64
    v_mul_f32 v65, s72, v65
    v_mul_f32 v66, s72, v66
    v_mul_f32 v67, s72, v67
    v_mul_f32 v68, s72, v68
    v_mul_f32 v69, s72, v69
    v_mul_f32 v70, s72, v70
    v_mul_f32 v71, s72, v71
    v_cvt_pk_bf16_f32 v112, v64, v65
    v_cvt_pk_bf16_f32 v113, v66, v67
    v_cvt_pk_bf16_f32 v136, v68, v69
    v_cvt_pk_bf16_f32 v137, v70, v71
    v_mul_f32 v72, s72, v72
    v_mul_f32 v73, s72, v73
    v_mul_f32 v74, s72, v74
    v_mul_f32 v75, s72, v75
    v_mul_f32 v76, s72, v76
    v_mul_f32 v77, s72, v77
    v_mul_f32 v78, s72, v78
    v_mul_f32 v79, s72, v79
    v_cvt_pk_bf16_f32 v114, v72, v73
    v_cvt_pk_bf16_f32 v115, v74, v75
    v_cvt_pk_bf16_f32 v138, v76, v77
    v_cvt_pk_bf16_f32 v139, v78, v79
    s_nop 1
    v_permlane32_swap_b32 v112, v114
    v_permlane32_swap_b32 v113, v115
    v_permlane32_swap_b32 v136, v138
    v_permlane32_swap_b32 v137, v139
    s_nop 0
    v_permlane16_swap_b32 v112, v114
    v_permlane16_swap_b32 v113, v115
    v_permlane16_swap_b32 v136, v138
    v_permlane16_swap_b32 v137, v139
    v_mul_f32 v80, s72, v80
    v_mul_f32 v81, s72, v81
    v_mul_f32 v82, s72, v82
    v_mul_f32 v83, s72, v83
    v_mul_f32 v84, s72, v84
    v_mul_f32 v85, s72, v85
    v_mul_f32 v86, s72, v86
    v_mul_f32 v87, s72, v87
    v_cvt_pk_bf16_f32 v116, v80, v81
    v_cvt_pk_bf16_f32 v117, v82, v83
    v_cvt_pk_bf16_f32 v140, v84, v85
    v_cvt_pk_bf16_f32 v141, v86, v87
    v_mul_f32 v88, s72, v88
    v_mul_f32 v89, s72, v89
    v_mul_f32 v90, s72, v90
    v_mul_f32 v91, s72, v91
    v_mul_f32 v92, s72, v92
    v_mul_f32 v93, s72, v93
    v_mul_f32 v94, s72, v94
    v_mul_f32 v95, s72, v95
    v_cvt_pk_bf16_f32 v118, v88, v89
    v_cvt_pk_bf16_f32 v119, v90, v91
    v_cvt_pk_bf16_f32 v142, v92, v93
    v_cvt_pk_bf16_f32 v143, v94, v95
    s_nop 1
    v_permlane32_swap_b32 v116, v118
    v_permlane32_swap_b32 v117, v119
    v_permlane32_swap_b32 v140, v142
    v_permlane32_swap_b32 v141, v143
    s_nop 0
    v_permlane16_swap_b32 v116, v118
    v_permlane16_swap_b32 v117, v119
    v_permlane16_swap_b32 v140, v142
    v_permlane16_swap_b32 v141, v143
    v_lshrrev_b32 v230, 4, v248
    v_lshrrev_b32 v231, 4, v230
    v_bfe_u32 v233, v230, 2, 2
    v_and_b32 v234, 3, v230
    v_lshlrev_b32 v234, 3, v234
    v_bfe_u32 v235, v230, 3, 2
    v_lshl_add_u32 v233, v231, 2, v233
    v_mul_u32_u24 v233, 384, v233
    v_add_u32 v233, v233, v234
    v_add_u32 v233, 139264, v233
    v_xor_b32 v234, 0, v235
    v_lshl_add_u32 v238, v234, 5, v233
    v_xor_b32 v234, 1, v235
    v_lshl_add_u32 v239, v234, 5, v233
    v_xor_b32 v234, 2, v235
    v_lshl_add_u32 v240, v234, 5, v233
    v_xor_b32 v234, 3, v235
    v_lshl_add_u32 v241, v234, 5, v233
    v_and_b32 v233, 15, v230
    v_bfe_u32 v235, v230, 1, 3
    v_mul_u32_u24 v233, 384, v233
    v_add_u32 v233, 114688, v233
    v_add_u32 v234, 0, v231
    v_xor_b32 v234, v234, v235
    v_lshl_add_u32 v242, v234, 4, v233
    v_add_u32 v234, 4, v231
    v_xor_b32 v234, v234, v235
    v_lshl_add_u32 v243, v234, 4, v233
    v_mov_b32 v228, 0
    v_mov_b32 v229, 0
    s_mov_b32 s73, 0x5d800000
    s_barrier
    ds_read_b128 v[176:179], v242 offset:0
    ds_read_b128 v[180:183], v243 offset:0
    ds_read_b128 v[184:187], v242 offset:128
    s_waitcnt lgkmcnt(2)
    v_mfma_f32_16x16x32_bf16 v[144:147], v[176:179], v[96:99], 0
    ds_read_b128 v[188:191], v243 offset:128
    v_mfma_f32_16x16x32_bf16 v[148:151], v[176:179], v[120:123], 0
    s_waitcnt lgkmcnt(2)
    v_mfma_f32_16x16x32_bf16 v[144:147], v[180:183], v[100:103], v[144:147]
    ds_read_b128 v[176:179], v242 offset:256
    v_mfma_f32_16x16x32_bf16 v[148:151], v[180:183], v[124:127], v[148:151]
    s_waitcnt lgkmcnt(2)
    v_mfma_f32_16x16x32_bf16 v[144:147], v[184:187], v[104:107], v[144:147]
    ds_read_b128 v[180:183], v243 offset:256
    v_mfma_f32_16x16x32_bf16 v[148:151], v[184:187], v[128:131], v[148:151]
    s_waitcnt lgkmcnt(2)
    v_mfma_f32_16x16x32_bf16 v[144:147], v[188:191], v[108:111], v[144:147]
    ds_read_b128 v[184:187], v242 offset:6144
    v_mfma_f32_16x16x32_bf16 v[148:151], v[188:191], v[132:135], v[148:151]
    s_waitcnt lgkmcnt(2)
    v_mfma_f32_16x16x32_bf16 v[144:147], v[176:179], v[112:115], v[144:147]
    ds_read_b128 v[188:191], v243 offset:6144
    v_mfma_f32_16x16x32_bf16 v[148:151], v[176:179], v[136:139], v[148:151]
    s_waitcnt lgkmcnt(2)
    v_mfma_f32_16x16x32_bf16 v[144:147], v[180:183], v[116:119], v[144:147]
    ds_read_b128 v[176:179], v242 offset:6272
    v_mfma_f32_16x16x32_bf16 v[148:151], v[180:183], v[140:143], v[148:151]
    s_waitcnt lgkmcnt(2)
    v_mfma_f32_16x16x32_bf16 v[152:155], v[184:187], v[96:99], 0
    ds_read_b128 v[180:183], v243 offset:6272
    v_mfma_f32_16x16x32_bf16 v[156:159], v[184:187], v[120:123], 0
    s_waitcnt lgkmcnt(2)
    v_mfma_f32_16x16x32_bf16 v[152:155], v[188:191], v[100:103], v[152:155]
    ds_read_b128 v[184:187], v242 offset:6400
    v_mfma_f32_16x16x32_bf16 v[156:159], v[188:191], v[124:127], v[156:159]
    s_waitcnt lgkmcnt(2)
    v_mfma_f32_16x16x32_bf16 v[152:155], v[176:179], v[104:107], v[152:155]
    ds_read_b128 v[188:191], v243 offset:6400
    v_mfma_f32_16x16x32_bf16 v[156:159], v[176:179], v[128:131], v[156:159]
    s_waitcnt lgkmcnt(2)
    v_mfma_f32_16x16x32_bf16 v[152:155], v[180:183], v[108:111], v[152:155]
    ds_read_b128 v[176:179], v242 offset:12288
    v_mfma_f32_16x16x32_bf16 v[156:159], v[180:183], v[132:135], v[156:159]
    s_waitcnt lgkmcnt(2)
    v_mfma_f32_16x16x32_bf16 v[152:155], v[184:187], v[112:115], v[152:155]
    ds_read_b128 v[180:183], v243 offset:12288
    v_mfma_f32_16x16x32_bf16 v[156:159], v[184:187], v[136:139], v[156:159]
    s_waitcnt lgkmcnt(2)
    v_mfma_f32_16x16x32_bf16 v[152:155], v[188:191], v[116:119], v[152:155]
    ds_read_b128 v[184:187], v242 offset:12416
    v_mfma_f32_16x16x32_bf16 v[156:159], v[188:191], v[140:143], v[156:159]
    s_waitcnt lgkmcnt(2)
    v_mfma_f32_16x16x32_bf16 v[160:163], v[176:179], v[96:99], 0
    ds_read_b128 v[188:191], v243 offset:12416
    v_mfma_f32_16x16x32_bf16 v[164:167], v[176:179], v[120:123], 0
    s_waitcnt lgkmcnt(2)
    v_mfma_f32_16x16x32_bf16 v[160:163], v[180:183], v[100:103], v[160:163]
    ds_read_b128 v[176:179], v242 offset:12544
    v_mfma_f32_16x16x32_bf16 v[164:167], v[180:183], v[124:127], v[164:167]
    v_max3_f32 v216, v144, v145, v146
    v_max3_f32 v216, v216, v147, v152
    v_max3_f32 v216, v216, v153, v154
    v_max_f32 v216, v216, v155
    v_max3_f32 v220, v148, v149, v150
    v_max3_f32 v220, v220, v151, v156
    s_waitcnt lgkmcnt(2)
    v_mfma_f32_16x16x32_bf16 v[160:163], v[184:187], v[104:107], v[160:163]
    v_max3_f32 v220, v220, v157, v158
    v_max_f32 v220, v220, v159
    v_mov_b32 v230, v216
    v_mov_b32 v231, v220
    ds_read_b128 v[180:183], v243 offset:12544
    s_nop 1
    v_mfma_f32_16x16x32_bf16 v[164:167], v[184:187], v[128:131], v[164:167]
    v_permlane32_swap_b32 v216, v230
    v_permlane32_swap_b32 v220, v231
    v_max_f32 v216, v216, v230
    v_max_f32 v220, v220, v231
    v_mov_b32 v230, v216
    v_mov_b32 v231, v220
    s_waitcnt lgkmcnt(2)
    v_mfma_f32_16x16x32_bf16 v[160:163], v[188:191], v[108:111], v[160:163]
    ds_read_b128 v[184:187], v242 offset:18432
    s_nop 1
    v_permlane16_swap_b32 v216, v230
    v_permlane16_swap_b32 v220, v231
    v_max_f32 v216, v216, v230
    v_max_f32 v220, v220, v231
    v_mfma_f32_16x16x32_bf16 v[164:167], v[188:191], v[132:135], v[164:167]
    v_sub_f32 v144, v144, v216
    v_sub_f32 v145, v145, v216
    v_sub_f32 v146, v146, v216
    v_sub_f32 v147, v147, v216
    v_sub_f32 v152, v152, v216
    s_waitcnt lgkmcnt(2)
    v_mfma_f32_16x16x32_bf16 v[160:163], v[176:179], v[112:115], v[160:163]
    v_sub_f32 v153, v153, v216
    v_sub_f32 v154, v154, v216
    v_sub_f32 v155, v155, v216
    v_sub_f32 v148, v148, v220
    v_sub_f32 v149, v149, v220
    v_sub_f32 v150, v150, v220
    ds_read_b128 v[188:191], v243 offset:18432
    v_mfma_f32_16x16x32_bf16 v[164:167], v[176:179], v[136:139], v[164:167]
    v_sub_f32 v151, v151, v220
    v_sub_f32 v156, v156, v220
    v_sub_f32 v157, v157, v220
    v_sub_f32 v158, v158, v220
    v_sub_f32 v159, v159, v220
    s_waitcnt lgkmcnt(2)
    v_mfma_f32_16x16x32_bf16 v[160:163], v[180:183], v[116:119], v[160:163]
    v_sub_f32 v208, 0, v216
    v_sub_f32 v209, 0, v216
    v_sub_f32 v210, 0, v216
    v_sub_f32 v211, 0, v216
    v_sub_f32 v212, 0, v220
    v_sub_f32 v213, 0, v220
    ds_read_b128 v[176:179], v242 offset:18560
    v_mfma_f32_16x16x32_bf16 v[164:167], v[180:183], v[140:143], v[164:167]
    v_sub_f32 v214, 0, v220
    v_sub_f32 v215, 0, v220
    v_exp_f32 v230, v144
    v_exp_f32 v231, v145
    v_exp_f32 v232, v146
    s_waitcnt lgkmcnt(2)
    v_mfma_f32_16x16x32_bf16 v[168:171], v[184:187], v[96:99], 0
    v_exp_f32 v233, v147
    v_exp_f32 v234, v148
    v_cvt_pk_bf16_f32 v192, v230, v231
    v_exp_f32 v235, v149
    v_cvt_pk_bf16_f32 v193, v232, v233
    ds_read_b128 v[180:183], v243 offset:18560
    v_mfma_f32_16x16x32_bf16 v[172:175], v[184:187], v[120:123], 0
    v_exp_f32 v236, v150
    v_exp_f32 v237, v151
    v_cvt_pk_bf16_f32 v200, v234, v235
    v_cvt_pk_bf16_f32 v201, v236, v237
    v_exp_f32 v230, v152
    v_exp_f32 v231, v153
    s_waitcnt lgkmcnt(2)
    v_mfma_f32_16x16x32_bf16 v[168:171], v[188:191], v[100:103], v[168:171]
    v_exp_f32 v232, v154
    v_exp_f32 v233, v155
    v_exp_f32 v234, v156
    v_cvt_pk_bf16_f32 v194, v230, v231
    v_exp_f32 v235, v157
    ds_read_b128 v[184:187], v242 offset:18688
    v_mfma_f32_16x16x32_bf16 v[172:175], v[188:191], v[124:127], v[172:175]
    v_cvt_pk_bf16_f32 v195, v232, v233
    v_exp_f32 v236, v158
    v_exp_f32 v237, v159
    v_cvt_pk_bf16_f32 v202, v234, v235
    v_cvt_pk_bf16_f32 v203, v236, v237
    s_waitcnt lgkmcnt(2)
    v_mfma_f32_16x16x32_bf16 v[168:171], v[176:179], v[104:107], v[168:171]
    ds_read_b128 v[188:191], v243 offset:18688
    v_mfma_f32_16x16x32_bf16 v[172:175], v[176:179], v[128:131], v[172:175]
    v_mfma_f32_16x16x32_bf16 v[216:219], v[224:227], v[192:195], 0
    v_mfma_f32_16x16x32_bf16 v[220:223], v[224:227], v[200:203], 0
    s_waitcnt vmcnt(15)
    s_barrier
    s_waitcnt lgkmcnt(2)
    v_mfma_f32_16x16x32_bf16 v[168:171], v[180:183], v[108:111], v[168:171]
    ds_read_b64_tr_b16 v[176:177], v238 offset:0
    v_mfma_f32_16x16x32_bf16 v[172:175], v[180:183], v[132:135], v[172:175]
    ds_read_b64_tr_b16 v[178:179], v238 offset:6144
    s_waitcnt lgkmcnt(3)
    v_mfma_f32_16x16x32_bf16 v[168:171], v[184:187], v[112:115], v[168:171]
    ds_read_b64_tr_b16 v[180:181], v239 offset:0
    s_add_u32 s75, s54, 2
    s_and_b32 s75, s75, 7
    s_mul_i32 s75, s75, 24576
    v_mfma_f32_16x16x32_bf16 v[172:175], v[184:187], v[136:139], v[172:175]
    ds_read_b64_tr_b16 v[182:183], v239 offset:6144
    s_waitcnt lgkmcnt(4)
    v_mfma_f32_16x16x32_bf16 v[168:171], v[188:191], v[116:119], v[168:171]
    ds_read_b64_tr_b16 v[184:185], v240 offset:0
    v_mfma_f32_16x16x32_bf16 v[172:175], v[188:191], v[140:143], v[172:175]
    ds_read_b64_tr_b16 v[186:187], v240 offset:6144
    s_waitcnt lgkmcnt(4)
    v_mfma_f32_16x16x32_bf16 v[0:3], v[176:179], v[192:195], 0
    v_add_f32 v228, v228, v216
    ds_read_b64_tr_b16 v[188:189], v241 offset:0
    s_add_u32 m0, s69, 73728
    s_nop 0
    buffer_load_dwordx4 v252, s[44:47], s75 offen lds
    v_mfma_f32_16x16x32_bf16 v[4:7], v[176:179], v[200:203], 0
    v_add_f32 v229, v229, v220
    ds_read_b64_tr_b16 v[190:191], v241 offset:6144
    s_waitcnt lgkmcnt(4)
    v_mfma_f32_16x16x32_bf16 v[8:11], v[180:183], v[192:195], 0
    ds_read_b64_tr_b16 v[176:177], v238 offset:128
    v_mfma_f32_16x16x32_bf16 v[12:15], v[180:183], v[200:203], 0
    v_add_f32 v160, v160, v208
    v_add_f32 v161, v161, v208
    ds_read_b64_tr_b16 v[178:179], v238 offset:6272
    s_waitcnt lgkmcnt(4)
    v_mfma_f32_16x16x32_bf16 v[16:19], v[184:187], v[192:195], 0
    v_add_f32 v162, v162, v208
    ds_read_b64_tr_b16 v[180:181], v239 offset:128
    v_mfma_f32_16x16x32_bf16 v[20:23], v[184:187], v[200:203], 0
    v_add_f32 v163, v163, v208
    ds_read_b64_tr_b16 v[182:183], v239 offset:6272
    s_add_u32 m0, s69, 74752
    s_nop 0
    buffer_load_dwordx4 v253, s[44:47], s75 offen lds
    s_waitcnt lgkmcnt(4)
    v_mfma_f32_16x16x32_bf16 v[24:27], v[188:191], v[192:195], 0
    v_add_f32 v168, v168, v208
    ds_read_b64_tr_b16 v[184:185], v240 offset:128
    v_mfma_f32_16x16x32_bf16 v[28:31], v[188:191], v[200:203], 0
    v_add_f32 v169, v169, v208
    ds_read_b64_tr_b16 v[186:187], v240 offset:6272
    s_waitcnt lgkmcnt(4)
    v_mfma_f32_16x16x32_bf16 v[32:35], v[176:179], v[192:195], 0
    v_add_f32 v170, v170, v208
    ds_read_b64_tr_b16 v[188:189], v241 offset:128
    v_mfma_f32_16x16x32_bf16 v[36:39], v[176:179], v[200:203], 0
    v_add_f32 v171, v171, v208
    ds_read_b64_tr_b16 v[190:191], v241 offset:6272
    s_add_u32 m0, s69, 75776
    s_nop 0
    buffer_load_dwordx4 v254, s[44:47], s75 offen lds
    s_waitcnt lgkmcnt(4)
    v_mfma_f32_16x16x32_bf16 v[40:43], v[180:183], v[192:195], 0
    v_add_f32 v164, v164, v212
    ds_read_b64_tr_b16 v[176:177], v238 offset:256
    v_mfma_f32_16x16x32_bf16 v[44:47], v[180:183], v[200:203], 0
    v_add_f32 v165, v165, v212
    ds_read_b64_tr_b16 v[178:179], v238 offset:6400
    s_waitcnt lgkmcnt(4)
    v_mfma_f32_16x16x32_bf16 v[48:51], v[184:187], v[192:195], 0
    v_add_f32 v166, v166, v212
    ds_read_b64_tr_b16 v[180:181], v239 offset:256
    v_add_u32 v242, 4294852608, v242
    v_mfma_f32_16x16x32_bf16 v[52:55], v[184:187], v[200:203], 0
    v_add_f32 v167, v167, v212
    ds_read_b64_tr_b16 v[182:183], v239 offset:6400
    s_waitcnt lgkmcnt(4)
    v_mfma_f32_16x16x32_bf16 v[56:59], v[188:191], v[192:195], 0
    v_add_f32 v172, v172, v212
    ds_read_b64_tr_b16 v[184:185], v240 offset:256
    v_add_u32 v243, 4294852608, v243
    v_mfma_f32_16x16x32_bf16 v[60:63], v[188:191], v[200:203], 0
    v_add_f32 v173, v173, v212
    v_add_f32 v174, v174, v212
    ds_read_b64_tr_b16 v[186:187], v240 offset:6400
    s_waitcnt lgkmcnt(4)
    v_mfma_f32_16x16x32_bf16 v[64:67], v[176:179], v[192:195], 0
    v_add_f32 v175, v175, v212
    ds_read_b64_tr_b16 v[188:189], v241 offset:256
    v_mfma_f32_16x16x32_bf16 v[68:71], v[176:179], v[200:203], 0
    v_exp_f32 v230, v160
    ds_read_b64_tr_b16 v[190:191], v241 offset:6400
    s_waitcnt vmcnt(15)
    s_barrier
    s_waitcnt lgkmcnt(4)
    v_mfma_f32_16x16x32_bf16 v[72:75], v[180:183], v[192:195], 0
    v_exp_f32 v231, v161
    ds_read_b128 v[176:179], v242 offset:0
    v_mfma_f32_16x16x32_bf16 v[76:79], v[180:183], v[200:203], 0
    v_exp_f32 v232, v162
    s_waitcnt lgkmcnt(3)
    v_mfma_f32_16x16x32_bf16 v[80:83], v[184:187], v[192:195], 0
    v_exp_f32 v233, v163
    ds_read_b128 v[180:183], v243 offset:0
    s_add_u32 s74, s54, 3
    s_and_b32 s74, s74, 7
    s_mul_i32 s74, s74, 24576
    v_mfma_f32_16x16x32_bf16 v[84:87], v[184:187], v[200:203], 0
    v_exp_f32 v234, v164
    s_waitcnt lgkmcnt(2)
    v_mfma_f32_16x16x32_bf16 v[88:91], v[188:191], v[192:195], 0
    v_cvt_pk_bf16_f32 v196, v230, v231
    ds_read_b128 v[184:187], v242 offset:128
    v_mfma_f32_16x16x32_bf16 v[92:95], v[188:191], v[200:203], 0
    v_exp_f32 v235, v165
    s_waitcnt lgkmcnt(2)
    v_mfma_f32_16x16x32_bf16 v[144:147], v[176:179], v[96:99], v[208:211]
    v_cvt_pk_bf16_f32 v197, v232, v233
    ds_read_b128 v[188:191], v243 offset:128
    s_add_u32 m0, s69, 114688
    s_nop 0
    buffer_load_dwordx4 v249, s[40:43], s74 offen lds
    v_mfma_f32_16x16x32_bf16 v[148:151], v[176:179], v[120:123], v[212:215]
    v_exp_f32 v236, v166
    s_waitcnt lgkmcnt(2)
    v_mfma_f32_16x16x32_bf16 v[144:147], v[180:183], v[100:103], v[144:147]
    v_exp_f32 v237, v167
    ds_read_b128 v[176:179], v242 offset:256
    v_mfma_f32_16x16x32_bf16 v[148:151], v[180:183], v[124:127], v[148:151]
    v_cvt_pk_bf16_f32 v204, v234, v235
    v_cvt_pk_bf16_f32 v205, v236, v237
    s_waitcnt lgkmcnt(2)
    v_mfma_f32_16x16x32_bf16 v[144:147], v[184:187], v[104:107], v[144:147]
    v_exp_f32 v230, v168
    ds_read_b128 v[180:183], v243 offset:256
    v_mfma_f32_16x16x32_bf16 v[148:151], v[184:187], v[128:131], v[148:151]
    v_exp_f32 v231, v169
    s_add_u32 m0, s69, 115712
    s_nop 0
    buffer_load_dwordx4 v250, s[40:43], s74 offen lds
    s_waitcnt lgkmcnt(2)
    v_mfma_f32_16x16x32_bf16 v[144:147], v[188:191], v[108:111], v[144:147]
    v_exp_f32 v232, v170
    ds_read_b128 v[184:187], v242 offset:6144
    v_mfma_f32_16x16x32_bf16 v[148:151], v[188:191], v[132:135], v[148:151]
    v_exp_f32 v233, v171
    s_waitcnt lgkmcnt(2)
    v_mfma_f32_16x16x32_bf16 v[144:147], v[176:179], v[112:115], v[144:147]
    v_exp_f32 v234, v172
    ds_read_b128 v[188:191], v243 offset:6144
    v_mfma_f32_16x16x32_bf16 v[148:151], v[176:179], v[136:139], v[148:151]
    v_cvt_pk_bf16_f32 v198, v230, v231
    s_add_u32 m0, s69, 116736
    s_nop 0
    buffer_load_dwordx4 v251, s[40:43], s74 offen lds
    s_waitcnt lgkmcnt(2)
    v_mfma_f32_16x16x32_bf16 v[144:147], v[180:183], v[116:119], v[144:147]
    v_exp_f32 v235, v173
    ds_read_b128 v[176:179], v242 offset:6272
    v_mfma_f32_16x16x32_bf16 v[148:151], v[180:183], v[140:143], v[148:151]
    v_cvt_pk_bf16_f32 v199, v232, v233
    s_waitcnt lgkmcnt(2)
    v_mfma_f32_16x16x32_bf16 v[152:155], v[184:187], v[96:99], v[208:211]
    v_exp_f32 v236, v174
    ds_read_b128 v[180:183], v243 offset:6272
    v_mfma_f32_16x16x32_bf16 v[156:159], v[184:187], v[120:123], v[212:215]
    v_exp_f32 v237, v175
    s_waitcnt lgkmcnt(2)
    v_mfma_f32_16x16x32_bf16 v[152:155], v[188:191], v[100:103], v[152:155]
    v_cvt_pk_bf16_f32 v206, v234, v235
    ds_read_b128 v[184:187], v242 offset:6400
    v_mfma_f32_16x16x32_bf16 v[156:159], v[188:191], v[124:127], v[156:159]
    v_cvt_pk_bf16_f32 v207, v236, v237
    s_waitcnt lgkmcnt(2)
    v_mfma_f32_16x16x32_bf16 v[152:155], v[176:179], v[104:107], v[152:155]
    ds_read_b128 v[188:191], v243 offset:6400
    v_mfma_f32_16x16x32_bf16 v[156:159], v[176:179], v[128:131], v[156:159]
    v_mfma_f32_16x16x32_bf16 v[216:219], v[224:227], v[196:199], 0
    v_mfma_f32_16x16x32_bf16 v[220:223], v[224:227], v[204:207], 0
    s_waitcnt lgkmcnt(2)
    v_mfma_f32_16x16x32_bf16 v[152:155], v[180:183], v[108:111], v[152:155]
    ds_read_b64_tr_b16 v[176:177], v238 offset:12288
    v_lshrrev_b32 v244, 4, v248
    v_mul_u32_u24 v245, 6554, v244
    v_lshrrev_b32 v245, 16, v245
    v_mul_u32_u24 v246, 1120, v245
    v_add_u32 v244, v246, v248
    s_lshl_b32 s97, s2, 3
    s_add_u32 s97, s97, s52
    s_and_b32 s98, s97, 255
    s_mul_i32 s98, s98, 7680
    s_lshr_b32 s81, s97, 8
    s_mul_i32 s81, s81, 160
    s_add_u32 s98, s98, s81
    s_mov_b32 s36, s20
    s_and_b32 s37, s21, 0xffff
    s_mov_b32 s38, 1966080
    s_mov_b32 s39, 0x20000
    s_mov_b32 exec_hi, 0xfffffff
    buffer_load_dwordx4 v[244:247], v244, s[36:39], s98 offen
    s_mov_b64 exec, -1
    s_mul_i32 s81, s97, 960
    s_add_u32 s81, s81, 55115776
    v_mfma_f32_16x16x32_bf16 v[156:159], v[180:183], v[132:135], v[156:159]
    ds_read_b64_tr_b16 v[178:179], v238 offset:18432
    s_waitcnt lgkmcnt(3)
    v_mfma_f32_16x16x32_bf16 v[152:155], v[184:187], v[112:115], v[152:155]
    ds_read_b64_tr_b16 v[180:181], v239 offset:12288
    v_mfma_f32_16x16x32_bf16 v[156:159], v[184:187], v[136:139], v[156:159]
    ds_read_b64_tr_b16 v[182:183], v239 offset:18432
    s_waitcnt lgkmcnt(4)
    v_mfma_f32_16x16x32_bf16 v[152:155], v[188:191], v[116:119], v[152:155]
    ds_read_b64_tr_b16 v[184:185], v240 offset:12288
    v_mfma_f32_16x16x32_bf16 v[156:159], v[188:191], v[140:143], v[156:159]
    ds_read_b64_tr_b16 v[186:187], v240 offset:18432
    v_max_f32 v217, v216, v220
    v_cmp_nge_f32 vcc, s73, v217
    s_cbranch_vccnz L_k1_tr0_1
L_k1_back0_1:
    s_waitcnt lgkmcnt(4)
    v_mfma_f32_16x16x32_bf16 v[0:3], v[176:179], v[196:199], v[0:3]
    v_add_f32 v228, v228, v216
    ds_read_b64_tr_b16 v[188:189], v241 offset:12288
    v_mfma_f32_16x16x32_bf16 v[4:7], v[176:179], v[204:207], v[4:7]
    v_add_f32 v229, v229, v220
    ds_read_b64_tr_b16 v[190:191], v241 offset:18432
    s_waitcnt lgkmcnt(4)
    v_mfma_f32_16x16x32_bf16 v[8:11], v[180:183], v[196:199], v[8:11]
    ds_read_b64_tr_b16 v[176:177], v238 offset:12416
    v_mfma_f32_16x16x32_bf16 v[12:15], v[180:183], v[204:207], v[12:15]
    v_exp_f32 v230, v144
    ds_read_b64_tr_b16 v[178:179], v238 offset:18560
    s_waitcnt lgkmcnt(4)
    v_mfma_f32_16x16x32_bf16 v[16:19], v[184:187], v[196:199], v[16:19]
    v_exp_f32 v231, v145
    ds_read_b64_tr_b16 v[180:181], v239 offset:12416
    v_mfma_f32_16x16x32_bf16 v[20:23], v[184:187], v[204:207], v[20:23]
    ds_read_b64_tr_b16 v[182:183], v239 offset:18560
    s_waitcnt lgkmcnt(4)
    v_mfma_f32_16x16x32_bf16 v[24:27], v[188:191], v[196:199], v[24:27]
    v_exp_f32 v232, v146
    ds_read_b64_tr_b16 v[184:185], v240 offset:12416
    v_mfma_f32_16x16x32_bf16 v[28:31], v[188:191], v[204:207], v[28:31]
    v_exp_f32 v233, v147
    ds_read_b64_tr_b16 v[186:187], v240 offset:18560
    s_waitcnt lgkmcnt(4)
    v_mfma_f32_16x16x32_bf16 v[32:35], v[176:179], v[196:199], v[32:35]
    ds_read_b64_tr_b16 v[188:189], v241 offset:12416
    v_mfma_f32_16x16x32_bf16 v[36:39], v[176:179], v[204:207], v[36:39]
    v_exp_f32 v234, v148
    ds_read_b64_tr_b16 v[190:191], v241 offset:18560
    s_waitcnt lgkmcnt(4)
    v_mfma_f32_16x16x32_bf16 v[40:43], v[180:183], v[196:199], v[40:43]
    v_cvt_pk_bf16_f32 v192, v230, v231
    ds_read_b64_tr_b16 v[176:177], v238 offset:12544
    v_mfma_f32_16x16x32_bf16 v[44:47], v[180:183], v[204:207], v[44:47]
    ds_read_b64_tr_b16 v[178:179], v238 offset:18688
    s_waitcnt lgkmcnt(4)
    v_mfma_f32_16x16x32_bf16 v[48:51], v[184:187], v[196:199], v[48:51]
    v_exp_f32 v235, v149
    ds_read_b64_tr_b16 v[180:181], v239 offset:12544
    v_mfma_f32_16x16x32_bf16 v[52:55], v[184:187], v[204:207], v[52:55]
    v_cvt_pk_bf16_f32 v193, v232, v233
    ds_read_b64_tr_b16 v[182:183], v239 offset:18688
    s_waitcnt lgkmcnt(4)
    v_mfma_f32_16x16x32_bf16 v[56:59], v[188:191], v[196:199], v[56:59]
    ds_read_b64_tr_b16 v[184:185], v240 offset:12544
    v_mfma_f32_16x16x32_bf16 v[60:63], v[188:191], v[204:207], v[60:63]
    v_exp_f32 v236, v150
    ds_read_b64_tr_b16 v[186:187], v240 offset:18688
    s_waitcnt lgkmcnt(4)
    v_mfma_f32_16x16x32_bf16 v[64:67], v[176:179], v[196:199], v[64:67]
    v_exp_f32 v237, v151
    ds_read_b64_tr_b16 v[188:189], v241 offset:12544
    v_mfma_f32_16x16x32_bf16 v[68:71], v[176:179], v[204:207], v[68:71]
    ds_read_b64_tr_b16 v[190:191], v241 offset:18688
    s_waitcnt lgkmcnt(4)
    v_mfma_f32_16x16x32_bf16 v[72:75], v[180:183], v[196:199], v[72:75]
    v_cvt_pk_bf16_f32 v200, v234, v235
    ds_read_b128 v[176:179], v242 offset:12288
    v_mfma_f32_16x16x32_bf16 v[76:79], v[180:183], v[204:207], v[76:79]
    v_cvt_pk_bf16_f32 v201, v236, v237
    s_waitcnt lgkmcnt(3)
    v_mfma_f32_16x16x32_bf16 v[80:83], v[184:187], v[196:199], v[80:83]
    ds_read_b128 v[180:183], v243 offset:12288
    v_mfma_f32_16x16x32_bf16 v[84:87], v[184:187], v[204:207], v[84:87]
    v_exp_f32 v230, v152
    s_waitcnt lgkmcnt(2)
    v_mfma_f32_16x16x32_bf16 v[88:91], v[188:191], v[196:199], v[88:91]
    ds_read_b128 v[184:187], v242 offset:12416
    v_mfma_f32_16x16x32_bf16 v[92:95], v[188:191], v[204:207], v[92:95]
    v_exp_f32 v231, v153
    s_waitcnt lgkmcnt(2)
    v_mfma_f32_16x16x32_bf16 v[160:163], v[176:179], v[96:99], v[208:211]
    v_exp_f32 v232, v154
    ds_read_b128 v[188:191], v243 offset:12416
    v_mfma_f32_16x16x32_bf16 v[164:167], v[176:179], v[120:123], v[212:215]
    s_waitcnt lgkmcnt(2)
    v_mfma_f32_16x16x32_bf16 v[160:163], v[180:183], v[100:103], v[160:163]
    v_exp_f32 v233, v155
    ds_read_b128 v[176:179], v242 offset:12544
    v_mfma_f32_16x16x32_bf16 v[164:167], v[180:183], v[124:127], v[164:167]
    v_exp_f32 v234, v156
    s_waitcnt lgkmcnt(2)
    v_mfma_f32_16x16x32_bf16 v[160:163], v[184:187], v[104:107], v[160:163]
    ds_read_b128 v[180:183], v243 offset:12544
    v_mfma_f32_16x16x32_bf16 v[164:167], v[184:187], v[128:131], v[164:167]
    v_cvt_pk_bf16_f32 v194, v230, v231
    s_waitcnt lgkmcnt(2)
    v_mfma_f32_16x16x32_bf16 v[160:163], v[188:191], v[108:111], v[160:163]
    v_exp_f32 v235, v157
    ds_read_b128 v[184:187], v242 offset:18432
    v_mfma_f32_16x16x32_bf16 v[164:167], v[188:191], v[132:135], v[164:167]
    s_waitcnt lgkmcnt(2)
    v_mfma_f32_16x16x32_bf16 v[160:163], v[176:179], v[112:115], v[160:163]
    v_cvt_pk_bf16_f32 v195, v232, v233
    ds_read_b128 v[188:191], v243 offset:18432
    v_mfma_f32_16x16x32_bf16 v[164:167], v[176:179], v[136:139], v[164:167]
    v_exp_f32 v236, v158
    s_waitcnt lgkmcnt(2)
    v_mfma_f32_16x16x32_bf16 v[160:163], v[180:183], v[116:119], v[160:163]
    ds_read_b128 v[176:179], v242 offset:18560
    v_mfma_f32_16x16x32_bf16 v[164:167], v[180:183], v[140:143], v[164:167]
    v_exp_f32 v237, v159
    v_add_u32 v238, 4294877184, v238
    s_waitcnt lgkmcnt(2)
    v_mfma_f32_16x16x32_bf16 v[168:171], v[184:187], v[96:99], v[208:211]
    v_cvt_pk_bf16_f32 v202, v234, v235
    ds_read_b128 v[180:183], v243 offset:18560
    v_mfma_f32_16x16x32_bf16 v[172:175], v[184:187], v[120:123], v[212:215]
    v_add_u32 v239, 4294877184, v239
    s_waitcnt lgkmcnt(2)
    v_mfma_f32_16x16x32_bf16 v[168:171], v[188:191], v[100:103], v[168:171]
    v_cvt_pk_bf16_f32 v203, v236, v237
    ds_read_b128 v[184:187], v242 offset:18688
    v_mfma_f32_16x16x32_bf16 v[172:175], v[188:191], v[124:127], v[172:175]
    v_add_u32 v240, 4294877184, v240
    s_waitcnt lgkmcnt(2)
    v_mfma_f32_16x16x32_bf16 v[168:171], v[176:179], v[104:107], v[168:171]
    ds_read_b128 v[188:191], v243 offset:18688
    v_mfma_f32_16x16x32_bf16 v[172:175], v[176:179], v[128:131], v[172:175]
    v_add_u32 v241, 4294877184, v241
    v_mfma_f32_16x16x32_bf16 v[216:219], v[224:227], v[192:195], 0
    v_mfma_f32_16x16x32_bf16 v[220:223], v[224:227], v[200:203], 0
    s_waitcnt vmcnt(16)
    s_barrier
    s_waitcnt lgkmcnt(2)
    v_mfma_f32_16x16x32_bf16 v[168:171], v[180:183], v[108:111], v[168:171]
    ds_read_b64_tr_b16 v[176:177], v238 offset:0
    v_mfma_f32_16x16x32_bf16 v[172:175], v[180:183], v[132:135], v[172:175]
    ds_read_b64_tr_b16 v[178:179], v238 offset:6144
    s_waitcnt lgkmcnt(3)
    v_mfma_f32_16x16x32_bf16 v[168:171], v[184:187], v[112:115], v[168:171]
    ds_read_b64_tr_b16 v[180:181], v239 offset:0
    s_add_u32 s75, s54, 3
    s_and_b32 s75, s75, 7
    s_mul_i32 s75, s75, 24576
    v_mfma_f32_16x16x32_bf16 v[172:175], v[184:187], v[136:139], v[172:175]
    ds_read_b64_tr_b16 v[182:183], v239 offset:6144
    s_waitcnt lgkmcnt(4)
    v_mfma_f32_16x16x32_bf16 v[168:171], v[188:191], v[116:119], v[168:171]
    ds_read_b64_tr_b16 v[184:185], v240 offset:0
    v_mfma_f32_16x16x32_bf16 v[172:175], v[188:191], v[140:143], v[172:175]
    ds_read_b64_tr_b16 v[186:187], v240 offset:6144
    v_max_f32 v217, v216, v220
    v_cmp_nge_f32 vcc, s73, v217
    s_cbranch_vccnz L_k1_tr1_0
L_k1_back1_0:
    s_waitcnt lgkmcnt(4)
    v_mfma_f32_16x16x32_bf16 v[0:3], v[176:179], v[192:195], v[0:3]
    v_add_f32 v228, v228, v216
    ds_read_b64_tr_b16 v[188:189], v241 offset:0
    s_add_u32 m0, s69, 139264
    s_nop 0
    buffer_load_dwordx4 v252, s[44:47], s75 offen lds
    v_mfma_f32_16x16x32_bf16 v[4:7], v[176:179], v[200:203], v[4:7]
    v_add_f32 v229, v229, v220
    ds_read_b64_tr_b16 v[190:191], v241 offset:6144
    s_waitcnt lgkmcnt(4)
    v_mfma_f32_16x16x32_bf16 v[8:11], v[180:183], v[192:195], v[8:11]
    ds_read_b64_tr_b16 v[176:177], v238 offset:128
    v_mfma_f32_16x16x32_bf16 v[12:15], v[180:183], v[200:203], v[12:15]
    v_exp_f32 v230, v160
    ds_read_b64_tr_b16 v[178:179], v238 offset:6272
    s_waitcnt lgkmcnt(4)
    v_mfma_f32_16x16x32_bf16 v[16:19], v[184:187], v[192:195], v[16:19]
    v_exp_f32 v231, v161
    ds_read_b64_tr_b16 v[180:181], v239 offset:128
    v_mfma_f32_16x16x32_bf16 v[20:23], v[184:187], v[200:203], v[20:23]
    ds_read_b64_tr_b16 v[182:183], v239 offset:6272
    s_add_u32 m0, s69, 140288
    s_nop 0
    buffer_load_dwordx4 v253, s[44:47], s75 offen lds
    s_waitcnt lgkmcnt(4)
    v_mfma_f32_16x16x32_bf16 v[24:27], v[188:191], v[192:195], v[24:27]
    v_exp_f32 v232, v162
    ds_read_b64_tr_b16 v[184:185], v240 offset:128
    s_add_u32 s36, s26, s81
    s_addc_u32 s37, s27, 0
    s_and_b32 s37, s37, 0xffff
    s_mov_b32 s38, 960
    s_mov_b32 s39, 0x20000
    s_waitcnt vmcnt(2)
    buffer_store_dwordx4 v[244:247], v248, s[36:39], 0 offen sc1
    v_mfma_f32_16x16x32_bf16 v[28:31], v[188:191], v[200:203], v[28:31]
    v_exp_f32 v233, v163
    ds_read_b64_tr_b16 v[186:187], v240 offset:6272
    s_waitcnt lgkmcnt(4)
    v_mfma_f32_16x16x32_bf16 v[32:35], v[176:179], v[192:195], v[32:35]
    ds_read_b64_tr_b16 v[188:189], v241 offset:128
    v_mfma_f32_16x16x32_bf16 v[36:39], v[176:179], v[200:203], v[36:39]
    v_exp_f32 v234, v164
    ds_read_b64_tr_b16 v[190:191], v241 offset:6272
    s_add_u32 m0, s69, 141312
    s_nop 0
    buffer_load_dwordx4 v254, s[44:47], s75 offen lds
    s_waitcnt lgkmcnt(4)
    v_mfma_f32_16x16x32_bf16 v[40:43], v[180:183], v[192:195], v[40:43]
    v_cvt_pk_bf16_f32 v196, v230, v231
    ds_read_b64_tr_b16 v[176:177], v238 offset:256
    v_mfma_f32_16x16x32_bf16 v[44:47], v[180:183], v[200:203], v[44:47]
    ds_read_b64_tr_b16 v[178:179], v238 offset:6400
    s_waitcnt lgkmcnt(4)
    v_mfma_f32_16x16x32_bf16 v[48:51], v[184:187], v[192:195], v[48:51]
    v_exp_f32 v235, v165
    ds_read_b64_tr_b16 v[180:181], v239 offset:256
    v_mfma_f32_16x16x32_bf16 v[52:55], v[184:187], v[200:203], v[52:55]
    v_cvt_pk_bf16_f32 v197, v232, v233
    ds_read_b64_tr_b16 v[182:183], v239 offset:6400
    s_waitcnt lgkmcnt(4)
    v_mfma_f32_16x16x32_bf16 v[56:59], v[188:191], v[192:195], v[56:59]
    ds_read_b64_tr_b16 v[184:185], v240 offset:256
    v_mfma_f32_16x16x32_bf16 v[60:63], v[188:191], v[200:203], v[60:63]
    v_exp_f32 v236, v166
    ds_read_b64_tr_b16 v[186:187], v240 offset:6400
    s_waitcnt lgkmcnt(4)
    v_mfma_f32_16x16x32_bf16 v[64:67], v[176:179], v[192:195], v[64:67]
    v_exp_f32 v237, v167
    ds_read_b64_tr_b16 v[188:189], v241 offset:256
    v_mfma_f32_16x16x32_bf16 v[68:71], v[176:179], v[200:203], v[68:71]
    ds_read_b64_tr_b16 v[190:191], v241 offset:6400
    s_barrier
    s_waitcnt lgkmcnt(4)
    v_mfma_f32_16x16x32_bf16 v[72:75], v[180:183], v[192:195], v[72:75]
    v_cvt_pk_bf16_f32 v204, v234, v235
    ds_read_b128 v[176:179], v242 offset:24576
    v_mfma_f32_16x16x32_bf16 v[76:79], v[180:183], v[200:203], v[76:79]
    v_cvt_pk_bf16_f32 v205, v236, v237
    s_waitcnt lgkmcnt(3)
    v_mfma_f32_16x16x32_bf16 v[80:83], v[184:187], v[192:195], v[80:83]
    ds_read_b128 v[180:183], v243 offset:24576
    s_add_u32 s74, s54, 4
    s_and_b32 s74, s74, 7
    s_mul_i32 s74, s74, 24576
    v_mfma_f32_16x16x32_bf16 v[84:87], v[184:187], v[200:203], v[84:87]
    v_exp_f32 v230, v168
    s_waitcnt lgkmcnt(2)
    v_mfma_f32_16x16x32_bf16 v[88:91], v[188:191], v[192:195], v[88:91]
    ds_read_b128 v[184:187], v242 offset:24704
    v_mfma_f32_16x16x32_bf16 v[92:95], v[188:191], v[200:203], v[92:95]
    v_exp_f32 v231, v169
    s_waitcnt lgkmcnt(2)
    v_mfma_f32_16x16x32_bf16 v[144:147], v[176:179], v[96:99], v[208:211]
    v_exp_f32 v232, v170
    ds_read_b128 v[188:191], v243 offset:24704
    s_add_u32 m0, s69, 0
    s_nop 0
    buffer_load_dwordx4 v249, s[40:43], s74 offen lds
    v_mfma_f32_16x16x32_bf16 v[148:151], v[176:179], v[120:123], v[212:215]
    s_waitcnt lgkmcnt(2)
    v_mfma_f32_16x16x32_bf16 v[144:147], v[180:183], v[100:103], v[144:147]
    v_exp_f32 v233, v171
    ds_read_b128 v[176:179], v242 offset:24832
    v_mfma_f32_16x16x32_bf16 v[148:151], v[180:183], v[124:127], v[148:151]
    v_exp_f32 v234, v172
    s_waitcnt lgkmcnt(2)
    v_mfma_f32_16x16x32_bf16 v[144:147], v[184:187], v[104:107], v[144:147]
    ds_read_b128 v[180:183], v243 offset:24832
    v_mfma_f32_16x16x32_bf16 v[148:151], v[184:187], v[128:131], v[148:151]
    v_cvt_pk_bf16_f32 v198, v230, v231
    s_add_u32 m0, s69, 1024
    s_nop 0
    buffer_load_dwordx4 v250, s[40:43], s74 offen lds
    s_waitcnt lgkmcnt(2)
    v_mfma_f32_16x16x32_bf16 v[144:147], v[188:191], v[108:111], v[144:147]
    v_exp_f32 v235, v173
    ds_read_b128 v[184:187], v242 offset:30720
    v_mfma_f32_16x16x32_bf16 v[148:151], v[188:191], v[132:135], v[148:151]
    s_waitcnt lgkmcnt(2)
    v_mfma_f32_16x16x32_bf16 v[144:147], v[176:179], v[112:115], v[144:147]
    v_cvt_pk_bf16_f32 v199, v232, v233
    ds_read_b128 v[188:191], v243 offset:30720
    v_mfma_f32_16x16x32_bf16 v[148:151], v[176:179], v[136:139], v[148:151]
    v_exp_f32 v236, v174
    s_add_u32 m0, s69, 2048
    s_nop 0
    buffer_load_dwordx4 v251, s[40:43], s74 offen lds
    s_waitcnt lgkmcnt(2)
    v_mfma_f32_16x16x32_bf16 v[144:147], v[180:183], v[116:119], v[144:147]
    ds_read_b128 v[176:179], v242 offset:30848
    v_mfma_f32_16x16x32_bf16 v[148:151], v[180:183], v[140:143], v[148:151]
    v_exp_f32 v237, v175
    s_waitcnt lgkmcnt(2)
    v_mfma_f32_16x16x32_bf16 v[152:155], v[184:187], v[96:99], v[208:211]
    v_cvt_pk_bf16_f32 v206, v234, v235
    ds_read_b128 v[180:183], v243 offset:30848
    v_mfma_f32_16x16x32_bf16 v[156:159], v[184:187], v[120:123], v[212:215]
    s_waitcnt lgkmcnt(2)
    v_mfma_f32_16x16x32_bf16 v[152:155], v[188:191], v[100:103], v[152:155]
    v_cvt_pk_bf16_f32 v207, v236, v237
    ds_read_b128 v[184:187], v242 offset:30976
    v_mfma_f32_16x16x32_bf16 v[156:159], v[188:191], v[124:127], v[156:159]
    s_waitcnt lgkmcnt(2)
    v_mfma_f32_16x16x32_bf16 v[152:155], v[176:179], v[104:107], v[152:155]
    ds_read_b128 v[188:191], v243 offset:30976
    s_and_b32 s55, s2, 3
    s_bfe_u32 s97, s2, 0x10002
    s_lshr_b32 s98, s2, 3
    v_mfma_f32_16x16x32_bf16 v[156:159], v[176:179], v[128:131], v[156:159]
    v_mfma_f32_16x16x32_bf16 v[216:219], v[224:227], v[196:199], 0
    s_and_b32 s57, s98, 3
    s_lshr_b32 s56, s98, 2
    v_mfma_f32_16x16x32_bf16 v[220:223], v[224:227], v[204:207], 0
    s_waitcnt lgkmcnt(2)
    v_mfma_f32_16x16x32_bf16 v[152:155], v[180:183], v[108:111], v[152:155]
    ds_read_b64_tr_b16 v[176:177], v238 offset:12288
    s_mul_i32 s64, s56, 6
    s_lshr_b32 s64, s64, 3
    s_mov_b32 s65, s64
    v_mfma_f32_16x16x32_bf16 v[156:159], v[180:183], v[132:135], v[156:159]
    ds_read_b64_tr_b16 v[178:179], v238 offset:18432
    s_waitcnt lgkmcnt(3)
    v_mfma_f32_16x16x32_bf16 v[152:155], v[184:187], v[112:115], v[152:155]
    ds_read_b64_tr_b16 v[180:181], v239 offset:12288
    s_mul_i32 s96, s56, 12
    s_lshr_b32 s96, s96, 3
    v_mfma_f32_16x16x32_bf16 v[156:159], v[184:187], v[136:139], v[156:159]
    ds_read_b64_tr_b16 v[182:183], v239 offset:18432
    s_waitcnt lgkmcnt(4)
    v_mfma_f32_16x16x32_bf16 v[152:155], v[188:191], v[116:119], v[152:155]
    ds_read_b64_tr_b16 v[184:185], v240 offset:12288
    s_lshl_b32 s97, s97, 3
    s_add_u32 s56, s56, s97
    s_lshr_b32 s58, s52, 2
    v_mfma_f32_16x16x32_bf16 v[156:159], v[188:191], v[140:143], v[156:159]
    ds_read_b64_tr_b16 v[186:187], v240 offset:18432
    v_max_f32 v217, v216, v220
    v_cmp_nge_f32 vcc, s73, v217
    s_cbranch_vccnz L_k1_tr1_1
L_k1_back1_1:
    s_waitcnt lgkmcnt(4)
    v_mfma_f32_16x16x32_bf16 v[0:3], v[176:179], v[196:199], v[0:3]
    v_add_f32 v228, v228, v216
    ds_read_b64_tr_b16 v[188:189], v241 offset:12288
    s_and_b32 s97, s52, 3
    s_lshl_b32 s59, s56, 2
    s_add_u32 s59, s59, s97
    v_mfma_f32_16x16x32_bf16 v[4:7], v[176:179], v[204:207], v[4:7]
    v_add_f32 v229, v229, v220
    ds_read_b64_tr_b16 v[190:191], v241 offset:18432
    s_waitcnt lgkmcnt(4)
    v_mfma_f32_16x16x32_bf16 v[8:11], v[180:183], v[196:199], v[8:11]
    ds_read_b64_tr_b16 v[176:177], v238 offset:12416
    s_mul_i32 s61, s52, 5120
    s_lshr_b32 s63, s52, 1
    v_mfma_f32_16x16x32_bf16 v[12:15], v[180:183], v[204:207], v[12:15]
    v_exp_f32 v230, v144
    ds_read_b64_tr_b16 v[178:179], v238 offset:18560
    s_waitcnt lgkmcnt(4)
    v_mfma_f32_16x16x32_bf16 v[16:19], v[184:187], v[196:199], v[16:19]
    v_exp_f32 v231, v145
    ds_read_b64_tr_b16 v[180:181], v239 offset:12416
    s_lshr_b32 s87, s56, 1
    s_lshl_b32 s87, s87, 5
    s_add_u32 s86, s87, 16
    v_mfma_f32_16x16x32_bf16 v[20:23], v[184:187], v[204:207], v[20:23]
    ds_read_b64_tr_b16 v[182:183], v239 offset:18560
    s_waitcnt lgkmcnt(4)
    v_mfma_f32_16x16x32_bf16 v[24:27], v[188:191], v[196:199], v[24:27]
    v_exp_f32 v232, v146
    ds_read_b64_tr_b16 v[184:185], v240 offset:12416
    v_mfma_f32_16x16x32_bf16 v[28:31], v[188:191], v[204:207], v[28:31]
    v_exp_f32 v233, v147
    ds_read_b64_tr_b16 v[186:187], v240 offset:18560
    s_waitcnt lgkmcnt(4)
    v_mfma_f32_16x16x32_bf16 v[32:35], v[176:179], v[196:199], v[32:35]
    ds_read_b64_tr_b16 v[188:189], v241 offset:12416
    v_mfma_f32_16x16x32_bf16 v[36:39], v[176:179], v[204:207], v[36:39]
    v_exp_f32 v234, v148
    ds_read_b64_tr_b16 v[190:191], v241 offset:18560
    s_waitcnt lgkmcnt(4)
    v_mfma_f32_16x16x32_bf16 v[40:43], v[180:183], v[196:199], v[40:43]
    v_cvt_pk_bf16_f32 v192, v230, v231
    ds_read_b64_tr_b16 v[176:177], v238 offset:12544
    v_lshlrev_b32 v245, 3, v248
    v_mov_b32 v247, 0x1000000
    v_cmp_gt_u32 vcc, 1920, v245
    s_lshr_b32 s97, s2, 3
    s_lshl_b32 s97, s97, 3
    v_cndmask_b32 v245, v247, v245, vcc
    s_add_u32 s97, s97, s52
    s_mul_i32 s97, s97, 7680
    s_mul_i32 s98, s55, 1966080
    s_add_u32 s97, s97, s98
    s_add_u32 s36, s12, s97
    s_addc_u32 s37, s13, 0
    s_and_b32 s37, s37, 0xffff
    s_mov_b32 s38, 7680
    s_mov_b32 s39, 0x20000
    v_mfma_f32_16x16x32_bf16 v[44:47], v[180:183], v[204:207], v[44:47]
    ds_read_b64_tr_b16 v[178:179], v238 offset:18688
    s_waitcnt lgkmcnt(4)
    v_mfma_f32_16x16x32_bf16 v[48:51], v[184:187], v[196:199], v[48:51]
    v_exp_f32 v235, v149
    ds_read_b64_tr_b16 v[180:181], v239 offset:12544
    s_mov_b32 s81, 3840
    v_mfma_f32_16x16x32_bf16 v[52:55], v[184:187], v[204:207], v[52:55]
    v_cvt_pk_bf16_f32 v193, v232, v233
    ds_read_b64_tr_b16 v[182:183], v239 offset:18688
    s_waitcnt lgkmcnt(4)
    v_mfma_f32_16x16x32_bf16 v[56:59], v[188:191], v[196:199], v[56:59]
    ds_read_b64_tr_b16 v[184:185], v240 offset:12544
    v_mfma_f32_16x16x32_bf16 v[60:63], v[188:191], v[204:207], v[60:63]
    v_exp_f32 v236, v150
    ds_read_b64_tr_b16 v[186:187], v240 offset:18688
    s_waitcnt lgkmcnt(4)
    v_mfma_f32_16x16x32_bf16 v[64:67], v[176:179], v[196:199], v[64:67]
    v_exp_f32 v237, v151
    ds_read_b64_tr_b16 v[188:189], v241 offset:12544
    v_mfma_f32_16x16x32_bf16 v[68:71], v[176:179], v[204:207], v[68:71]
    ds_read_b64_tr_b16 v[190:191], v241 offset:18688
    s_waitcnt lgkmcnt(4)
    v_mfma_f32_16x16x32_bf16 v[72:75], v[180:183], v[196:199], v[72:75]
    v_cvt_pk_bf16_f32 v200, v234, v235
    ds_read_b128 v[176:179], v242 offset:36864
    v_mfma_f32_16x16x32_bf16 v[76:79], v[180:183], v[204:207], v[76:79]
    v_cvt_pk_bf16_f32 v201, v236, v237
    s_waitcnt lgkmcnt(3)
    v_mfma_f32_16x16x32_bf16 v[80:83], v[184:187], v[196:199], v[80:83]
    ds_read_b128 v[180:183], v243 offset:36864
    v_mfma_f32_16x16x32_bf16 v[84:87], v[184:187], v[204:207], v[84:87]
    v_exp_f32 v230, v152
    s_waitcnt lgkmcnt(2)
    v_mfma_f32_16x16x32_bf16 v[88:91], v[188:191], v[196:199], v[88:91]
    ds_read_b128 v[184:187], v242 offset:36992
    v_mfma_f32_16x16x32_bf16 v[92:95], v[188:191], v[204:207], v[92:95]
    v_exp_f32 v231, v153
    s_waitcnt lgkmcnt(2)
    v_mfma_f32_16x16x32_bf16 v[160:163], v[176:179], v[96:99], v[208:211]
    v_exp_f32 v232, v154
    ds_read_b128 v[188:191], v243 offset:36992
    v_mfma_f32_16x16x32_bf16 v[164:167], v[176:179], v[120:123], v[212:215]
    s_waitcnt lgkmcnt(2)
    v_mfma_f32_16x16x32_bf16 v[160:163], v[180:183], v[100:103], v[160:163]
    v_exp_f32 v233, v155
    ds_read_b128 v[176:179], v242 offset:37120
    v_mfma_f32_16x16x32_bf16 v[164:167], v[180:183], v[124:127], v[164:167]
    v_exp_f32 v234, v156
    s_waitcnt lgkmcnt(2)
    v_mfma_f32_16x16x32_bf16 v[160:163], v[184:187], v[104:107], v[160:163]
    ds_read_b128 v[180:183], v243 offset:37120
    buffer_load_dword v247, v245, s[36:39], 0 offen offset:0
    v_mfma_f32_16x16x32_bf16 v[164:167], v[184:187], v[128:131], v[164:167]
    v_cvt_pk_bf16_f32 v194, v230, v231
    s_waitcnt lgkmcnt(2)
    v_mfma_f32_16x16x32_bf16 v[160:163], v[188:191], v[108:111], v[160:163]
    v_exp_f32 v235, v157
    ds_read_b128 v[184:187], v242 offset:43008
    v_mfma_f32_16x16x32_bf16 v[164:167], v[188:191], v[132:135], v[164:167]
    s_waitcnt lgkmcnt(2)
    v_mfma_f32_16x16x32_bf16 v[160:163], v[176:179], v[112:115], v[160:163]
    v_cvt_pk_bf16_f32 v195, v232, v233
    ds_read_b128 v[188:191], v243 offset:43008
    v_mfma_f32_16x16x32_bf16 v[164:167], v[176:179], v[136:139], v[164:167]
    v_exp_f32 v236, v158
    s_waitcnt lgkmcnt(2)
    v_mfma_f32_16x16x32_bf16 v[160:163], v[180:183], v[116:119], v[160:163]
    ds_read_b128 v[176:179], v242 offset:43136
    v_mfma_f32_16x16x32_bf16 v[164:167], v[180:183], v[140:143], v[164:167]
    v_exp_f32 v237, v159
    s_waitcnt lgkmcnt(2)
    v_mfma_f32_16x16x32_bf16 v[168:171], v[184:187], v[96:99], v[208:211]
    v_cvt_pk_bf16_f32 v202, v234, v235
    ds_read_b128 v[180:183], v243 offset:43136
    v_mfma_f32_16x16x32_bf16 v[172:175], v[184:187], v[120:123], v[212:215]
    s_waitcnt lgkmcnt(2)
    v_mfma_f32_16x16x32_bf16 v[168:171], v[188:191], v[100:103], v[168:171]
    v_cvt_pk_bf16_f32 v203, v236, v237
    ds_read_b128 v[184:187], v242 offset:43264
    v_mfma_f32_16x16x32_bf16 v[172:175], v[188:191], v[124:127], v[172:175]
    s_waitcnt lgkmcnt(2)
    v_mfma_f32_16x16x32_bf16 v[168:171], v[176:179], v[104:107], v[168:171]
    ds_read_b128 v[188:191], v243 offset:43264
    v_mfma_f32_16x16x32_bf16 v[172:175], v[176:179], v[128:131], v[172:175]
    v_mfma_f32_16x16x32_bf16 v[216:219], v[224:227], v[192:195], 0
    v_mfma_f32_16x16x32_bf16 v[220:223], v[224:227], v[200:203], 0
    s_barrier
    s_waitcnt lgkmcnt(2)
    v_mfma_f32_16x16x32_bf16 v[168:171], v[180:183], v[108:111], v[168:171]
    ds_read_b64_tr_b16 v[176:177], v238 offset:24576
    v_mfma_f32_16x16x32_bf16 v[172:175], v[180:183], v[132:135], v[172:175]
    ds_read_b64_tr_b16 v[178:179], v238 offset:30720
    s_waitcnt lgkmcnt(3)
    v_mfma_f32_16x16x32_bf16 v[168:171], v[184:187], v[112:115], v[168:171]
    ds_read_b64_tr_b16 v[180:181], v239 offset:24576
    s_add_u32 s75, s54, 4
    s_and_b32 s75, s75, 7
    s_mul_i32 s75, s75, 24576
    v_mfma_f32_16x16x32_bf16 v[172:175], v[184:187], v[136:139], v[172:175]
    ds_read_b64_tr_b16 v[182:183], v239 offset:30720
    s_waitcnt lgkmcnt(4)
    v_mfma_f32_16x16x32_bf16 v[168:171], v[188:191], v[116:119], v[168:171]
    ds_read_b64_tr_b16 v[184:185], v240 offset:24576
    v_mfma_f32_16x16x32_bf16 v[172:175], v[188:191], v[140:143], v[172:175]
    ds_read_b64_tr_b16 v[186:187], v240 offset:30720
    v_max_f32 v217, v216, v220
    v_cmp_nge_f32 vcc, s73, v217
    s_cbranch_vccnz L_k1_tr2_0
L_k1_back2_0:
    s_waitcnt lgkmcnt(4)
    v_mfma_f32_16x16x32_bf16 v[0:3], v[176:179], v[192:195], v[0:3]
    v_add_f32 v228, v228, v216
    ds_read_b64_tr_b16 v[188:189], v241 offset:24576
    s_add_u32 m0, s69, 49152
    s_nop 0
    buffer_load_dwordx4 v252, s[44:47], s75 offen lds
    v_mfma_f32_16x16x32_bf16 v[4:7], v[176:179], v[200:203], v[4:7]
    v_add_f32 v229, v229, v220
    ds_read_b64_tr_b16 v[190:191], v241 offset:30720
    s_waitcnt lgkmcnt(4)
    v_mfma_f32_16x16x32_bf16 v[8:11], v[180:183], v[192:195], v[8:11]
    ds_read_b64_tr_b16 v[176:177], v238 offset:24704
    v_mfma_f32_16x16x32_bf16 v[12:15], v[180:183], v[200:203], v[12:15]
    v_exp_f32 v230, v160
    ds_read_b64_tr_b16 v[178:179], v238 offset:30848
    s_waitcnt lgkmcnt(4)
    v_mfma_f32_16x16x32_bf16 v[16:19], v[184:187], v[192:195], v[16:19]
    v_exp_f32 v231, v161
    ds_read_b64_tr_b16 v[180:181], v239 offset:24704
    v_mfma_f32_16x16x32_bf16 v[20:23], v[184:187], v[200:203], v[20:23]
    ds_read_b64_tr_b16 v[182:183], v239 offset:30848
    s_add_u32 m0, s69, 50176
    s_nop 0
    buffer_load_dwordx4 v253, s[44:47], s75 offen lds
    s_waitcnt lgkmcnt(4)
    v_mfma_f32_16x16x32_bf16 v[24:27], v[188:191], v[192:195], v[24:27]
    v_exp_f32 v232, v162
    ds_read_b64_tr_b16 v[184:185], v240 offset:24704
    v_mfma_f32_16x16x32_bf16 v[28:31], v[188:191], v[200:203], v[28:31]
    v_exp_f32 v233, v163
    ds_read_b64_tr_b16 v[186:187], v240 offset:30848
    s_waitcnt lgkmcnt(4)
    v_mfma_f32_16x16x32_bf16 v[32:35], v[176:179], v[192:195], v[32:35]
    ds_read_b64_tr_b16 v[188:189], v241 offset:24704
    v_mfma_f32_16x16x32_bf16 v[36:39], v[176:179], v[200:203], v[36:39]
    v_exp_f32 v234, v164
    ds_read_b64_tr_b16 v[190:191], v241 offset:30848
    s_add_u32 m0, s69, 51200
    s_nop 0
    buffer_load_dwordx4 v254, s[44:47], s75 offen lds
    s_waitcnt lgkmcnt(4)
    v_mfma_f32_16x16x32_bf16 v[40:43], v[180:183], v[192:195], v[40:43]
    v_cvt_pk_bf16_f32 v196, v230, v231
    ds_read_b64_tr_b16 v[176:177], v238 offset:24832
    v_mfma_f32_16x16x32_bf16 v[44:47], v[180:183], v[200:203], v[44:47]
    ds_read_b64_tr_b16 v[178:179], v238 offset:30976
    s_waitcnt lgkmcnt(4)
    v_mfma_f32_16x16x32_bf16 v[48:51], v[184:187], v[192:195], v[48:51]
    v_exp_f32 v235, v165
    ds_read_b64_tr_b16 v[180:181], v239 offset:24832
    v_add_u32 v242, 114688, v242
    v_mfma_f32_16x16x32_bf16 v[52:55], v[184:187], v[200:203], v[52:55]
    v_cvt_pk_bf16_f32 v197, v232, v233
    ds_read_b64_tr_b16 v[182:183], v239 offset:30976
    s_waitcnt lgkmcnt(4)
    v_mfma_f32_16x16x32_bf16 v[56:59], v[188:191], v[192:195], v[56:59]
    ds_read_b64_tr_b16 v[184:185], v240 offset:24832
    v_add_u32 v243, 114688, v243
    v_mfma_f32_16x16x32_bf16 v[60:63], v[188:191], v[200:203], v[60:63]
    v_exp_f32 v236, v166
    ds_read_b64_tr_b16 v[186:187], v240 offset:30976
    s_waitcnt lgkmcnt(4)
    v_mfma_f32_16x16x32_bf16 v[64:67], v[176:179], v[192:195], v[64:67]
    v_exp_f32 v237, v167
    ds_read_b64_tr_b16 v[188:189], v241 offset:24832
    v_mfma_f32_16x16x32_bf16 v[68:71], v[176:179], v[200:203], v[68:71]
    ds_read_b64_tr_b16 v[190:191], v241 offset:30976
    s_waitcnt vmcnt(8)
    s_barrier
    v_mov_b32 v244, 0
    v_mov_b32 v246, 1
    s_mov_b64 exec, 1
    buffer_atomic_add v246, v244, s[92:95], s100 offen offset:4 sc0 sc1
    s_mov_b64 exec, -1
    s_waitcnt lgkmcnt(4)
    v_mfma_f32_16x16x32_bf16 v[72:75], v[180:183], v[192:195], v[72:75]
    v_cvt_pk_bf16_f32 v204, v234, v235
    ds_read_b128 v[176:179], v242 offset:0
    v_mfma_f32_16x16x32_bf16 v[76:79], v[180:183], v[200:203], v[76:79]
    v_cvt_pk_bf16_f32 v205, v236, v237
    s_waitcnt lgkmcnt(3)
    v_mfma_f32_16x16x32_bf16 v[80:83], v[184:187], v[192:195], v[80:83]
    ds_read_b128 v[180:183], v243 offset:0
    s_add_u32 s74, s54, 5
    s_and_b32 s74, s74, 7
    s_mul_i32 s74, s74, 24576
    v_mfma_f32_16x16x32_bf16 v[84:87], v[184:187], v[200:203], v[84:87]
    v_exp_f32 v230, v168
    s_waitcnt lgkmcnt(2)
    v_mfma_f32_16x16x32_bf16 v[88:91], v[188:191], v[192:195], v[88:91]
    ds_read_b128 v[184:187], v242 offset:128
    v_mfma_f32_16x16x32_bf16 v[92:95], v[188:191], v[200:203], v[92:95]
    v_exp_f32 v231, v169
    s_waitcnt lgkmcnt(2)
    v_mfma_f32_16x16x32_bf16 v[144:147], v[176:179], v[96:99], v[208:211]
    v_exp_f32 v232, v170
    ds_read_b128 v[188:191], v243 offset:128
    s_add_u32 m0, s69, 24576
    s_nop 0
    buffer_load_dwordx4 v249, s[40:43], s74 offen lds
    v_mfma_f32_16x16x32_bf16 v[148:151], v[176:179], v[120:123], v[212:215]
    s_waitcnt lgkmcnt(2)
    v_mfma_f32_16x16x32_bf16 v[144:147], v[180:183], v[100:103], v[144:147]
    v_exp_f32 v233, v171
    ds_read_b128 v[176:179], v242 offset:256
    v_mfma_f32_16x16x32_bf16 v[148:151], v[180:183], v[124:127], v[148:151]
    v_exp_f32 v234, v172
    s_waitcnt lgkmcnt(2)
    v_mfma_f32_16x16x32_bf16 v[144:147], v[184:187], v[104:107], v[144:147]
    ds_read_b128 v[180:183], v243 offset:256
    v_mfma_f32_16x16x32_bf16 v[148:151], v[184:187], v[128:131], v[148:151]
    v_cvt_pk_bf16_f32 v198, v230, v231
    s_add_u32 m0, s69, 25600
    s_nop 0
    buffer_load_dwordx4 v250, s[40:43], s74 offen lds
    s_waitcnt lgkmcnt(2)
    v_mfma_f32_16x16x32_bf16 v[144:147], v[188:191], v[108:111], v[144:147]
    v_exp_f32 v235, v173
    ds_read_b128 v[184:187], v242 offset:6144
    v_mfma_f32_16x16x32_bf16 v[148:151], v[188:191], v[132:135], v[148:151]
    s_waitcnt lgkmcnt(2)
    v_mfma_f32_16x16x32_bf16 v[144:147], v[176:179], v[112:115], v[144:147]
    v_cvt_pk_bf16_f32 v199, v232, v233
    ds_read_b128 v[188:191], v243 offset:6144
    v_mfma_f32_16x16x32_bf16 v[148:151], v[176:179], v[136:139], v[148:151]
    v_exp_f32 v236, v174
    s_add_u32 m0, s69, 26624
    s_nop 0
    buffer_load_dwordx4 v251, s[40:43], s74 offen lds
    s_waitcnt lgkmcnt(2)
    v_mfma_f32_16x16x32_bf16 v[144:147], v[180:183], v[116:119], v[144:147]
    ds_read_b128 v[176:179], v242 offset:6272
    v_mfma_f32_16x16x32_bf16 v[148:151], v[180:183], v[140:143], v[148:151]
    v_exp_f32 v237, v175
    s_waitcnt lgkmcnt(2)
    v_mfma_f32_16x16x32_bf16 v[152:155], v[184:187], v[96:99], v[208:211]
    v_cvt_pk_bf16_f32 v206, v234, v235
    ds_read_b128 v[180:183], v243 offset:6272
    v_mfma_f32_16x16x32_bf16 v[156:159], v[184:187], v[120:123], v[212:215]
    s_waitcnt lgkmcnt(2)
    v_mfma_f32_16x16x32_bf16 v[152:155], v[188:191], v[100:103], v[152:155]
    v_cvt_pk_bf16_f32 v207, v236, v237
    ds_read_b128 v[184:187], v242 offset:6400
    v_mfma_f32_16x16x32_bf16 v[156:159], v[188:191], v[124:127], v[156:159]
    s_waitcnt lgkmcnt(2)
    v_mfma_f32_16x16x32_bf16 v[152:155], v[176:179], v[104:107], v[152:155]
    ds_read_b128 v[188:191], v243 offset:6400
    v_mfma_f32_16x16x32_bf16 v[156:159], v[176:179], v[128:131], v[156:159]
    v_mfma_f32_16x16x32_bf16 v[216:219], v[224:227], v[196:199], 0
    s_mul_i32 s80, s63, 61440
    s_and_b32 s97, s52, 1
    s_mul_i32 s97, s97, 5120
    s_add_u32 s80, s80, s97
    s_mul_i32 s79, s63, 12288
    s_add_u32 s79, s79, 196608
    v_mfma_f32_16x16x32_bf16 v[220:223], v[224:227], v[204:207], 0
    s_waitcnt lgkmcnt(2)
    v_mfma_f32_16x16x32_bf16 v[152:155], v[180:183], v[108:111], v[152:155]
    ds_read_b64_tr_b16 v[176:177], v238 offset:36864
    v_mfma_f32_16x16x32_bf16 v[156:159], v[180:183], v[132:135], v[156:159]
    ds_read_b64_tr_b16 v[178:179], v238 offset:43008
    s_waitcnt lgkmcnt(3)
    v_mfma_f32_16x16x32_bf16 v[152:155], v[184:187], v[112:115], v[152:155]
    ds_read_b64_tr_b16 v[180:181], v239 offset:36864
    v_mfma_f32_16x16x32_bf16 v[156:159], v[184:187], v[136:139], v[156:159]
    ds_read_b64_tr_b16 v[182:183], v239 offset:43008
    s_lshl_b32 s98, s57, 1
    s_and_b32 s97, s55, 1
    s_add_u32 s98, s98, s97
    s_mul_i32 s98, s98, 245760
    s_add_u32 s98, s98, 55115776
    s_add_u32 s32, s26, s98
    s_addc_u32 s33, s27, 0
    s_and_b32 s33, s33, 0xffff
    s_mov_b32 s34, 245760
    s_mov_b32 s35, 0x20000
    s_waitcnt lgkmcnt(4)
    v_mfma_f32_16x16x32_bf16 v[152:155], v[188:191], v[116:119], v[152:155]
    ds_read_b64_tr_b16 v[184:185], v240 offset:36864
    v_mfma_f32_16x16x32_bf16 v[156:159], v[188:191], v[140:143], v[156:159]
    ds_read_b64_tr_b16 v[186:187], v240 offset:43008
    v_max_f32 v217, v216, v220
    v_cmp_nge_f32 vcc, s73, v217
    s_cbranch_vccnz L_k1_tr2_1
L_k1_back2_1:
    s_waitcnt lgkmcnt(4)
    v_mfma_f32_16x16x32_bf16 v[0:3], v[176:179], v[196:199], v[0:3]
    v_add_f32 v228, v228, v216
    ds_read_b64_tr_b16 v[188:189], v241 offset:36864
    v_mfma_f32_16x16x32_bf16 v[4:7], v[176:179], v[204:207], v[4:7]
    v_add_f32 v229, v229, v220
    ds_read_b64_tr_b16 v[190:191], v241 offset:43008
    s_waitcnt lgkmcnt(4)
    v_mfma_f32_16x16x32_bf16 v[8:11], v[180:183], v[196:199], v[8:11]
    ds_read_b64_tr_b16 v[176:177], v238 offset:36992
    s_lshl_b32 s98, s56, 2
    s_and_b32 s97, s55, 2
    s_add_u32 s98, s98, s97
    s_and_b32 s97, s52, 1
    s_add_u32 s98, s98, s97
    s_mul_i32 s98, s98, 491520
    s_add_u32 s28, s26, s98
    s_addc_u32 s29, s27, 0
    s_and_b32 s29, s29, 0xffff
    s_mov_b32 s30, 491520
    s_mov_b32 s31, 0x20000
    v_mfma_f32_16x16x32_bf16 v[12:15], v[180:183], v[204:207], v[12:15]
    v_exp_f32 v230, v144
    ds_read_b64_tr_b16 v[178:179], v238 offset:43136
    s_waitcnt lgkmcnt(4)
    v_mfma_f32_16x16x32_bf16 v[16:19], v[184:187], v[196:199], v[16:19]
    v_exp_f32 v231, v145
    ds_read_b64_tr_b16 v[180:181], v239 offset:36992
    v_mfma_f32_16x16x32_bf16 v[20:23], v[184:187], v[204:207], v[20:23]
    ds_read_b64_tr_b16 v[182:183], v239 offset:43136
    s_waitcnt lgkmcnt(4)
    v_mfma_f32_16x16x32_bf16 v[24:27], v[188:191], v[196:199], v[24:27]
    v_exp_f32 v232, v146
    ds_read_b64_tr_b16 v[184:185], v240 offset:36992
    v_mfma_f32_16x16x32_bf16 v[28:31], v[188:191], v[204:207], v[28:31]
    v_exp_f32 v233, v147
    ds_read_b64_tr_b16 v[186:187], v240 offset:43136
    s_waitcnt lgkmcnt(4)
    v_mfma_f32_16x16x32_bf16 v[32:35], v[176:179], v[196:199], v[32:35]
    ds_read_b64_tr_b16 v[188:189], v241 offset:36992
    v_mfma_f32_16x16x32_bf16 v[36:39], v[176:179], v[204:207], v[36:39]
    v_exp_f32 v234, v148
    ds_read_b64_tr_b16 v[190:191], v241 offset:43136
    s_waitcnt lgkmcnt(4)
    v_mfma_f32_16x16x32_bf16 v[40:43], v[180:183], v[196:199], v[40:43]
    v_cvt_pk_bf16_f32 v192, v230, v231
    ds_read_b64_tr_b16 v[176:177], v238 offset:37120
    v_mfma_f32_16x16x32_bf16 v[44:47], v[180:183], v[204:207], v[44:47]
    ds_read_b64_tr_b16 v[178:179], v238 offset:43264
    s_waitcnt lgkmcnt(4)
    v_mfma_f32_16x16x32_bf16 v[48:51], v[184:187], v[196:199], v[48:51]
    v_exp_f32 v235, v149
    ds_read_b64_tr_b16 v[180:181], v239 offset:37120
    v_mfma_f32_16x16x32_bf16 v[52:55], v[184:187], v[204:207], v[52:55]
    v_cvt_pk_bf16_f32 v193, v232, v233
    ds_read_b64_tr_b16 v[182:183], v239 offset:43264
    s_waitcnt lgkmcnt(4)
    v_mfma_f32_16x16x32_bf16 v[56:59], v[188:191], v[196:199], v[56:59]
    ds_read_b64_tr_b16 v[184:185], v240 offset:37120
    v_mfma_f32_16x16x32_bf16 v[60:63], v[188:191], v[204:207], v[60:63]
    v_exp_f32 v236, v150
    ds_read_b64_tr_b16 v[186:187], v240 offset:43264
    s_waitcnt lgkmcnt(4)
    v_mfma_f32_16x16x32_bf16 v[64:67], v[176:179], v[196:199], v[64:67]
    v_exp_f32 v237, v151
    ds_read_b64_tr_b16 v[188:189], v241 offset:37120
    v_mfma_f32_16x16x32_bf16 v[68:71], v[176:179], v[204:207], v[68:71]
    ds_read_b64_tr_b16 v[190:191], v241 offset:43264
    s_waitcnt lgkmcnt(4)
    v_mfma_f32_16x16x32_bf16 v[72:75], v[180:183], v[196:199], v[72:75]
    v_cvt_pk_bf16_f32 v200, v234, v235
    ds_read_b128 v[176:179], v242 offset:12288
    v_mfma_f32_16x16x32_bf16 v[76:79], v[180:183], v[204:207], v[76:79]
    v_cvt_pk_bf16_f32 v201, v236, v237
    s_waitcnt lgkmcnt(3)
    v_mfma_f32_16x16x32_bf16 v[80:83], v[184:187], v[196:199], v[80:83]
    ds_read_b128 v[180:183], v243 offset:12288
    v_mfma_f32_16x16x32_bf16 v[84:87], v[184:187], v[204:207], v[84:87]
    v_exp_f32 v230, v152
    s_waitcnt lgkmcnt(2)
    v_mfma_f32_16x16x32_bf16 v[88:91], v[188:191], v[196:199], v[88:91]
    ds_read_b128 v[184:187], v242 offset:12416
    v_mfma_f32_16x16x32_bf16 v[92:95], v[188:191], v[204:207], v[92:95]
    v_exp_f32 v231, v153
    s_waitcnt lgkmcnt(2)
    v_mfma_f32_16x16x32_bf16 v[160:163], v[176:179], v[96:99], v[208:211]
    v_exp_f32 v232, v154
    ds_read_b128 v[188:191], v243 offset:12416
    v_mfma_f32_16x16x32_bf16 v[164:167], v[176:179], v[120:123], v[212:215]
    s_waitcnt lgkmcnt(2)
    v_mfma_f32_16x16x32_bf16 v[160:163], v[180:183], v[100:103], v[160:163]
    v_exp_f32 v233, v155
    ds_read_b128 v[176:179], v242 offset:12544
    v_mfma_f32_16x16x32_bf16 v[164:167], v[180:183], v[124:127], v[164:167]
    v_exp_f32 v234, v156
    s_waitcnt lgkmcnt(2)
    v_mfma_f32_16x16x32_bf16 v[160:163], v[184:187], v[104:107], v[160:163]
    ds_read_b128 v[180:183], v243 offset:12544
    buffer_load_dword v247, v245, s[36:39], 0 offen offset:1920
    v_mfma_f32_16x16x32_bf16 v[164:167], v[184:187], v[128:131], v[164:167]
    v_cvt_pk_bf16_f32 v194, v230, v231
    s_waitcnt lgkmcnt(2)
    v_mfma_f32_16x16x32_bf16 v[160:163], v[188:191], v[108:111], v[160:163]
    v_exp_f32 v235, v157
    ds_read_b128 v[184:187], v242 offset:18432
    v_mfma_f32_16x16x32_bf16 v[164:167], v[188:191], v[132:135], v[164:167]
    s_waitcnt lgkmcnt(2)
    v_mfma_f32_16x16x32_bf16 v[160:163], v[176:179], v[112:115], v[160:163]
    v_cvt_pk_bf16_f32 v195, v232, v233
    ds_read_b128 v[188:191], v243 offset:18432
    v_mfma_f32_16x16x32_bf16 v[164:167], v[176:179], v[136:139], v[164:167]
    v_exp_f32 v236, v158
    s_waitcnt lgkmcnt(2)
    v_mfma_f32_16x16x32_bf16 v[160:163], v[180:183], v[116:119], v[160:163]
    ds_read_b128 v[176:179], v242 offset:18560
    v_mfma_f32_16x16x32_bf16 v[164:167], v[180:183], v[140:143], v[164:167]
    v_exp_f32 v237, v159
    v_add_u32 v238, 90112, v238
    s_waitcnt lgkmcnt(2)
    v_mfma_f32_16x16x32_bf16 v[168:171], v[184:187], v[96:99], v[208:211]
    v_cvt_pk_bf16_f32 v202, v234, v235
    ds_read_b128 v[180:183], v243 offset:18560
    v_mfma_f32_16x16x32_bf16 v[172:175], v[184:187], v[120:123], v[212:215]
    v_add_u32 v239, 90112, v239
    s_waitcnt lgkmcnt(2)
    v_mfma_f32_16x16x32_bf16 v[168:171], v[188:191], v[100:103], v[168:171]
    v_cvt_pk_bf16_f32 v203, v236, v237
    ds_read_b128 v[184:187], v242 offset:18688
    v_mfma_f32_16x16x32_bf16 v[172:175], v[188:191], v[124:127], v[172:175]
    v_add_u32 v240, 90112, v240
    s_waitcnt lgkmcnt(2)
    v_mfma_f32_16x16x32_bf16 v[168:171], v[176:179], v[104:107], v[168:171]
    ds_read_b128 v[188:191], v243 offset:18688
    v_mfma_f32_16x16x32_bf16 v[172:175], v[176:179], v[128:131], v[172:175]
    v_add_u32 v241, 90112, v241
    v_mfma_f32_16x16x32_bf16 v[216:219], v[224:227], v[192:195], 0
    v_mfma_f32_16x16x32_bf16 v[220:223], v[224:227], v[200:203], 0
    s_waitcnt vmcnt(12)
    s_barrier
    s_waitcnt lgkmcnt(2)
    v_mfma_f32_16x16x32_bf16 v[168:171], v[180:183], v[108:111], v[168:171]
    ds_read_b64_tr_b16 v[176:177], v238 offset:0
    v_mfma_f32_16x16x32_bf16 v[172:175], v[180:183], v[132:135], v[172:175]
    ds_read_b64_tr_b16 v[178:179], v238 offset:6144
    s_waitcnt lgkmcnt(3)
    v_mfma_f32_16x16x32_bf16 v[168:171], v[184:187], v[112:115], v[168:171]
    ds_read_b64_tr_b16 v[180:181], v239 offset:0
    s_add_u32 s75, s54, 5
    s_and_b32 s75, s75, 7
    s_mul_i32 s75, s75, 24576
    v_mfma_f32_16x16x32_bf16 v[172:175], v[184:187], v[136:139], v[172:175]
    ds_read_b64_tr_b16 v[182:183], v239 offset:6144
    s_waitcnt lgkmcnt(4)
    v_mfma_f32_16x16x32_bf16 v[168:171], v[188:191], v[116:119], v[168:171]
    ds_read_b64_tr_b16 v[184:185], v240 offset:0
    v_mfma_f32_16x16x32_bf16 v[172:175], v[188:191], v[140:143], v[172:175]
    ds_read_b64_tr_b16 v[186:187], v240 offset:6144
    v_max_f32 v217, v216, v220
    v_cmp_nge_f32 vcc, s73, v217
    s_cbranch_vccnz L_k1_tr3_0
L_k1_back3_0:
    s_waitcnt lgkmcnt(4)
    v_mfma_f32_16x16x32_bf16 v[0:3], v[176:179], v[192:195], v[0:3]
    v_add_f32 v228, v228, v216
    ds_read_b64_tr_b16 v[188:189], v241 offset:0
    s_add_u32 m0, s69, 73728
    s_nop 0
    buffer_load_dwordx4 v252, s[44:47], s75 offen lds
    v_mfma_f32_16x16x32_bf16 v[4:7], v[176:179], v[200:203], v[4:7]
    v_add_f32 v229, v229, v220
    ds_read_b64_tr_b16 v[190:191], v241 offset:6144
    s_waitcnt lgkmcnt(4)
    v_mfma_f32_16x16x32_bf16 v[8:11], v[180:183], v[192:195], v[8:11]
    ds_read_b64_tr_b16 v[176:177], v238 offset:128
    v_mfma_f32_16x16x32_bf16 v[12:15], v[180:183], v[200:203], v[12:15]
    v_exp_f32 v230, v160
    ds_read_b64_tr_b16 v[178:179], v238 offset:6272
    s_waitcnt lgkmcnt(4)
    v_mfma_f32_16x16x32_bf16 v[16:19], v[184:187], v[192:195], v[16:19]
    v_exp_f32 v231, v161
    ds_read_b64_tr_b16 v[180:181], v239 offset:128
    v_mfma_f32_16x16x32_bf16 v[20:23], v[184:187], v[200:203], v[20:23]
    ds_read_b64_tr_b16 v[182:183], v239 offset:6272
    s_add_u32 m0, s69, 74752
    s_nop 0
    buffer_load_dwordx4 v253, s[44:47], s75 offen lds
    s_waitcnt lgkmcnt(4)
    v_mfma_f32_16x16x32_bf16 v[24:27], v[188:191], v[192:195], v[24:27]
    v_exp_f32 v232, v162
    ds_read_b64_tr_b16 v[184:185], v240 offset:128
    v_mfma_f32_16x16x32_bf16 v[28:31], v[188:191], v[200:203], v[28:31]
    v_exp_f32 v233, v163
    ds_read_b64_tr_b16 v[186:187], v240 offset:6272
    s_waitcnt lgkmcnt(4)
    v_mfma_f32_16x16x32_bf16 v[32:35], v[176:179], v[192:195], v[32:35]
    ds_read_b64_tr_b16 v[188:189], v241 offset:128
    v_mfma_f32_16x16x32_bf16 v[36:39], v[176:179], v[200:203], v[36:39]
    v_exp_f32 v234, v164
    ds_read_b64_tr_b16 v[190:191], v241 offset:6272
    s_add_u32 m0, s69, 75776
    s_nop 0
    buffer_load_dwordx4 v254, s[44:47], s75 offen lds
    s_waitcnt lgkmcnt(4)
    v_mfma_f32_16x16x32_bf16 v[40:43], v[180:183], v[192:195], v[40:43]
    v_cvt_pk_bf16_f32 v196, v230, v231
    ds_read_b64_tr_b16 v[176:177], v238 offset:256
    v_mfma_f32_16x16x32_bf16 v[44:47], v[180:183], v[200:203], v[44:47]
    ds_read_b64_tr_b16 v[178:179], v238 offset:6400
    s_waitcnt lgkmcnt(4)
    v_mfma_f32_16x16x32_bf16 v[48:51], v[184:187], v[192:195], v[48:51]
    v_exp_f32 v235, v165
    ds_read_b64_tr_b16 v[180:181], v239 offset:256
    v_add_u32 v242, 4294852608, v242
    v_mfma_f32_16x16x32_bf16 v[52:55], v[184:187], v[200:203], v[52:55]
    v_cvt_pk_bf16_f32 v197, v232, v233
    ds_read_b64_tr_b16 v[182:183], v239 offset:6400
    s_waitcnt lgkmcnt(4)
    v_mfma_f32_16x16x32_bf16 v[56:59], v[188:191], v[192:195], v[56:59]
    ds_read_b64_tr_b16 v[184:185], v240 offset:256
    v_add_u32 v243, 4294852608, v243
    v_mfma_f32_16x16x32_bf16 v[60:63], v[188:191], v[200:203], v[60:63]
    v_exp_f32 v236, v166
    ds_read_b64_tr_b16 v[186:187], v240 offset:6400
    s_waitcnt lgkmcnt(4)
    v_mfma_f32_16x16x32_bf16 v[64:67], v[176:179], v[192:195], v[64:67]
    v_exp_f32 v237, v167
    ds_read_b64_tr_b16 v[188:189], v241 offset:256
    v_mfma_f32_16x16x32_bf16 v[68:71], v[176:179], v[200:203], v[68:71]
    ds_read_b64_tr_b16 v[190:191], v241 offset:6400
    s_waitcnt vmcnt(12)
    s_barrier
    s_waitcnt lgkmcnt(4)
    v_mfma_f32_16x16x32_bf16 v[72:75], v[180:183], v[192:195], v[72:75]
    v_cvt_pk_bf16_f32 v204, v234, v235
    ds_read_b128 v[176:179], v242 offset:0
    v_mfma_f32_16x16x32_bf16 v[76:79], v[180:183], v[200:203], v[76:79]
    v_cvt_pk_bf16_f32 v205, v236, v237
    s_waitcnt lgkmcnt(3)
    v_mfma_f32_16x16x32_bf16 v[80:83], v[184:187], v[192:195], v[80:83]
    ds_read_b128 v[180:183], v243 offset:0
    s_add_u32 s74, s54, 6
    s_and_b32 s74, s74, 7
    s_mul_i32 s74, s74, 24576
    v_mfma_f32_16x16x32_bf16 v[84:87], v[184:187], v[200:203], v[84:87]
    v_exp_f32 v230, v168
    s_waitcnt lgkmcnt(2)
    v_mfma_f32_16x16x32_bf16 v[88:91], v[188:191], v[192:195], v[88:91]
    ds_read_b128 v[184:187], v242 offset:128
    v_mfma_f32_16x16x32_bf16 v[92:95], v[188:191], v[200:203], v[92:95]
    v_exp_f32 v231, v169
    s_waitcnt lgkmcnt(2)
    v_mfma_f32_16x16x32_bf16 v[144:147], v[176:179], v[96:99], v[208:211]
    v_exp_f32 v232, v170
    ds_read_b128 v[188:191], v243 offset:128
    s_add_u32 m0, s69, 114688
    s_nop 0
    buffer_load_dwordx4 v249, s[40:43], s74 offen lds
    v_mfma_f32_16x16x32_bf16 v[148:151], v[176:179], v[120:123], v[212:215]
    s_waitcnt lgkmcnt(2)
    v_mfma_f32_16x16x32_bf16 v[144:147], v[180:183], v[100:103], v[144:147]
    v_exp_f32 v233, v171
    ds_read_b128 v[176:179], v242 offset:256
    v_mfma_f32_16x16x32_bf16 v[148:151], v[180:183], v[124:127], v[148:151]
    v_exp_f32 v234, v172
    s_waitcnt lgkmcnt(2)
    v_mfma_f32_16x16x32_bf16 v[144:147], v[184:187], v[104:107], v[144:147]
    ds_read_b128 v[180:183], v243 offset:256
    v_mfma_f32_16x16x32_bf16 v[148:151], v[184:187], v[128:131], v[148:151]
    v_cvt_pk_bf16_f32 v198, v230, v231
    s_add_u32 m0, s69, 115712
    s_nop 0
    buffer_load_dwordx4 v250, s[40:43], s74 offen lds
    s_waitcnt lgkmcnt(2)
    v_mfma_f32_16x16x32_bf16 v[144:147], v[188:191], v[108:111], v[144:147]
    v_exp_f32 v235, v173
    ds_read_b128 v[184:187], v242 offset:6144
    v_mfma_f32_16x16x32_bf16 v[148:151], v[188:191], v[132:135], v[148:151]
    s_waitcnt lgkmcnt(2)
    v_mfma_f32_16x16x32_bf16 v[144:147], v[176:179], v[112:115], v[144:147]
    v_cvt_pk_bf16_f32 v199, v232, v233
    ds_read_b128 v[188:191], v243 offset:6144
    v_mfma_f32_16x16x32_bf16 v[148:151], v[176:179], v[136:139], v[148:151]
    v_exp_f32 v236, v174
    s_add_u32 m0, s69, 116736
    s_nop 0
    buffer_load_dwordx4 v251, s[40:43], s74 offen lds
    s_waitcnt lgkmcnt(2)
    v_mfma_f32_16x16x32_bf16 v[144:147], v[180:183], v[116:119], v[144:147]
    ds_read_b128 v[176:179], v242 offset:6272
    v_mfma_f32_16x16x32_bf16 v[148:151], v[180:183], v[140:143], v[148:151]
    v_exp_f32 v237, v175
    s_waitcnt lgkmcnt(2)
    v_mfma_f32_16x16x32_bf16 v[152:155], v[184:187], v[96:99], v[208:211]
    v_cvt_pk_bf16_f32 v206, v234, v235
    ds_read_b128 v[180:183], v243 offset:6272
    v_mfma_f32_16x16x32_bf16 v[156:159], v[184:187], v[120:123], v[212:215]
    s_waitcnt lgkmcnt(2)
    v_mfma_f32_16x16x32_bf16 v[152:155], v[188:191], v[100:103], v[152:155]
    v_cvt_pk_bf16_f32 v207, v236, v237
    ds_read_b128 v[184:187], v242 offset:6400
    v_mfma_f32_16x16x32_bf16 v[156:159], v[188:191], v[124:127], v[156:159]
    s_waitcnt lgkmcnt(2)
    v_mfma_f32_16x16x32_bf16 v[152:155], v[176:179], v[104:107], v[152:155]
    ds_read_b128 v[188:191], v243 offset:6400
    v_mfma_f32_16x16x32_bf16 v[156:159], v[176:179], v[128:131], v[156:159]
    v_mfma_f32_16x16x32_bf16 v[216:219], v[224:227], v[196:199], 0
    v_mfma_f32_16x16x32_bf16 v[220:223], v[224:227], v[204:207], 0
    s_waitcnt lgkmcnt(2)
    v_mfma_f32_16x16x32_bf16 v[152:155], v[180:183], v[108:111], v[152:155]
    ds_read_b64_tr_b16 v[176:177], v238 offset:12288
    v_mfma_f32_16x16x32_bf16 v[156:159], v[180:183], v[132:135], v[156:159]
    ds_read_b64_tr_b16 v[178:179], v238 offset:18432
    s_waitcnt lgkmcnt(3)
    v_mfma_f32_16x16x32_bf16 v[152:155], v[184:187], v[112:115], v[152:155]
    ds_read_b64_tr_b16 v[180:181], v239 offset:12288
    v_mfma_f32_16x16x32_bf16 v[156:159], v[184:187], v[136:139], v[156:159]
    ds_read_b64_tr_b16 v[182:183], v239 offset:18432
    s_waitcnt lgkmcnt(4)
    v_mfma_f32_16x16x32_bf16 v[152:155], v[188:191], v[116:119], v[152:155]
    ds_read_b64_tr_b16 v[184:185], v240 offset:12288
    v_mfma_f32_16x16x32_bf16 v[156:159], v[188:191], v[140:143], v[156:159]
    ds_read_b64_tr_b16 v[186:187], v240 offset:18432
    v_max_f32 v217, v216, v220
    v_cmp_nge_f32 vcc, s73, v217
    s_cbranch_vccnz L_k1_tr3_1
L_k1_back3_1:
    s_waitcnt lgkmcnt(4)
    v_mfma_f32_16x16x32_bf16 v[0:3], v[176:179], v[196:199], v[0:3]
    v_add_f32 v228, v228, v216
    ds_read_b64_tr_b16 v[188:189], v241 offset:12288
    v_mfma_f32_16x16x32_bf16 v[4:7], v[176:179], v[204:207], v[4:7]
    v_add_f32 v229, v229, v220
    ds_read_b64_tr_b16 v[190:191], v241 offset:18432
    s_waitcnt lgkmcnt(4)
    v_mfma_f32_16x16x32_bf16 v[8:11], v[180:183], v[196:199], v[8:11]
    ds_read_b64_tr_b16 v[176:177], v238 offset:12416
    v_mfma_f32_16x16x32_bf16 v[12:15], v[180:183], v[204:207], v[12:15]
    v_exp_f32 v230, v144
    ds_read_b64_tr_b16 v[178:179], v238 offset:18560
    s_waitcnt lgkmcnt(4)
    v_mfma_f32_16x16x32_bf16 v[16:19], v[184:187], v[196:199], v[16:19]
    v_exp_f32 v231, v145
    ds_read_b64_tr_b16 v[180:181], v239 offset:12416
    v_mfma_f32_16x16x32_bf16 v[20:23], v[184:187], v[204:207], v[20:23]
    ds_read_b64_tr_b16 v[182:183], v239 offset:18560
    s_waitcnt lgkmcnt(4)
    v_mfma_f32_16x16x32_bf16 v[24:27], v[188:191], v[196:199], v[24:27]
    v_exp_f32 v232, v146
    ds_read_b64_tr_b16 v[184:185], v240 offset:12416
    v_mfma_f32_16x16x32_bf16 v[28:31], v[188:191], v[204:207], v[28:31]
    v_exp_f32 v233, v147
    ds_read_b64_tr_b16 v[186:187], v240 offset:18560
    s_waitcnt lgkmcnt(4)
    v_mfma_f32_16x16x32_bf16 v[32:35], v[176:179], v[196:199], v[32:35]
    ds_read_b64_tr_b16 v[188:189], v241 offset:12416
    v_mfma_f32_16x16x32_bf16 v[36:39], v[176:179], v[204:207], v[36:39]
    v_exp_f32 v234, v148
    ds_read_b64_tr_b16 v[190:191], v241 offset:18560
    s_waitcnt lgkmcnt(4)
    v_mfma_f32_16x16x32_bf16 v[40:43], v[180:183], v[196:199], v[40:43]
    v_cvt_pk_bf16_f32 v192, v230, v231
    ds_read_b64_tr_b16 v[176:177], v238 offset:12544
    v_mfma_f32_16x16x32_bf16 v[44:47], v[180:183], v[204:207], v[44:47]
    ds_read_b64_tr_b16 v[178:179], v238 offset:18688
    s_waitcnt lgkmcnt(4)
    v_mfma_f32_16x16x32_bf16 v[48:51], v[184:187], v[196:199], v[48:51]
    v_exp_f32 v235, v149
    ds_read_b64_tr_b16 v[180:181], v239 offset:12544
    v_mfma_f32_16x16x32_bf16 v[52:55], v[184:187], v[204:207], v[52:55]
    v_cvt_pk_bf16_f32 v193, v232, v233
    ds_read_b64_tr_b16 v[182:183], v239 offset:18688
    s_waitcnt lgkmcnt(4)
    v_mfma_f32_16x16x32_bf16 v[56:59], v[188:191], v[196:199], v[56:59]
    ds_read_b64_tr_b16 v[184:185], v240 offset:12544
    v_mfma_f32_16x16x32_bf16 v[60:63], v[188:191], v[204:207], v[60:63]
    v_exp_f32 v236, v150
    ds_read_b64_tr_b16 v[186:187], v240 offset:18688
    s_waitcnt lgkmcnt(4)
    v_mfma_f32_16x16x32_bf16 v[64:67], v[176:179], v[196:199], v[64:67]
    v_exp_f32 v237, v151
    ds_read_b64_tr_b16 v[188:189], v241 offset:12544
    v_mfma_f32_16x16x32_bf16 v[68:71], v[176:179], v[204:207], v[68:71]
    ds_read_b64_tr_b16 v[190:191], v241 offset:18688
    s_waitcnt lgkmcnt(4)
    v_mfma_f32_16x16x32_bf16 v[72:75], v[180:183], v[196:199], v[72:75]
    v_cvt_pk_bf16_f32 v200, v234, v235
    ds_read_b128 v[176:179], v242 offset:12288
    v_mfma_f32_16x16x32_bf16 v[76:79], v[180:183], v[204:207], v[76:79]
    v_cvt_pk_bf16_f32 v201, v236, v237
    s_waitcnt lgkmcnt(3)
    v_mfma_f32_16x16x32_bf16 v[80:83], v[184:187], v[196:199], v[80:83]
    ds_read_b128 v[180:183], v243 offset:12288
    v_mfma_f32_16x16x32_bf16 v[84:87], v[184:187], v[204:207], v[84:87]
    v_exp_f32 v230, v152
    s_waitcnt lgkmcnt(2)
    v_mfma_f32_16x16x32_bf16 v[88:91], v[188:191], v[196:199], v[88:91]
    ds_read_b128 v[184:187], v242 offset:12416
    v_mfma_f32_16x16x32_bf16 v[92:95], v[188:191], v[204:207], v[92:95]
    v_exp_f32 v231, v153
    s_waitcnt lgkmcnt(2)
    v_mfma_f32_16x16x32_bf16 v[160:163], v[176:179], v[96:99], v[208:211]
    v_exp_f32 v232, v154
    ds_read_b128 v[188:191], v243 offset:12416
    v_mfma_f32_16x16x32_bf16 v[164:167], v[176:179], v[120:123], v[212:215]
    s_waitcnt lgkmcnt(2)
    v_mfma_f32_16x16x32_bf16 v[160:163], v[180:183], v[100:103], v[160:163]
    v_exp_f32 v233, v155
    ds_read_b128 v[176:179], v242 offset:12544
    v_mfma_f32_16x16x32_bf16 v[164:167], v[180:183], v[124:127], v[164:167]
    v_exp_f32 v234, v156
    s_waitcnt lgkmcnt(2)
    v_mfma_f32_16x16x32_bf16 v[160:163], v[184:187], v[104:107], v[160:163]
    ds_read_b128 v[180:183], v243 offset:12544
    buffer_load_dword v247, v245, s[36:39], s81 offen offset:0
    v_mfma_f32_16x16x32_bf16 v[164:167], v[184:187], v[128:131], v[164:167]
    v_cvt_pk_bf16_f32 v194, v230, v231
    s_waitcnt lgkmcnt(2)
    v_mfma_f32_16x16x32_bf16 v[160:163], v[188:191], v[108:111], v[160:163]
    v_exp_f32 v235, v157
    ds_read_b128 v[184:187], v242 offset:18432
    v_mfma_f32_16x16x32_bf16 v[164:167], v[188:191], v[132:135], v[164:167]
    s_waitcnt lgkmcnt(2)
    v_mfma_f32_16x16x32_bf16 v[160:163], v[176:179], v[112:115], v[160:163]
    v_cvt_pk_bf16_f32 v195, v232, v233
    ds_read_b128 v[188:191], v243 offset:18432
    v_mfma_f32_16x16x32_bf16 v[164:167], v[176:179], v[136:139], v[164:167]
    v_exp_f32 v236, v158
    s_waitcnt lgkmcnt(2)
    v_mfma_f32_16x16x32_bf16 v[160:163], v[180:183], v[116:119], v[160:163]
    ds_read_b128 v[176:179], v242 offset:18560
    v_mfma_f32_16x16x32_bf16 v[164:167], v[180:183], v[140:143], v[164:167]
    v_exp_f32 v237, v159
    v_add_u32 v238, 4294877184, v238
    s_waitcnt lgkmcnt(2)
    v_mfma_f32_16x16x32_bf16 v[168:171], v[184:187], v[96:99], v[208:211]
    v_cvt_pk_bf16_f32 v202, v234, v235
    ds_read_b128 v[180:183], v243 offset:18560
    v_mfma_f32_16x16x32_bf16 v[172:175], v[184:187], v[120:123], v[212:215]
    v_add_u32 v239, 4294877184, v239
    s_waitcnt lgkmcnt(2)
    v_mfma_f32_16x16x32_bf16 v[168:171], v[188:191], v[100:103], v[168:171]
    v_cvt_pk_bf16_f32 v203, v236, v237
    ds_read_b128 v[184:187], v242 offset:18688
    v_mfma_f32_16x16x32_bf16 v[172:175], v[188:191], v[124:127], v[172:175]
    v_add_u32 v240, 4294877184, v240
    s_waitcnt lgkmcnt(2)
    v_mfma_f32_16x16x32_bf16 v[168:171], v[176:179], v[104:107], v[168:171]
    ds_read_b128 v[188:191], v243 offset:18688
    v_mfma_f32_16x16x32_bf16 v[172:175], v[176:179], v[128:131], v[172:175]
    v_add_u32 v241, 4294877184, v241
    v_mfma_f32_16x16x32_bf16 v[216:219], v[224:227], v[192:195], 0
    v_mfma_f32_16x16x32_bf16 v[220:223], v[224:227], v[200:203], 0
    s_waitcnt vmcnt(12)
    s_barrier
    s_waitcnt lgkmcnt(2)
    v_mfma_f32_16x16x32_bf16 v[168:171], v[180:183], v[108:111], v[168:171]
    ds_read_b64_tr_b16 v[176:177], v238 offset:0
    v_mfma_f32_16x16x32_bf16 v[172:175], v[180:183], v[132:135], v[172:175]
    ds_read_b64_tr_b16 v[178:179], v238 offset:6144
    s_waitcnt lgkmcnt(3)
    v_mfma_f32_16x16x32_bf16 v[168:171], v[184:187], v[112:115], v[168:171]
    ds_read_b64_tr_b16 v[180:181], v239 offset:0
    s_add_u32 s75, s54, 6
    s_and_b32 s75, s75, 7
    s_mul_i32 s75, s75, 24576
    v_mfma_f32_16x16x32_bf16 v[172:175], v[184:187], v[136:139], v[172:175]
    ds_read_b64_tr_b16 v[182:183], v239 offset:6144
    s_waitcnt lgkmcnt(4)
    v_mfma_f32_16x16x32_bf16 v[168:171], v[188:191], v[116:119], v[168:171]
    ds_read_b64_tr_b16 v[184:185], v240 offset:0
    v_mfma_f32_16x16x32_bf16 v[172:175], v[188:191], v[140:143], v[172:175]
    ds_read_b64_tr_b16 v[186:187], v240 offset:6144
    v_max_f32 v217, v216, v220
    v_cmp_nge_f32 vcc, s73, v217
    s_cbranch_vccnz L_k1_tr4_0
L_k1_back4_0:
    s_waitcnt lgkmcnt(4)
    v_mfma_f32_16x16x32_bf16 v[0:3], v[176:179], v[192:195], v[0:3]
    v_add_f32 v228, v228, v216
    ds_read_b64_tr_b16 v[188:189], v241 offset:0
    s_add_u32 m0, s69, 139264
    s_nop 0
    buffer_load_dwordx4 v252, s[44:47], s75 offen lds
    v_mfma_f32_16x16x32_bf16 v[4:7], v[176:179], v[200:203], v[4:7]
    v_add_f32 v229, v229, v220
    ds_read_b64_tr_b16 v[190:191], v241 offset:6144
    s_waitcnt lgkmcnt(4)
    v_mfma_f32_16x16x32_bf16 v[8:11], v[180:183], v[192:195], v[8:11]
    ds_read_b64_tr_b16 v[176:177], v238 offset:128
    v_mfma_f32_16x16x32_bf16 v[12:15], v[180:183], v[200:203], v[12:15]
    v_exp_f32 v230, v160
    ds_read_b64_tr_b16 v[178:179], v238 offset:6272
    s_waitcnt lgkmcnt(4)
    v_mfma_f32_16x16x32_bf16 v[16:19], v[184:187], v[192:195], v[16:19]
    v_exp_f32 v231, v161
    ds_read_b64_tr_b16 v[180:181], v239 offset:128
    v_mfma_f32_16x16x32_bf16 v[20:23], v[184:187], v[200:203], v[20:23]
    ds_read_b64_tr_b16 v[182:183], v239 offset:6272
    s_add_u32 m0, s69, 140288
    s_nop 0
    buffer_load_dwordx4 v253, s[44:47], s75 offen lds
    s_waitcnt lgkmcnt(4)
    v_mfma_f32_16x16x32_bf16 v[24:27], v[188:191], v[192:195], v[24:27]
    v_exp_f32 v232, v162
    ds_read_b64_tr_b16 v[184:185], v240 offset:128
    v_mfma_f32_16x16x32_bf16 v[28:31], v[188:191], v[200:203], v[28:31]
    v_exp_f32 v233, v163
    ds_read_b64_tr_b16 v[186:187], v240 offset:6272
    s_waitcnt lgkmcnt(4)
    v_mfma_f32_16x16x32_bf16 v[32:35], v[176:179], v[192:195], v[32:35]
    ds_read_b64_tr_b16 v[188:189], v241 offset:128
    v_mfma_f32_16x16x32_bf16 v[36:39], v[176:179], v[200:203], v[36:39]
    v_exp_f32 v234, v164
    ds_read_b64_tr_b16 v[190:191], v241 offset:6272
    s_add_u32 m0, s69, 141312
    s_nop 0
    buffer_load_dwordx4 v254, s[44:47], s75 offen lds
    s_waitcnt lgkmcnt(4)
    v_mfma_f32_16x16x32_bf16 v[40:43], v[180:183], v[192:195], v[40:43]
    v_cvt_pk_bf16_f32 v196, v230, v231
    ds_read_b64_tr_b16 v[176:177], v238 offset:256
    v_mfma_f32_16x16x32_bf16 v[44:47], v[180:183], v[200:203], v[44:47]
    ds_read_b64_tr_b16 v[178:179], v238 offset:6400
    s_waitcnt lgkmcnt(4)
    v_mfma_f32_16x16x32_bf16 v[48:51], v[184:187], v[192:195], v[48:51]
    v_exp_f32 v235, v165
    ds_read_b64_tr_b16 v[180:181], v239 offset:256
    v_mfma_f32_16x16x32_bf16 v[52:55], v[184:187], v[200:203], v[52:55]
    v_cvt_pk_bf16_f32 v197, v232, v233
    ds_read_b64_tr_b16 v[182:183], v239 offset:6400
    s_waitcnt lgkmcnt(4)
    v_mfma_f32_16x16x32_bf16 v[56:59], v[188:191], v[192:195], v[56:59]
    ds_read_b64_tr_b16 v[184:185], v240 offset:256
    v_mfma_f32_16x16x32_bf16 v[60:63], v[188:191], v[200:203], v[60:63]
    v_exp_f32 v236, v166
    ds_read_b64_tr_b16 v[186:187], v240 offset:6400
    s_waitcnt lgkmcnt(4)
    v_mfma_f32_16x16x32_bf16 v[64:67], v[176:179], v[192:195], v[64:67]
    v_exp_f32 v237, v167
    ds_read_b64_tr_b16 v[188:189], v241 offset:256
    v_mfma_f32_16x16x32_bf16 v[68:71], v[176:179], v[200:203], v[68:71]
    ds_read_b64_tr_b16 v[190:191], v241 offset:6400
    s_waitcnt vmcnt(11)
    s_barrier
    s_waitcnt lgkmcnt(4)
    v_mfma_f32_16x16x32_bf16 v[72:75], v[180:183], v[192:195], v[72:75]
    v_cvt_pk_bf16_f32 v204, v234, v235
    ds_read_b128 v[176:179], v242 offset:24576
    v_mfma_f32_16x16x32_bf16 v[76:79], v[180:183], v[200:203], v[76:79]
    v_cvt_pk_bf16_f32 v205, v236, v237
    s_waitcnt lgkmcnt(3)
    v_mfma_f32_16x16x32_bf16 v[80:83], v[184:187], v[192:195], v[80:83]
    ds_read_b128 v[180:183], v243 offset:24576
    s_add_u32 s74, s54, 7
    s_and_b32 s74, s74, 7
    s_mul_i32 s74, s74, 24576
    v_mfma_f32_16x16x32_bf16 v[84:87], v[184:187], v[200:203], v[84:87]
    v_exp_f32 v230, v168
    s_waitcnt lgkmcnt(2)
    v_mfma_f32_16x16x32_bf16 v[88:91], v[188:191], v[192:195], v[88:91]
    ds_read_b128 v[184:187], v242 offset:24704
    v_mfma_f32_16x16x32_bf16 v[92:95], v[188:191], v[200:203], v[92:95]
    v_exp_f32 v231, v169
    s_waitcnt lgkmcnt(2)
    v_mfma_f32_16x16x32_bf16 v[144:147], v[176:179], v[96:99], v[208:211]
    v_exp_f32 v232, v170
    ds_read_b128 v[188:191], v243 offset:24704
    s_add_u32 m0, s69, 0
    s_nop 0
    buffer_load_dwordx4 v249, s[40:43], s74 offen lds
    v_mfma_f32_16x16x32_bf16 v[148:151], v[176:179], v[120:123], v[212:215]
    s_waitcnt lgkmcnt(2)
    v_mfma_f32_16x16x32_bf16 v[144:147], v[180:183], v[100:103], v[144:147]
    v_exp_f32 v233, v171
    ds_read_b128 v[176:179], v242 offset:24832
    v_mfma_f32_16x16x32_bf16 v[148:151], v[180:183], v[124:127], v[148:151]
    v_exp_f32 v234, v172
    s_waitcnt lgkmcnt(2)
    v_mfma_f32_16x16x32_bf16 v[144:147], v[184:187], v[104:107], v[144:147]
    ds_read_b128 v[180:183], v243 offset:24832
    v_mfma_f32_16x16x32_bf16 v[148:151], v[184:187], v[128:131], v[148:151]
    v_cvt_pk_bf16_f32 v198, v230, v231
    s_add_u32 m0, s69, 1024
    s_nop 0
    buffer_load_dwordx4 v250, s[40:43], s74 offen lds
    s_waitcnt lgkmcnt(2)
    v_mfma_f32_16x16x32_bf16 v[144:147], v[188:191], v[108:111], v[144:147]
    v_exp_f32 v235, v173
    ds_read_b128 v[184:187], v242 offset:30720
    v_mfma_f32_16x16x32_bf16 v[148:151], v[188:191], v[132:135], v[148:151]
    s_waitcnt lgkmcnt(2)
    v_mfma_f32_16x16x32_bf16 v[144:147], v[176:179], v[112:115], v[144:147]
    v_cvt_pk_bf16_f32 v199, v232, v233
    ds_read_b128 v[188:191], v243 offset:30720
    v_mfma_f32_16x16x32_bf16 v[148:151], v[176:179], v[136:139], v[148:151]
    v_exp_f32 v236, v174
    s_add_u32 m0, s69, 2048
    s_nop 0
    buffer_load_dwordx4 v251, s[40:43], s74 offen lds
    s_waitcnt lgkmcnt(2)
    v_mfma_f32_16x16x32_bf16 v[144:147], v[180:183], v[116:119], v[144:147]
    ds_read_b128 v[176:179], v242 offset:30848
    v_mfma_f32_16x16x32_bf16 v[148:151], v[180:183], v[140:143], v[148:151]
    v_exp_f32 v237, v175
    s_waitcnt lgkmcnt(2)
    v_mfma_f32_16x16x32_bf16 v[152:155], v[184:187], v[96:99], v[208:211]
    v_cvt_pk_bf16_f32 v206, v234, v235
    ds_read_b128 v[180:183], v243 offset:30848
    v_mfma_f32_16x16x32_bf16 v[156:159], v[184:187], v[120:123], v[212:215]
    s_waitcnt lgkmcnt(2)
    v_mfma_f32_16x16x32_bf16 v[152:155], v[188:191], v[100:103], v[152:155]
    v_cvt_pk_bf16_f32 v207, v236, v237
    ds_read_b128 v[184:187], v242 offset:30976
    v_mfma_f32_16x16x32_bf16 v[156:159], v[188:191], v[124:127], v[156:159]
    s_waitcnt lgkmcnt(2)
    v_mfma_f32_16x16x32_bf16 v[152:155], v[176:179], v[104:107], v[152:155]
    ds_read_b128 v[188:191], v243 offset:30976
    v_mfma_f32_16x16x32_bf16 v[156:159], v[176:179], v[128:131], v[156:159]
    v_mfma_f32_16x16x32_bf16 v[216:219], v[224:227], v[196:199], 0
    v_mfma_f32_16x16x32_bf16 v[220:223], v[224:227], v[204:207], 0
    s_waitcnt lgkmcnt(2)
    v_mfma_f32_16x16x32_bf16 v[152:155], v[180:183], v[108:111], v[152:155]
    ds_read_b64_tr_b16 v[176:177], v238 offset:12288
    v_mfma_f32_16x16x32_bf16 v[156:159], v[180:183], v[132:135], v[156:159]
    ds_read_b64_tr_b16 v[178:179], v238 offset:18432
    s_waitcnt lgkmcnt(3)
    v_mfma_f32_16x16x32_bf16 v[152:155], v[184:187], v[112:115], v[152:155]
    ds_read_b64_tr_b16 v[180:181], v239 offset:12288
    v_mfma_f32_16x16x32_bf16 v[156:159], v[184:187], v[136:139], v[156:159]
    ds_read_b64_tr_b16 v[182:183], v239 offset:18432
    s_waitcnt lgkmcnt(4)
    v_mfma_f32_16x16x32_bf16 v[152:155], v[188:191], v[116:119], v[152:155]
    ds_read_b64_tr_b16 v[184:185], v240 offset:12288
    v_mfma_f32_16x16x32_bf16 v[156:159], v[188:191], v[140:143], v[156:159]
    ds_read_b64_tr_b16 v[186:187], v240 offset:18432
    v_max_f32 v217, v216, v220
    v_cmp_nge_f32 vcc, s73, v217
    s_cbranch_vccnz L_k1_tr4_1
L_k1_back4_1:
    s_waitcnt lgkmcnt(4)
    v_mfma_f32_16x16x32_bf16 v[0:3], v[176:179], v[196:199], v[0:3]
    v_add_f32 v228, v228, v216
    ds_read_b64_tr_b16 v[188:189], v241 offset:12288
    v_mfma_f32_16x16x32_bf16 v[4:7], v[176:179], v[204:207], v[4:7]
    v_add_f32 v229, v229, v220
    ds_read_b64_tr_b16 v[190:191], v241 offset:18432
    s_waitcnt lgkmcnt(4)
    v_mfma_f32_16x16x32_bf16 v[8:11], v[180:183], v[196:199], v[8:11]
    ds_read_b64_tr_b16 v[176:177], v238 offset:12416
    v_mfma_f32_16x16x32_bf16 v[12:15], v[180:183], v[204:207], v[12:15]
    v_exp_f32 v230, v144
    ds_read_b64_tr_b16 v[178:179], v238 offset:18560
    s_waitcnt lgkmcnt(4)
    v_mfma_f32_16x16x32_bf16 v[16:19], v[184:187], v[196:199], v[16:19]
    v_exp_f32 v231, v145
    ds_read_b64_tr_b16 v[180:181], v239 offset:12416
    v_mfma_f32_16x16x32_bf16 v[20:23], v[184:187], v[204:207], v[20:23]
    ds_read_b64_tr_b16 v[182:183], v239 offset:18560
    s_waitcnt lgkmcnt(4)
    v_mfma_f32_16x16x32_bf16 v[24:27], v[188:191], v[196:199], v[24:27]
    v_exp_f32 v232, v146
    ds_read_b64_tr_b16 v[184:185], v240 offset:12416
    v_mfma_f32_16x16x32_bf16 v[28:31], v[188:191], v[204:207], v[28:31]
    v_exp_f32 v233, v147
    ds_read_b64_tr_b16 v[186:187], v240 offset:18560
    s_waitcnt lgkmcnt(4)
    v_mfma_f32_16x16x32_bf16 v[32:35], v[176:179], v[196:199], v[32:35]
    ds_read_b64_tr_b16 v[188:189], v241 offset:12416
    v_mfma_f32_16x16x32_bf16 v[36:39], v[176:179], v[204:207], v[36:39]
    v_exp_f32 v234, v148
    ds_read_b64_tr_b16 v[190:191], v241 offset:18560
    s_waitcnt lgkmcnt(4)
    v_mfma_f32_16x16x32_bf16 v[40:43], v[180:183], v[196:199], v[40:43]
    v_cvt_pk_bf16_f32 v192, v230, v231
    ds_read_b64_tr_b16 v[176:177], v238 offset:12544
    v_mfma_f32_16x16x32_bf16 v[44:47], v[180:183], v[204:207], v[44:47]
    ds_read_b64_tr_b16 v[178:179], v238 offset:18688
    s_waitcnt lgkmcnt(4)
    v_mfma_f32_16x16x32_bf16 v[48:51], v[184:187], v[196:199], v[48:51]
    v_exp_f32 v235, v149
    ds_read_b64_tr_b16 v[180:181], v239 offset:12544
    v_mfma_f32_16x16x32_bf16 v[52:55], v[184:187], v[204:207], v[52:55]
    v_cvt_pk_bf16_f32 v193, v232, v233
    ds_read_b64_tr_b16 v[182:183], v239 offset:18688
    s_waitcnt lgkmcnt(4)
    v_mfma_f32_16x16x32_bf16 v[56:59], v[188:191], v[196:199], v[56:59]
    ds_read_b64_tr_b16 v[184:185], v240 offset:12544
    v_mfma_f32_16x16x32_bf16 v[60:63], v[188:191], v[204:207], v[60:63]
    v_exp_f32 v236, v150
    ds_read_b64_tr_b16 v[186:187], v240 offset:18688
    s_waitcnt lgkmcnt(4)
    v_mfma_f32_16x16x32_bf16 v[64:67], v[176:179], v[196:199], v[64:67]
    v_exp_f32 v237, v151
    ds_read_b64_tr_b16 v[188:189], v241 offset:12544
    v_mfma_f32_16x16x32_bf16 v[68:71], v[176:179], v[204:207], v[68:71]
    ds_read_b64_tr_b16 v[190:191], v241 offset:18688
    s_waitcnt lgkmcnt(4)
    v_mfma_f32_16x16x32_bf16 v[72:75], v[180:183], v[196:199], v[72:75]
    v_cvt_pk_bf16_f32 v200, v234, v235
    ds_read_b128 v[176:179], v242 offset:36864
    v_mfma_f32_16x16x32_bf16 v[76:79], v[180:183], v[204:207], v[76:79]
    v_cvt_pk_bf16_f32 v201, v236, v237
    s_waitcnt lgkmcnt(3)
    v_mfma_f32_16x16x32_bf16 v[80:83], v[184:187], v[196:199], v[80:83]
    ds_read_b128 v[180:183], v243 offset:36864
    v_mfma_f32_16x16x32_bf16 v[84:87], v[184:187], v[204:207], v[84:87]
    v_exp_f32 v230, v152
    s_waitcnt lgkmcnt(2)
    v_mfma_f32_16x16x32_bf16 v[88:91], v[188:191], v[196:199], v[88:91]
    ds_read_b128 v[184:187], v242 offset:36992
    v_mfma_f32_16x16x32_bf16 v[92:95], v[188:191], v[204:207], v[92:95]
    v_exp_f32 v231, v153
    s_waitcnt lgkmcnt(2)
    v_mfma_f32_16x16x32_bf16 v[160:163], v[176:179], v[96:99], v[208:211]
    v_exp_f32 v232, v154
    ds_read_b128 v[188:191], v243 offset:36992
    v_mfma_f32_16x16x32_bf16 v[164:167], v[176:179], v[120:123], v[212:215]
    s_waitcnt lgkmcnt(2)
    v_mfma_f32_16x16x32_bf16 v[160:163], v[180:183], v[100:103], v[160:163]
    v_exp_f32 v233, v155
    ds_read_b128 v[176:179], v242 offset:37120
    v_mfma_f32_16x16x32_bf16 v[164:167], v[180:183], v[124:127], v[164:167]
    v_exp_f32 v234, v156
    s_waitcnt lgkmcnt(2)
    v_mfma_f32_16x16x32_bf16 v[160:163], v[184:187], v[104:107], v[160:163]
    ds_read_b128 v[180:183], v243 offset:37120
    buffer_load_dword v247, v245, s[36:39], s81 offen offset:1920
    v_mfma_f32_16x16x32_bf16 v[164:167], v[184:187], v[128:131], v[164:167]
    v_cvt_pk_bf16_f32 v194, v230, v231
    s_waitcnt lgkmcnt(2)
    v_mfma_f32_16x16x32_bf16 v[160:163], v[188:191], v[108:111], v[160:163]
    v_exp_f32 v235, v157
    ds_read_b128 v[184:187], v242 offset:43008
    v_mfma_f32_16x16x32_bf16 v[164:167], v[188:191], v[132:135], v[164:167]
    s_waitcnt lgkmcnt(2)
    v_mfma_f32_16x16x32_bf16 v[160:163], v[176:179], v[112:115], v[160:163]
    v_cvt_pk_bf16_f32 v195, v232, v233
    ds_read_b128 v[188:191], v243 offset:43008
    v_mfma_f32_16x16x32_bf16 v[164:167], v[176:179], v[136:139], v[164:167]
    v_exp_f32 v236, v158
    s_waitcnt lgkmcnt(2)
    v_mfma_f32_16x16x32_bf16 v[160:163], v[180:183], v[116:119], v[160:163]
    ds_read_b128 v[176:179], v242 offset:43136
    v_mfma_f32_16x16x32_bf16 v[164:167], v[180:183], v[140:143], v[164:167]
    v_exp_f32 v237, v159
    s_waitcnt lgkmcnt(2)
    v_mfma_f32_16x16x32_bf16 v[168:171], v[184:187], v[96:99], v[208:211]
    v_cvt_pk_bf16_f32 v202, v234, v235
    ds_read_b128 v[180:183], v243 offset:43136
    v_mfma_f32_16x16x32_bf16 v[172:175], v[184:187], v[120:123], v[212:215]
    s_waitcnt lgkmcnt(2)
    v_mfma_f32_16x16x32_bf16 v[168:171], v[188:191], v[100:103], v[168:171]
    v_cvt_pk_bf16_f32 v203, v236, v237
    ds_read_b128 v[184:187], v242 offset:43264
    v_mfma_f32_16x16x32_bf16 v[172:175], v[188:191], v[124:127], v[172:175]
    s_waitcnt lgkmcnt(2)
    v_mfma_f32_16x16x32_bf16 v[168:171], v[176:179], v[104:107], v[168:171]
    ds_read_b128 v[188:191], v243 offset:43264
    v_mfma_f32_16x16x32_bf16 v[172:175], v[176:179], v[128:131], v[172:175]
    v_mfma_f32_16x16x32_bf16 v[216:219], v[224:227], v[192:195], 0
    v_mfma_f32_16x16x32_bf16 v[220:223], v[224:227], v[200:203], 0
    s_waitcnt vmcnt(11)
    s_barrier
    s_waitcnt lgkmcnt(2)
    v_mfma_f32_16x16x32_bf16 v[168:171], v[180:183], v[108:111], v[168:171]
    ds_read_b64_tr_b16 v[176:177], v238 offset:24576
    v_mfma_f32_16x16x32_bf16 v[172:175], v[180:183], v[132:135], v[172:175]
    ds_read_b64_tr_b16 v[178:179], v238 offset:30720
    s_waitcnt lgkmcnt(3)
    v_mfma_f32_16x16x32_bf16 v[168:171], v[184:187], v[112:115], v[168:171]
    ds_read_b64_tr_b16 v[180:181], v239 offset:24576
    s_add_u32 s75, s54, 7
    s_and_b32 s75, s75, 7
    s_mul_i32 s75, s75, 24576
    v_mfma_f32_16x16x32_bf16 v[172:175], v[184:187], v[136:139], v[172:175]
    ds_read_b64_tr_b16 v[182:183], v239 offset:30720
    s_waitcnt lgkmcnt(4)
    v_mfma_f32_16x16x32_bf16 v[168:171], v[188:191], v[116:119], v[168:171]
    ds_read_b64_tr_b16 v[184:185], v240 offset:24576
    v_mfma_f32_16x16x32_bf16 v[172:175], v[188:191], v[140:143], v[172:175]
    ds_read_b64_tr_b16 v[186:187], v240 offset:30720
    v_max_f32 v217, v216, v220
    v_cmp_nge_f32 vcc, s73, v217
    s_cbranch_vccnz L_k1_tr5_0
L_k1_back5_0:
    s_waitcnt lgkmcnt(4)
    v_mfma_f32_16x16x32_bf16 v[0:3], v[176:179], v[192:195], v[0:3]
    v_add_f32 v228, v228, v216
    ds_read_b64_tr_b16 v[188:189], v241 offset:24576
    s_add_u32 m0, s69, 49152
    s_nop 0
    buffer_load_dwordx4 v252, s[44:47], s75 offen lds
    v_mfma_f32_16x16x32_bf16 v[4:7], v[176:179], v[200:203], v[4:7]
    v_add_f32 v229, v229, v220
    ds_read_b64_tr_b16 v[190:191], v241 offset:30720
    s_waitcnt lgkmcnt(4)
    v_mfma_f32_16x16x32_bf16 v[8:11], v[180:183], v[192:195], v[8:11]
    ds_read_b64_tr_b16 v[176:177], v238 offset:24704
    v_mfma_f32_16x16x32_bf16 v[12:15], v[180:183], v[200:203], v[12:15]
    v_exp_f32 v230, v160
    ds_read_b64_tr_b16 v[178:179], v238 offset:30848
    s_waitcnt lgkmcnt(4)
    v_mfma_f32_16x16x32_bf16 v[16:19], v[184:187], v[192:195], v[16:19]
    v_exp_f32 v231, v161
    ds_read_b64_tr_b16 v[180:181], v239 offset:24704
    v_mfma_f32_16x16x32_bf16 v[20:23], v[184:187], v[200:203], v[20:23]
    ds_read_b64_tr_b16 v[182:183], v239 offset:30848
    s_add_u32 m0, s69, 50176
    s_nop 0
    buffer_load_dwordx4 v253, s[44:47], s75 offen lds
    s_waitcnt lgkmcnt(4)
    v_mfma_f32_16x16x32_bf16 v[24:27], v[188:191], v[192:195], v[24:27]
    v_exp_f32 v232, v162
    ds_read_b64_tr_b16 v[184:185], v240 offset:24704
    v_mfma_f32_16x16x32_bf16 v[28:31], v[188:191], v[200:203], v[28:31]
    v_exp_f32 v233, v163
    ds_read_b64_tr_b16 v[186:187], v240 offset:30848
    s_waitcnt lgkmcnt(4)
    v_mfma_f32_16x16x32_bf16 v[32:35], v[176:179], v[192:195], v[32:35]
    ds_read_b64_tr_b16 v[188:189], v241 offset:24704
    v_mfma_f32_16x16x32_bf16 v[36:39], v[176:179], v[200:203], v[36:39]
    v_exp_f32 v234, v164
    ds_read_b64_tr_b16 v[190:191], v241 offset:30848
    s_add_u32 m0, s69, 51200
    s_nop 0
    buffer_load_dwordx4 v254, s[44:47], s75 offen lds
    s_waitcnt lgkmcnt(4)
    v_mfma_f32_16x16x32_bf16 v[40:43], v[180:183], v[192:195], v[40:43]
    v_cvt_pk_bf16_f32 v196, v230, v231
    ds_read_b64_tr_b16 v[176:177], v238 offset:24832
    v_mfma_f32_16x16x32_bf16 v[44:47], v[180:183], v[200:203], v[44:47]
    ds_read_b64_tr_b16 v[178:179], v238 offset:30976
    s_waitcnt lgkmcnt(4)
    v_mfma_f32_16x16x32_bf16 v[48:51], v[184:187], v[192:195], v[48:51]
    v_exp_f32 v235, v165
    ds_read_b64_tr_b16 v[180:181], v239 offset:24832
    v_add_u32 v242, 114688, v242
    v_mfma_f32_16x16x32_bf16 v[52:55], v[184:187], v[200:203], v[52:55]
    v_cvt_pk_bf16_f32 v197, v232, v233
    ds_read_b64_tr_b16 v[182:183], v239 offset:30976
    s_waitcnt lgkmcnt(4)
    v_mfma_f32_16x16x32_bf16 v[56:59], v[188:191], v[192:195], v[56:59]
    ds_read_b64_tr_b16 v[184:185], v240 offset:24832
    v_add_u32 v243, 114688, v243
    v_mfma_f32_16x16x32_bf16 v[60:63], v[188:191], v[200:203], v[60:63]
    v_exp_f32 v236, v166
    ds_read_b64_tr_b16 v[186:187], v240 offset:30976
    s_waitcnt lgkmcnt(4)
    v_mfma_f32_16x16x32_bf16 v[64:67], v[176:179], v[192:195], v[64:67]
    v_exp_f32 v237, v167
    ds_read_b64_tr_b16 v[188:189], v241 offset:24832
    v_mfma_f32_16x16x32_bf16 v[68:71], v[176:179], v[200:203], v[68:71]
    ds_read_b64_tr_b16 v[190:191], v241 offset:30976
    s_waitcnt vmcnt(11)
    s_barrier
    s_waitcnt vmcnt(3)
    s_waitcnt lgkmcnt(4)
    v_mfma_f32_16x16x32_bf16 v[72:75], v[180:183], v[192:195], v[72:75]
    v_cvt_pk_bf16_f32 v204, v234, v235
    ds_read_b128 v[176:179], v242 offset:0
    v_mfma_f32_16x16x32_bf16 v[76:79], v[180:183], v[200:203], v[76:79]
    v_cvt_pk_bf16_f32 v205, v236, v237
    s_waitcnt lgkmcnt(3)
    v_mfma_f32_16x16x32_bf16 v[80:83], v[184:187], v[192:195], v[80:83]
    ds_read_b128 v[180:183], v243 offset:0
    v_mfma_f32_16x16x32_bf16 v[84:87], v[184:187], v[200:203], v[84:87]
    v_exp_f32 v230, v168
    s_waitcnt lgkmcnt(2)
    v_mfma_f32_16x16x32_bf16 v[88:91], v[188:191], v[192:195], v[88:91]
    ds_read_b128 v[184:187], v242 offset:128
    v_mfma_f32_16x16x32_bf16 v[92:95], v[188:191], v[200:203], v[92:95]
    v_exp_f32 v231, v169
    s_waitcnt lgkmcnt(2)
    v_mfma_f32_16x16x32_bf16 v[144:147], v[176:179], v[96:99], v[208:211]
    v_exp_f32 v232, v170
    ds_read_b128 v[188:191], v243 offset:128
    v_mfma_f32_16x16x32_bf16 v[148:151], v[176:179], v[120:123], v[212:215]
    s_waitcnt lgkmcnt(2)
    v_mfma_f32_16x16x32_bf16 v[144:147], v[180:183], v[100:103], v[144:147]
    v_exp_f32 v233, v171
    ds_read_b128 v[176:179], v242 offset:256
    v_mfma_f32_16x16x32_bf16 v[148:151], v[180:183], v[124:127], v[148:151]
    v_exp_f32 v234, v172
    s_waitcnt lgkmcnt(2)
    v_mfma_f32_16x16x32_bf16 v[144:147], v[184:187], v[104:107], v[144:147]
    ds_read_b128 v[180:183], v243 offset:256
    v_mfma_f32_16x16x32_bf16 v[148:151], v[184:187], v[128:131], v[148:151]
    v_cvt_pk_bf16_f32 v198, v230, v231
    s_waitcnt lgkmcnt(2)
    v_mfma_f32_16x16x32_bf16 v[144:147], v[188:191], v[108:111], v[144:147]
    v_exp_f32 v235, v173
    ds_read_b128 v[184:187], v242 offset:6144
    v_mfma_f32_16x16x32_bf16 v[148:151], v[188:191], v[132:135], v[148:151]
    s_waitcnt lgkmcnt(2)
    v_mfma_f32_16x16x32_bf16 v[144:147], v[176:179], v[112:115], v[144:147]
    v_cvt_pk_bf16_f32 v199, v232, v233
    ds_read_b128 v[188:191], v243 offset:6144
    v_mfma_f32_16x16x32_bf16 v[148:151], v[176:179], v[136:139], v[148:151]
    v_exp_f32 v236, v174
    s_waitcnt lgkmcnt(2)
    v_mfma_f32_16x16x32_bf16 v[144:147], v[180:183], v[116:119], v[144:147]
    ds_read_b128 v[176:179], v242 offset:6272
    v_mfma_f32_16x16x32_bf16 v[148:151], v[180:183], v[140:143], v[148:151]
    v_exp_f32 v237, v175
    s_waitcnt lgkmcnt(2)
    v_mfma_f32_16x16x32_bf16 v[152:155], v[184:187], v[96:99], v[208:211]
    v_cvt_pk_bf16_f32 v206, v234, v235
    ds_read_b128 v[180:183], v243 offset:6272
    v_mfma_f32_16x16x32_bf16 v[156:159], v[184:187], v[120:123], v[212:215]
    s_waitcnt lgkmcnt(2)
    v_mfma_f32_16x16x32_bf16 v[152:155], v[188:191], v[100:103], v[152:155]
    v_cvt_pk_bf16_f32 v207, v236, v237
    ds_read_b128 v[184:187], v242 offset:6400
    v_mfma_f32_16x16x32_bf16 v[156:159], v[188:191], v[124:127], v[156:159]
    s_waitcnt lgkmcnt(2)
    v_mfma_f32_16x16x32_bf16 v[152:155], v[176:179], v[104:107], v[152:155]
    ds_read_b128 v[188:191], v243 offset:6400
    v_mfma_f32_16x16x32_bf16 v[156:159], v[176:179], v[128:131], v[156:159]
    v_mfma_f32_16x16x32_bf16 v[216:219], v[224:227], v[196:199], 0
    v_mfma_f32_16x16x32_bf16 v[220:223], v[224:227], v[204:207], 0
    s_waitcnt lgkmcnt(2)
    v_mfma_f32_16x16x32_bf16 v[152:155], v[180:183], v[108:111], v[152:155]
    ds_read_b64_tr_b16 v[176:177], v238 offset:36864
    v_mfma_f32_16x16x32_bf16 v[156:159], v[180:183], v[132:135], v[156:159]
    ds_read_b64_tr_b16 v[178:179], v238 offset:43008
    s_waitcnt lgkmcnt(3)
    v_mfma_f32_16x16x32_bf16 v[152:155], v[184:187], v[112:115], v[152:155]
    ds_read_b64_tr_b16 v[180:181], v239 offset:36864
    v_mfma_f32_16x16x32_bf16 v[156:159], v[184:187], v[136:139], v[156:159]
    ds_read_b64_tr_b16 v[182:183], v239 offset:43008
    s_waitcnt lgkmcnt(4)
    v_mfma_f32_16x16x32_bf16 v[152:155], v[188:191], v[116:119], v[152:155]
    ds_read_b64_tr_b16 v[184:185], v240 offset:36864
    v_mfma_f32_16x16x32_bf16 v[156:159], v[188:191], v[140:143], v[156:159]
    ds_read_b64_tr_b16 v[186:187], v240 offset:43008
    v_max_f32 v217, v216, v220
    v_cmp_nge_f32 vcc, s73, v217
    s_cbranch_vccnz L_k1_tr5_1
L_k1_back5_1:
    s_waitcnt lgkmcnt(4)
    v_mfma_f32_16x16x32_bf16 v[0:3], v[176:179], v[196:199], v[0:3]
    v_add_f32 v228, v228, v216
    ds_read_b64_tr_b16 v[188:189], v241 offset:36864
    v_mfma_f32_16x16x32_bf16 v[4:7], v[176:179], v[204:207], v[4:7]
    v_add_f32 v229, v229, v220
    ds_read_b64_tr_b16 v[190:191], v241 offset:43008
    s_waitcnt lgkmcnt(4)
    v_mfma_f32_16x16x32_bf16 v[8:11], v[180:183], v[196:199], v[8:11]
    ds_read_b64_tr_b16 v[176:177], v238 offset:36992
    v_mfma_f32_16x16x32_bf16 v[12:15], v[180:183], v[204:207], v[12:15]
    v_exp_f32 v230, v144
    ds_read_b64_tr_b16 v[178:179], v238 offset:43136
    s_waitcnt lgkmcnt(4)
    v_mfma_f32_16x16x32_bf16 v[16:19], v[184:187], v[196:199], v[16:19]
    v_exp_f32 v231, v145
    ds_read_b64_tr_b16 v[180:181], v239 offset:36992
    v_mfma_f32_16x16x32_bf16 v[20:23], v[184:187], v[204:207], v[20:23]
    ds_read_b64_tr_b16 v[182:183], v239 offset:43136
    s_waitcnt lgkmcnt(4)
    v_mfma_f32_16x16x32_bf16 v[24:27], v[188:191], v[196:199], v[24:27]
    v_exp_f32 v232, v146
    ds_read_b64_tr_b16 v[184:185], v240 offset:36992
    v_mfma_f32_16x16x32_bf16 v[28:31], v[188:191], v[204:207], v[28:31]
    v_exp_f32 v233, v147
    ds_read_b64_tr_b16 v[186:187], v240 offset:43136
    s_waitcnt lgkmcnt(4)
    v_mfma_f32_16x16x32_bf16 v[32:35], v[176:179], v[196:199], v[32:35]
    ds_read_b64_tr_b16 v[188:189], v241 offset:36992
    v_mfma_f32_16x16x32_bf16 v[36:39], v[176:179], v[204:207], v[36:39]
    v_exp_f32 v234, v148
    ds_read_b64_tr_b16 v[190:191], v241 offset:43136
    s_waitcnt lgkmcnt(4)
    v_mfma_f32_16x16x32_bf16 v[40:43], v[180:183], v[196:199], v[40:43]
    v_cvt_pk_bf16_f32 v192, v230, v231
    ds_read_b64_tr_b16 v[176:177], v238 offset:37120
    v_mfma_f32_16x16x32_bf16 v[44:47], v[180:183], v[204:207], v[44:47]
    ds_read_b64_tr_b16 v[178:179], v238 offset:43264
    s_waitcnt lgkmcnt(4)
    v_mfma_f32_16x16x32_bf16 v[48:51], v[184:187], v[196:199], v[48:51]
    v_exp_f32 v235, v149
    ds_read_b64_tr_b16 v[180:181], v239 offset:37120
    v_mfma_f32_16x16x32_bf16 v[52:55], v[184:187], v[204:207], v[52:55]
    v_cvt_pk_bf16_f32 v193, v232, v233
    ds_read_b64_tr_b16 v[182:183], v239 offset:43264
    s_waitcnt lgkmcnt(4)
    v_mfma_f32_16x16x32_bf16 v[56:59], v[188:191], v[196:199], v[56:59]
    ds_read_b64_tr_b16 v[184:185], v240 offset:37120
    v_mfma_f32_16x16x32_bf16 v[60:63], v[188:191], v[204:207], v[60:63]
    v_exp_f32 v236, v150
    ds_read_b64_tr_b16 v[186:187], v240 offset:43264
    s_waitcnt lgkmcnt(4)
    v_mfma_f32_16x16x32_bf16 v[64:67], v[176:179], v[196:199], v[64:67]
    v_exp_f32 v237, v151
    ds_read_b64_tr_b16 v[188:189], v241 offset:37120
    v_mfma_f32_16x16x32_bf16 v[68:71], v[176:179], v[204:207], v[68:71]
    ds_read_b64_tr_b16 v[190:191], v241 offset:43264
    s_waitcnt lgkmcnt(4)
    v_mfma_f32_16x16x32_bf16 v[72:75], v[180:183], v[196:199], v[72:75]
    v_cvt_pk_bf16_f32 v200, v234, v235
    ds_read_b128 v[176:179], v242 offset:12288
    v_mfma_f32_16x16x32_bf16 v[76:79], v[180:183], v[204:207], v[76:79]
    v_cvt_pk_bf16_f32 v201, v236, v237
    s_waitcnt lgkmcnt(3)
    v_mfma_f32_16x16x32_bf16 v[80:83], v[184:187], v[196:199], v[80:83]
    ds_read_b128 v[180:183], v243 offset:12288
    v_mfma_f32_16x16x32_bf16 v[84:87], v[184:187], v[204:207], v[84:87]
    v_exp_f32 v230, v152
    s_waitcnt lgkmcnt(2)
    v_mfma_f32_16x16x32_bf16 v[88:91], v[188:191], v[196:199], v[88:91]
    ds_read_b128 v[184:187], v242 offset:12416
    v_mfma_f32_16x16x32_bf16 v[92:95], v[188:191], v[204:207], v[92:95]
    v_exp_f32 v231, v153
    s_waitcnt lgkmcnt(2)
    v_mfma_f32_16x16x32_bf16 v[160:163], v[176:179], v[96:99], v[208:211]
    v_exp_f32 v232, v154
    ds_read_b128 v[188:191], v243 offset:12416
    v_mfma_f32_16x16x32_bf16 v[164:167], v[176:179], v[120:123], v[212:215]
    s_waitcnt lgkmcnt(2)
    v_mfma_f32_16x16x32_bf16 v[160:163], v[180:183], v[100:103], v[160:163]
    v_exp_f32 v233, v155
    ds_read_b128 v[176:179], v242 offset:12544
    v_mfma_f32_16x16x32_bf16 v[164:167], v[180:183], v[124:127], v[164:167]
    v_exp_f32 v234, v156
    s_waitcnt lgkmcnt(2)
    v_mfma_f32_16x16x32_bf16 v[160:163], v[184:187], v[104:107], v[160:163]
    ds_read_b128 v[180:183], v243 offset:12544
    v_lshlrev_b32 v244, 1, v248
    s_cmp_eq_u32 s52, 0
    s_cselect_b32 s97, 0, 0x100000
    s_mov_b64 exec, 0xff
    buffer_load_dword v246, v244, s[92:95], s97 offen offset:4 sc1
    s_mov_b64 exec, -1
    v_mfma_f32_16x16x32_bf16 v[164:167], v[184:187], v[128:131], v[164:167]
    v_cvt_pk_bf16_f32 v194, v230, v231
    s_waitcnt lgkmcnt(2)
    v_mfma_f32_16x16x32_bf16 v[160:163], v[188:191], v[108:111], v[160:163]
    v_exp_f32 v235, v157
    ds_read_b128 v[184:187], v242 offset:18432
    v_mfma_f32_16x16x32_bf16 v[164:167], v[188:191], v[132:135], v[164:167]
    s_waitcnt lgkmcnt(2)
    v_mfma_f32_16x16x32_bf16 v[160:163], v[176:179], v[112:115], v[160:163]
    v_cvt_pk_bf16_f32 v195, v232, v233
    ds_read_b128 v[188:191], v243 offset:18432
    v_mfma_f32_16x16x32_bf16 v[164:167], v[176:179], v[136:139], v[164:167]
    v_exp_f32 v236, v158
    s_waitcnt lgkmcnt(2)
    v_mfma_f32_16x16x32_bf16 v[160:163], v[180:183], v[116:119], v[160:163]
    ds_read_b128 v[176:179], v242 offset:18560
    v_mfma_f32_16x16x32_bf16 v[164:167], v[180:183], v[140:143], v[164:167]
    v_exp_f32 v237, v159
    v_add_u32 v238, 90112, v238
    s_waitcnt lgkmcnt(2)
    v_mfma_f32_16x16x32_bf16 v[168:171], v[184:187], v[96:99], v[208:211]
    v_cvt_pk_bf16_f32 v202, v234, v235
    ds_read_b128 v[180:183], v243 offset:18560
    v_mfma_f32_16x16x32_bf16 v[172:175], v[184:187], v[120:123], v[212:215]
    v_add_u32 v239, 90112, v239
    s_waitcnt lgkmcnt(2)
    v_mfma_f32_16x16x32_bf16 v[168:171], v[188:191], v[100:103], v[168:171]
    v_cvt_pk_bf16_f32 v203, v236, v237
    ds_read_b128 v[184:187], v242 offset:18688
    v_mfma_f32_16x16x32_bf16 v[172:175], v[188:191], v[124:127], v[172:175]
    v_add_u32 v240, 90112, v240
    s_waitcnt lgkmcnt(2)
    v_mfma_f32_16x16x32_bf16 v[168:171], v[176:179], v[104:107], v[168:171]
    ds_read_b128 v[188:191], v243 offset:18688
    v_mfma_f32_16x16x32_bf16 v[172:175], v[176:179], v[128:131], v[172:175]
    v_add_u32 v241, 90112, v241
    v_mfma_f32_16x16x32_bf16 v[216:219], v[224:227], v[192:195], 0
    v_mfma_f32_16x16x32_bf16 v[220:223], v[224:227], v[200:203], 0
    s_barrier
    s_waitcnt lgkmcnt(2)
    v_mfma_f32_16x16x32_bf16 v[168:171], v[180:183], v[108:111], v[168:171]
    ds_read_b64_tr_b16 v[176:177], v238 offset:0
    v_mfma_f32_16x16x32_bf16 v[172:175], v[180:183], v[132:135], v[172:175]
    ds_read_b64_tr_b16 v[178:179], v238 offset:6144
    s_waitcnt lgkmcnt(3)
    v_mfma_f32_16x16x32_bf16 v[168:171], v[184:187], v[112:115], v[168:171]
    ds_read_b64_tr_b16 v[180:181], v239 offset:0
    v_mfma_f32_16x16x32_bf16 v[172:175], v[184:187], v[136:139], v[172:175]
    ds_read_b64_tr_b16 v[182:183], v239 offset:6144
    s_waitcnt lgkmcnt(4)
    v_mfma_f32_16x16x32_bf16 v[168:171], v[188:191], v[116:119], v[168:171]
    ds_read_b64_tr_b16 v[184:185], v240 offset:0
    v_mfma_f32_16x16x32_bf16 v[172:175], v[188:191], v[140:143], v[172:175]
    ds_read_b64_tr_b16 v[186:187], v240 offset:6144
    v_max_f32 v217, v216, v220
    v_cmp_nge_f32 vcc, s73, v217
    s_cbranch_vccnz L_k1_tr6_0
L_k1_back6_0:
    s_waitcnt lgkmcnt(4)
    v_mfma_f32_16x16x32_bf16 v[0:3], v[176:179], v[192:195], v[0:3]
    v_add_f32 v228, v228, v216
    ds_read_b64_tr_b16 v[188:189], v241 offset:0
    v_mfma_f32_16x16x32_bf16 v[4:7], v[176:179], v[200:203], v[4:7]
    v_add_f32 v229, v229, v220
    ds_read_b64_tr_b16 v[190:191], v241 offset:6144
    s_waitcnt lgkmcnt(4)
    v_mfma_f32_16x16x32_bf16 v[8:11], v[180:183], v[192:195], v[8:11]
    ds_read_b64_tr_b16 v[176:177], v238 offset:128
    v_mfma_f32_16x16x32_bf16 v[12:15], v[180:183], v[200:203], v[12:15]
    v_exp_f32 v230, v160
    ds_read_b64_tr_b16 v[178:179], v238 offset:6272
    s_waitcnt lgkmcnt(4)
    v_mfma_f32_16x16x32_bf16 v[16:19], v[184:187], v[192:195], v[16:19]
    v_exp_f32 v231, v161
    ds_read_b64_tr_b16 v[180:181], v239 offset:128
    v_mfma_f32_16x16x32_bf16 v[20:23], v[184:187], v[200:203], v[20:23]
    ds_read_b64_tr_b16 v[182:183], v239 offset:6272
    s_waitcnt lgkmcnt(4)
    v_mfma_f32_16x16x32_bf16 v[24:27], v[188:191], v[192:195], v[24:27]
    v_exp_f32 v232, v162
    ds_read_b64_tr_b16 v[184:185], v240 offset:128
    v_mfma_f32_16x16x32_bf16 v[28:31], v[188:191], v[200:203], v[28:31]
    v_exp_f32 v233, v163
    ds_read_b64_tr_b16 v[186:187], v240 offset:6272
    s_waitcnt lgkmcnt(4)
    v_mfma_f32_16x16x32_bf16 v[32:35], v[176:179], v[192:195], v[32:35]
    ds_read_b64_tr_b16 v[188:189], v241 offset:128
    v_mfma_f32_16x16x32_bf16 v[36:39], v[176:179], v[200:203], v[36:39]
    v_exp_f32 v234, v164
    ds_read_b64_tr_b16 v[190:191], v241 offset:6272
    s_waitcnt lgkmcnt(4)
    v_mfma_f32_16x16x32_bf16 v[40:43], v[180:183], v[192:195], v[40:43]
    v_cvt_pk_bf16_f32 v196, v230, v231
    ds_read_b64_tr_b16 v[176:177], v238 offset:256
    v_mfma_f32_16x16x32_bf16 v[44:47], v[180:183], v[200:203], v[44:47]
    ds_read_b64_tr_b16 v[178:179], v238 offset:6400
    s_waitcnt lgkmcnt(4)
    v_mfma_f32_16x16x32_bf16 v[48:51], v[184:187], v[192:195], v[48:51]
    v_exp_f32 v235, v165
    ds_read_b64_tr_b16 v[180:181], v239 offset:256
    v_add_u32 v242, 4294852608, v242
    v_mfma_f32_16x16x32_bf16 v[52:55], v[184:187], v[200:203], v[52:55]
    v_cvt_pk_bf16_f32 v197, v232, v233
    ds_read_b64_tr_b16 v[182:183], v239 offset:6400
    s_waitcnt lgkmcnt(4)
    v_mfma_f32_16x16x32_bf16 v[56:59], v[188:191], v[192:195], v[56:59]
    ds_read_b64_tr_b16 v[184:185], v240 offset:256
    v_add_u32 v243, 4294852608, v243
    v_mfma_f32_16x16x32_bf16 v[60:63], v[188:191], v[200:203], v[60:63]
    v_exp_f32 v236, v166
    ds_read_b64_tr_b16 v[186:187], v240 offset:6400
    s_waitcnt lgkmcnt(4)
    v_mfma_f32_16x16x32_bf16 v[64:67], v[176:179], v[192:195], v[64:67]
    v_exp_f32 v237, v167
    ds_read_b64_tr_b16 v[188:189], v241 offset:256
    v_mfma_f32_16x16x32_bf16 v[68:71], v[176:179], v[200:203], v[68:71]
    ds_read_b64_tr_b16 v[190:191], v241 offset:6400
    s_waitcnt vmcnt(0)
    v_add_u32 v246, -1, v246
    v_and_b32 v246, 0x8000001f, v246
    v_cmp_ne_u32 vcc, 31, v246
    s_cmp_eq_u32 s52, 0
    s_cselect_b32 s97, 0xff, 0
    s_nop 1
    s_and_b32 s97, s97, vcc_lo
    s_cbranch_scc1 L_ph_spin
L_ph_ok:
    s_barrier
    s_waitcnt lgkmcnt(4)
    v_mfma_f32_16x16x32_bf16 v[72:75], v[180:183], v[192:195], v[72:75]
    v_cvt_pk_bf16_f32 v204, v234, v235
    ds_read_b128 v[176:179], v242 offset:0
    v_mfma_f32_16x16x32_bf16 v[76:79], v[180:183], v[200:203], v[76:79]
    v_cvt_pk_bf16_f32 v205, v236, v237
    s_waitcnt lgkmcnt(3)
    v_mfma_f32_16x16x32_bf16 v[80:83], v[184:187], v[192:195], v[80:83]
    ds_read_b128 v[180:183], v243 offset:0
    s_mul_i32 s60, s64, 10240
    s_add_u32 s60, s60, s80
    v_mfma_f32_16x16x32_bf16 v[84:87], v[184:187], v[200:203], v[84:87]
    v_exp_f32 v230, v168
    s_waitcnt lgkmcnt(2)
    v_mfma_f32_16x16x32_bf16 v[88:91], v[188:191], v[192:195], v[88:91]
    ds_read_b128 v[184:187], v242 offset:128
    v_mfma_f32_16x16x32_bf16 v[92:95], v[188:191], v[200:203], v[92:95]
    v_exp_f32 v231, v169
    s_waitcnt lgkmcnt(2)
    v_mfma_f32_16x16x32_bf16 v[144:147], v[176:179], v[96:99], v[208:211]
    v_exp_f32 v232, v170
    ds_read_b128 v[188:191], v243 offset:128
    v_mfma_f32_16x16x32_bf16 v[148:151], v[176:179], v[120:123], v[212:215]
    s_waitcnt lgkmcnt(2)
    v_mfma_f32_16x16x32_bf16 v[144:147], v[180:183], v[100:103], v[144:147]
    v_exp_f32 v233, v171
    ds_read_b128 v[176:179], v242 offset:256
    v_mfma_f32_16x16x32_bf16 v[148:151], v[180:183], v[124:127], v[148:151]
    v_exp_f32 v234, v172
    s_waitcnt lgkmcnt(2)
    v_mfma_f32_16x16x32_bf16 v[144:147], v[184:187], v[104:107], v[144:147]
    ds_read_b128 v[180:183], v243 offset:256
    v_mfma_f32_16x16x32_bf16 v[148:151], v[184:187], v[128:131], v[148:151]
    v_cvt_pk_bf16_f32 v198, v230, v231
    s_waitcnt lgkmcnt(2)
    v_mfma_f32_16x16x32_bf16 v[144:147], v[188:191], v[108:111], v[144:147]
    v_exp_f32 v235, v173
    ds_read_b128 v[184:187], v242 offset:6144
    v_mfma_f32_16x16x32_bf16 v[148:151], v[188:191], v[132:135], v[148:151]
    s_waitcnt lgkmcnt(2)
    v_mfma_f32_16x16x32_bf16 v[144:147], v[176:179], v[112:115], v[144:147]
    v_cvt_pk_bf16_f32 v199, v232, v233
    ds_read_b128 v[188:191], v243 offset:6144
    s_add_u32 m0, s61, 81920
    s_add_u32 s64, s64, 1
    buffer_load_dwordx4 v248, s[32:35], s60 offen sc1 lds
    s_add_u32 s60, s60, 1024
    v_mfma_f32_16x16x32_bf16 v[148:151], v[176:179], v[136:139], v[148:151]
    v_exp_f32 v236, v174
    s_waitcnt lgkmcnt(2)
    v_mfma_f32_16x16x32_bf16 v[144:147], v[180:183], v[116:119], v[144:147]
    ds_read_b128 v[176:179], v242 offset:6272
    v_mfma_f32_16x16x32_bf16 v[148:151], v[180:183], v[140:143], v[148:151]
    v_exp_f32 v237, v175
    s_waitcnt lgkmcnt(2)
    v_mfma_f32_16x16x32_bf16 v[152:155], v[184:187], v[96:99], v[208:211]
    v_cvt_pk_bf16_f32 v206, v234, v235
    ds_read_b128 v[180:183], v243 offset:6272
    v_mfma_f32_16x16x32_bf16 v[156:159], v[184:187], v[120:123], v[212:215]
    s_waitcnt lgkmcnt(2)
    v_mfma_f32_16x16x32_bf16 v[152:155], v[188:191], v[100:103], v[152:155]
    v_cvt_pk_bf16_f32 v207, v236, v237
    ds_read_b128 v[184:187], v242 offset:6400
    v_mfma_f32_16x16x32_bf16 v[156:159], v[188:191], v[124:127], v[156:159]
    s_waitcnt lgkmcnt(2)
    v_mfma_f32_16x16x32_bf16 v[152:155], v[176:179], v[104:107], v[152:155]
    ds_read_b128 v[188:191], v243 offset:6400
    v_mfma_f32_16x16x32_bf16 v[156:159], v[176:179], v[128:131], v[156:159]
    v_mfma_f32_16x16x32_bf16 v[216:219], v[224:227], v[196:199], 0
    v_mfma_f32_16x16x32_bf16 v[220:223], v[224:227], v[204:207], 0
    s_waitcnt lgkmcnt(2)
    v_mfma_f32_16x16x32_bf16 v[152:155], v[180:183], v[108:111], v[152:155]
    ds_read_b64_tr_b16 v[176:177], v238 offset:12288
    s_add_u32 m0, s61, 82944
    s_cmp_eq_u32 s64, 6
    buffer_load_dwordx4 v248, s[32:35], s60 offen sc1 lds
    s_cselect_b32 s64, 0, s64
    s_add_u32 s60, s60, 1024
    v_mfma_f32_16x16x32_bf16 v[156:159], v[180:183], v[132:135], v[156:159]
    ds_read_b64_tr_b16 v[178:179], v238 offset:18432
    s_waitcnt lgkmcnt(3)
    v_mfma_f32_16x16x32_bf16 v[152:155], v[184:187], v[112:115], v[152:155]
    ds_read_b64_tr_b16 v[180:181], v239 offset:12288
    v_mfma_f32_16x16x32_bf16 v[156:159], v[184:187], v[136:139], v[156:159]
    ds_read_b64_tr_b16 v[182:183], v239 offset:18432
    s_waitcnt lgkmcnt(4)
    v_mfma_f32_16x16x32_bf16 v[152:155], v[188:191], v[116:119], v[152:155]
    ds_read_b64_tr_b16 v[184:185], v240 offset:12288
    v_mfma_f32_16x16x32_bf16 v[156:159], v[188:191], v[140:143], v[156:159]
    ds_read_b64_tr_b16 v[186:187], v240 offset:18432
    v_max_f32 v217, v216, v220
    v_cmp_nge_f32 vcc, s73, v217
    s_cbranch_vccnz L_k1_tr6_1
L_k1_back6_1:
    s_waitcnt lgkmcnt(4)
    v_mfma_f32_16x16x32_bf16 v[0:3], v[176:179], v[196:199], v[0:3]
    v_add_f32 v228, v228, v216
    ds_read_b64_tr_b16 v[188:189], v241 offset:12288
    v_mfma_f32_16x16x32_bf16 v[4:7], v[176:179], v[204:207], v[4:7]
    v_add_f32 v229, v229, v220
    ds_read_b64_tr_b16 v[190:191], v241 offset:18432
    s_waitcnt lgkmcnt(4)
    v_mfma_f32_16x16x32_bf16 v[8:11], v[180:183], v[196:199], v[8:11]
    ds_read_b64_tr_b16 v[176:177], v238 offset:12416
    v_mfma_f32_16x16x32_bf16 v[12:15], v[180:183], v[204:207], v[12:15]
    v_exp_f32 v230, v144
    ds_read_b64_tr_b16 v[178:179], v238 offset:18560
    s_waitcnt lgkmcnt(4)
    v_mfma_f32_16x16x32_bf16 v[16:19], v[184:187], v[196:199], v[16:19]
    v_exp_f32 v231, v145
    ds_read_b64_tr_b16 v[180:181], v239 offset:12416
    v_mfma_f32_16x16x32_bf16 v[20:23], v[184:187], v[204:207], v[20:23]
    ds_read_b64_tr_b16 v[182:183], v239 offset:18560
    s_waitcnt lgkmcnt(4)
    v_mfma_f32_16x16x32_bf16 v[24:27], v[188:191], v[196:199], v[24:27]
    v_exp_f32 v232, v146
    ds_read_b64_tr_b16 v[184:185], v240 offset:12416
    s_add_u32 m0, s61, 83968
    s_nop 0
    buffer_load_dwordx4 v248, s[32:35], s60 offen sc1 lds
    s_add_u32 s60, s60, 1024
    v_mfma_f32_16x16x32_bf16 v[28:31], v[188:191], v[204:207], v[28:31]
    v_exp_f32 v233, v147
    ds_read_b64_tr_b16 v[186:187], v240 offset:18560
    s_waitcnt lgkmcnt(4)
    v_mfma_f32_16x16x32_bf16 v[32:35], v[176:179], v[196:199], v[32:35]
    ds_read_b64_tr_b16 v[188:189], v241 offset:12416
    v_mfma_f32_16x16x32_bf16 v[36:39], v[176:179], v[204:207], v[36:39]
    v_exp_f32 v234, v148
    ds_read_b64_tr_b16 v[190:191], v241 offset:18560
    s_waitcnt lgkmcnt(4)
    v_mfma_f32_16x16x32_bf16 v[40:43], v[180:183], v[196:199], v[40:43]
    v_cvt_pk_bf16_f32 v192, v230, v231
    ds_read_b64_tr_b16 v[176:177], v238 offset:12544
    v_mfma_f32_16x16x32_bf16 v[44:47], v[180:183], v[204:207], v[44:47]
    ds_read_b64_tr_b16 v[178:179], v238 offset:18688
    s_waitcnt lgkmcnt(4)
    v_mfma_f32_16x16x32_bf16 v[48:51], v[184:187], v[196:199], v[48:51]
    v_exp_f32 v235, v149
    ds_read_b64_tr_b16 v[180:181], v239 offset:12544
    v_mfma_f32_16x16x32_bf16 v[52:55], v[184:187], v[204:207], v[52:55]
    v_cvt_pk_bf16_f32 v193, v232, v233
    ds_read_b64_tr_b16 v[182:183], v239 offset:18688
    s_waitcnt lgkmcnt(4)
    v_mfma_f32_16x16x32_bf16 v[56:59], v[188:191], v[196:199], v[56:59]
    ds_read_b64_tr_b16 v[184:185], v240 offset:12544
    v_mfma_f32_16x16x32_bf16 v[60:63], v[188:191], v[204:207], v[60:63]
    v_exp_f32 v236, v150
    ds_read_b64_tr_b16 v[186:187], v240 offset:18688
    s_waitcnt lgkmcnt(4)
    v_mfma_f32_16x16x32_bf16 v[64:67], v[176:179], v[196:199], v[64:67]
    v_exp_f32 v237, v151
    ds_read_b64_tr_b16 v[188:189], v241 offset:12544
    v_mfma_f32_16x16x32_bf16 v[68:71], v[176:179], v[204:207], v[68:71]
    ds_read_b64_tr_b16 v[190:191], v241 offset:18688
    s_waitcnt lgkmcnt(4)
    v_mfma_f32_16x16x32_bf16 v[72:75], v[180:183], v[196:199], v[72:75]
    v_cvt_pk_bf16_f32 v200, v234, v235
    ds_read_b128 v[176:179], v242 offset:12288
    s_add_u32 m0, s61, 84992
    s_nop 0
    buffer_load_dwordx4 v248, s[32:35], s60 offen sc1 lds
    s_add_u32 s60, s60, 1024
    v_mfma_f32_16x16x32_bf16 v[76:79], v[180:183], v[204:207], v[76:79]
    v_cvt_pk_bf16_f32 v201, v236, v237
    s_waitcnt lgkmcnt(3)
    v_mfma_f32_16x16x32_bf16 v[80:83], v[184:187], v[196:199], v[80:83]
    ds_read_b128 v[180:183], v243 offset:12288
    v_mfma_f32_16x16x32_bf16 v[84:87], v[184:187], v[204:207], v[84:87]
    v_exp_f32 v230, v152
    s_waitcnt lgkmcnt(2)
    v_mfma_f32_16x16x32_bf16 v[88:91], v[188:191], v[196:199], v[88:91]
    ds_read_b128 v[184:187], v242 offset:12416
    v_mfma_f32_16x16x32_bf16 v[92:95], v[188:191], v[204:207], v[92:95]
    v_exp_f32 v231, v153
    s_waitcnt lgkmcnt(2)
    v_mfma_f32_16x16x32_bf16 v[160:163], v[176:179], v[96:99], v[208:211]
    v_exp_f32 v232, v154
    ds_read_b128 v[188:191], v243 offset:12416
    v_mfma_f32_16x16x32_bf16 v[164:167], v[176:179], v[120:123], v[212:215]
    s_waitcnt lgkmcnt(2)
    v_mfma_f32_16x16x32_bf16 v[160:163], v[180:183], v[100:103], v[160:163]
    v_exp_f32 v233, v155
    ds_read_b128 v[176:179], v242 offset:12544
    v_mfma_f32_16x16x32_bf16 v[164:167], v[180:183], v[124:127], v[164:167]
    v_exp_f32 v234, v156
    s_waitcnt lgkmcnt(2)
    v_mfma_f32_16x16x32_bf16 v[160:163], v[184:187], v[104:107], v[160:163]
    ds_read_b128 v[180:183], v243 offset:12544
    v_mfma_f32_16x16x32_bf16 v[164:167], v[184:187], v[128:131], v[164:167]
    v_cvt_pk_bf16_f32 v194, v230, v231
    s_waitcnt lgkmcnt(2)
    v_mfma_f32_16x16x32_bf16 v[160:163], v[188:191], v[108:111], v[160:163]
    v_exp_f32 v235, v157
    ds_read_b128 v[184:187], v242 offset:18432
    s_add_u32 m0, s61, 86016
    s_nop 0
    buffer_load_dwordx4 v248, s[32:35], s60 offen sc1 lds
    s_add_u32 s60, s60, 1024
    v_mfma_f32_16x16x32_bf16 v[164:167], v[188:191], v[132:135], v[164:167]
    s_waitcnt lgkmcnt(2)
    v_mfma_f32_16x16x32_bf16 v[160:163], v[176:179], v[112:115], v[160:163]
    v_cvt_pk_bf16_f32 v195, v232, v233
    ds_read_b128 v[188:191], v243 offset:18432
    v_mfma_f32_16x16x32_bf16 v[164:167], v[176:179], v[136:139], v[164:167]
    v_exp_f32 v236, v158
    s_waitcnt lgkmcnt(2)
    v_mfma_f32_16x16x32_bf16 v[160:163], v[180:183], v[116:119], v[160:163]
    ds_read_b128 v[176:179], v242 offset:18560
    v_mfma_f32_16x16x32_bf16 v[164:167], v[180:183], v[140:143], v[164:167]
    v_exp_f32 v237, v159
    v_add_u32 v238, 4294877184, v238
    s_waitcnt lgkmcnt(2)
    v_mfma_f32_16x16x32_bf16 v[168:171], v[184:187], v[96:99], v[208:211]
    v_cvt_pk_bf16_f32 v202, v234, v235
    ds_read_b128 v[180:183], v243 offset:18560
    v_mfma_f32_16x16x32_bf16 v[172:175], v[184:187], v[120:123], v[212:215]
    v_add_u32 v239, 4294877184, v239
    s_waitcnt lgkmcnt(2)
    v_mfma_f32_16x16x32_bf16 v[168:171], v[188:191], v[100:103], v[168:171]
    v_cvt_pk_bf16_f32 v203, v236, v237
    ds_read_b128 v[184:187], v242 offset:18688
    v_mfma_f32_16x16x32_bf16 v[172:175], v[188:191], v[124:127], v[172:175]
    v_add_u32 v240, 4294877184, v240
    s_waitcnt lgkmcnt(2)
    v_mfma_f32_16x16x32_bf16 v[168:171], v[176:179], v[104:107], v[168:171]
    ds_read_b128 v[188:191], v243 offset:18688
    v_mfma_f32_16x16x32_bf16 v[172:175], v[176:179], v[128:131], v[172:175]
    v_add_u32 v241, 4294877184, v241
    v_mfma_f32_16x16x32_bf16 v[216:219], v[224:227], v[192:195], 0
    v_mfma_f32_16x16x32_bf16 v[220:223], v[224:227], v[200:203], 0
    s_barrier
    s_waitcnt lgkmcnt(2)
    v_mfma_f32_16x16x32_bf16 v[168:171], v[180:183], v[108:111], v[168:171]
    ds_read_b64_tr_b16 v[176:177], v238 offset:0
    v_mfma_f32_16x16x32_bf16 v[172:175], v[180:183], v[132:135], v[172:175]
    ds_read_b64_tr_b16 v[178:179], v238 offset:6144
    s_waitcnt lgkmcnt(3)
    v_mfma_f32_16x16x32_bf16 v[168:171], v[184:187], v[112:115], v[168:171]
    ds_read_b64_tr_b16 v[180:181], v239 offset:0
    s_mul_i32 s60, s64, 10240
    s_add_u32 s60, s60, s80
    v_mfma_f32_16x16x32_bf16 v[172:175], v[184:187], v[136:139], v[172:175]
    ds_read_b64_tr_b16 v[182:183], v239 offset:6144
    s_waitcnt lgkmcnt(4)
    v_mfma_f32_16x16x32_bf16 v[168:171], v[188:191], v[116:119], v[168:171]
    ds_read_b64_tr_b16 v[184:185], v240 offset:0
    v_mfma_f32_16x16x32_bf16 v[172:175], v[188:191], v[140:143], v[172:175]
    ds_read_b64_tr_b16 v[186:187], v240 offset:6144
    s_add_u32 m0, s61, 122880
    s_add_u32 s64, s64, 1
    buffer_load_dwordx4 v248, s[32:35], s60 offen sc1 lds
    s_add_u32 s60, s60, 1024
    v_max_f32 v217, v216, v220
    v_cmp_nge_f32 vcc, s73, v217
    s_cbranch_vccnz L_k1_tr7_0
L_k1_back7_0:
    s_waitcnt lgkmcnt(4)
    v_mfma_f32_16x16x32_bf16 v[0:3], v[176:179], v[192:195], v[0:3]
    v_add_f32 v228, v228, v216
    ds_read_b64_tr_b16 v[188:189], v241 offset:0
    v_mfma_f32_16x16x32_bf16 v[4:7], v[176:179], v[200:203], v[4:7]
    v_add_f32 v229, v229, v220
    ds_read_b64_tr_b16 v[190:191], v241 offset:6144
    s_waitcnt lgkmcnt(4)
    v_mfma_f32_16x16x32_bf16 v[8:11], v[180:183], v[192:195], v[8:11]
    ds_read_b64_tr_b16 v[176:177], v238 offset:128
    s_add_u32 m0, s61, 123904
    s_cmp_eq_u32 s64, 6
    buffer_load_dwordx4 v248, s[32:35], s60 offen sc1 lds
    s_cselect_b32 s64, 0, s64
    s_add_u32 s60, s60, 1024
    s_lshl_b32 s62, s65, 11
    s_add_u32 s62, s62, s79
    s_add_u32 s65, s65, 1
    s_cmp_eq_u32 s65, 6
    s_cselect_b32 s65, 0, s65
    s_add_u32 s78, s62, 245760
    v_mfma_f32_16x16x32_bf16 v[12:15], v[180:183], v[200:203], v[12:15]
    v_exp_f32 v230, v160
    v_exp_f32 v231, v161
    ds_read_b64_tr_b16 v[178:179], v238 offset:6272
    s_waitcnt lgkmcnt(4)
    v_mfma_f32_16x16x32_bf16 v[16:19], v[184:187], v[192:195], v[16:19]
    v_exp_f32 v232, v162
    v_exp_f32 v233, v163
    ds_read_b64_tr_b16 v[180:181], v239 offset:128
    buffer_load_dwordx4 v[96:99], v248, s[28:31], s62 offen offset:0 sc1
    v_mfma_f32_16x16x32_bf16 v[20:23], v[184:187], v[200:203], v[20:23]
    v_exp_f32 v234, v164
    v_cvt_pk_bf16_f32 v196, v230, v231
    ds_read_b64_tr_b16 v[182:183], v239 offset:6272
    s_add_u32 m0, s61, 124928
    s_nop 0
    buffer_load_dwordx4 v248, s[32:35], s60 offen sc1 lds
    s_add_u32 s60, s60, 1024
    s_waitcnt lgkmcnt(4)
    v_mfma_f32_16x16x32_bf16 v[24:27], v[188:191], v[192:195], v[24:27]
    v_exp_f32 v235, v165
    v_cvt_pk_bf16_f32 v197, v232, v233
    ds_read_b64_tr_b16 v[184:185], v240 offset:128
    buffer_load_dwordx4 v[100:103], v248, s[28:31], s78 offen offset:0 sc1
    v_mfma_f32_16x16x32_bf16 v[28:31], v[188:191], v[200:203], v[28:31]
    v_exp_f32 v236, v166
    v_exp_f32 v237, v167
    ds_read_b64_tr_b16 v[186:187], v240 offset:6272
    s_waitcnt lgkmcnt(4)
    v_mfma_f32_16x16x32_bf16 v[32:35], v[176:179], v[192:195], v[32:35]
    v_cvt_pk_bf16_f32 v204, v234, v235
    v_cvt_pk_bf16_f32 v205, v236, v237
    ds_read_b64_tr_b16 v[188:189], v241 offset:128
    s_add_u32 m0, s61, 125952
    s_nop 0
    buffer_load_dwordx4 v248, s[32:35], s60 offen sc1 lds
    s_add_u32 s60, s60, 1024
    buffer_load_dwordx4 v[104:107], v248, s[28:31], s62 offen offset:1024 sc1
    v_mfma_f32_16x16x32_bf16 v[36:39], v[176:179], v[200:203], v[36:39]
    v_exp_f32 v230, v168
    ds_read_b64_tr_b16 v[190:191], v241 offset:6272
    s_waitcnt lgkmcnt(4)
    v_mfma_f32_16x16x32_bf16 v[40:43], v[180:183], v[192:195], v[40:43]
    v_exp_f32 v231, v169
    v_exp_f32 v232, v170
    ds_read_b64_tr_b16 v[176:177], v238 offset:256
    buffer_load_dwordx4 v[108:111], v248, s[28:31], s78 offen offset:1024 sc1
    v_mfma_f32_16x16x32_bf16 v[44:47], v[180:183], v[200:203], v[44:47]
    v_exp_f32 v233, v171
    v_exp_f32 v234, v172
    ds_read_b64_tr_b16 v[178:179], v238 offset:6400
    s_add_u32 m0, s61, 126976
    s_nop 0
    buffer_load_dwordx4 v248, s[32:35], s60 offen sc1 lds
    s_add_u32 s60, s60, 1024
    s_waitcnt lgkmcnt(4)
    v_mfma_f32_16x16x32_bf16 v[48:51], v[184:187], v[192:195], v[48:51]
    v_cvt_pk_bf16_f32 v198, v230, v231
    v_exp_f32 v235, v173
    ds_read_b64_tr_b16 v[180:181], v239 offset:256
    v_mfma_f32_16x16x32_bf16 v[52:55], v[184:187], v[200:203], v[52:55]
    v_cvt_pk_bf16_f32 v199, v232, v233
    v_exp_f32 v236, v174
    ds_read_b64_tr_b16 v[182:183], v239 offset:6400
    s_lshl_b32 s62, s65, 11
    s_add_u32 s62, s62, s79
    s_add_u32 s65, s65, 1
    s_cmp_eq_u32 s65, 6
    s_cselect_b32 s65, 0, s65
    s_add_u32 s78, s62, 245760
    s_waitcnt lgkmcnt(4)
    v_mfma_f32_16x16x32_bf16 v[56:59], v[188:191], v[192:195], v[56:59]
    v_exp_f32 v237, v175
    v_cvt_pk_bf16_f32 v206, v234, v235
    ds_read_b64_tr_b16 v[184:185], v240 offset:256
    v_mfma_f32_16x16x32_bf16 v[60:63], v[188:191], v[200:203], v[60:63]
    v_cvt_pk_bf16_f32 v207, v236, v237
    ds_read_b64_tr_b16 v[186:187], v240 offset:6400
    buffer_load_dwordx4 v[112:115], v248, s[28:31], s62 offen offset:0 sc1
    s_waitcnt lgkmcnt(4)
    v_mfma_f32_16x16x32_bf16 v[64:67], v[176:179], v[192:195], v[64:67]
    ds_read_b64_tr_b16 v[188:189], v241 offset:256
    v_mfma_f32_16x16x32_bf16 v[68:71], v[176:179], v[200:203], v[68:71]
    ds_read_b64_tr_b16 v[190:191], v241 offset:6400
    buffer_load_dwordx4 v[116:119], v248, s[28:31], s78 offen offset:0 sc1
    v_mfma_f32_16x16x32_bf16 v[216:219], v[224:227], v[196:199], 0
    v_mfma_f32_16x16x32_bf16 v[220:223], v[224:227], v[204:207], 0
    buffer_load_dwordx4 v[120:123], v248, s[28:31], s62 offen offset:1024 sc1
    s_waitcnt lgkmcnt(4)
    v_mfma_f32_16x16x32_bf16 v[72:75], v[180:183], v[192:195], v[72:75]
    ds_read_b64_tr_b16 v[176:177], v238 offset:12288
    v_mfma_f32_16x16x32_bf16 v[76:79], v[180:183], v[200:203], v[76:79]
    ds_read_b64_tr_b16 v[178:179], v238 offset:18432
    buffer_load_dwordx4 v[124:127], v248, s[28:31], s78 offen offset:1024 sc1
    s_waitcnt lgkmcnt(4)
    v_mfma_f32_16x16x32_bf16 v[80:83], v[184:187], v[192:195], v[80:83]
    ds_read_b64_tr_b16 v[180:181], v239 offset:12288
    v_mfma_f32_16x16x32_bf16 v[84:87], v[184:187], v[200:203], v[84:87]
    ds_read_b64_tr_b16 v[182:183], v239 offset:18432
    s_waitcnt lgkmcnt(4)
    v_mfma_f32_16x16x32_bf16 v[88:91], v[188:191], v[192:195], v[88:91]
    ds_read_b64_tr_b16 v[184:185], v240 offset:12288
    v_mfma_f32_16x16x32_bf16 v[92:95], v[188:191], v[200:203], v[92:95]
    ds_read_b64_tr_b16 v[186:187], v240 offset:18432
    v_max_f32 v217, v216, v220
    v_cmp_nge_f32 vcc, s73, v217
    s_cbranch_vccnz L_k1_tr7_1
L_k1_back7_1:
    s_waitcnt lgkmcnt(4)
    v_mfma_f32_16x16x32_bf16 v[0:3], v[176:179], v[196:199], v[0:3]
    v_add_f32 v228, v228, v216
    ds_read_b64_tr_b16 v[188:189], v241 offset:12288
    v_mfma_f32_16x16x32_bf16 v[4:7], v[176:179], v[204:207], v[4:7]
    v_add_f32 v229, v229, v220
    ds_read_b64_tr_b16 v[190:191], v241 offset:18432
    s_waitcnt lgkmcnt(4)
    v_mfma_f32_16x16x32_bf16 v[8:11], v[180:183], v[196:199], v[8:11]
    ds_read_b64_tr_b16 v[176:177], v238 offset:12416
    s_mul_i32 s70, s53, 6144
    v_mfma_f32_16x16x32_bf16 v[12:15], v[180:183], v[204:207], v[12:15]
    v_rcp_f32 v230, v228
    v_rcp_f32 v231, v229
    ds_read_b64_tr_b16 v[178:179], v238 offset:18560
    s_waitcnt lgkmcnt(4)
    v_mfma_f32_16x16x32_bf16 v[16:19], v[184:187], v[196:199], v[16:19]
    ds_read_b64_tr_b16 v[180:181], v239 offset:12416
    v_mfma_f32_16x16x32_bf16 v[20:23], v[184:187], v[204:207], v[20:23]
    ds_read_b64_tr_b16 v[182:183], v239 offset:18560
    s_waitcnt lgkmcnt(4)
    v_mfma_f32_16x16x32_bf16 v[24:27], v[188:191], v[196:199], v[24:27]
    ds_read_b64_tr_b16 v[184:185], v240 offset:12416
    v_mfma_f32_16x16x32_bf16 v[28:31], v[188:191], v[204:207], v[28:31]
    v_mul_f32 v0, v230, v0
    v_mul_f32 v1, v230, v1
    v_mul_f32 v2, v230, v2
    ds_read_b64_tr_b16 v[186:187], v240 offset:18560
    s_waitcnt lgkmcnt(4)
    v_mfma_f32_16x16x32_bf16 v[32:35], v[176:179], v[196:199], v[32:35]
    v_mul_f32 v3, v230, v3
    v_mul_f32 v8, v230, v8
    v_mul_f32 v9, v230, v9
    ds_read_b64_tr_b16 v[188:189], v241 offset:12416
    v_mfma_f32_16x16x32_bf16 v[36:39], v[176:179], v[204:207], v[36:39]
    v_mul_f32 v10, v230, v10
    v_mul_f32 v11, v230, v11
    v_mul_f32 v4, v231, v4
    ds_read_b64_tr_b16 v[190:191], v241 offset:18560
    s_waitcnt lgkmcnt(4)
    v_mfma_f32_16x16x32_bf16 v[40:43], v[180:183], v[196:199], v[40:43]
    v_mul_f32 v5, v231, v5
    v_mul_f32 v6, v231, v6
    v_mul_f32 v7, v231, v7
    ds_read_b64_tr_b16 v[176:177], v238 offset:12544
    v_mfma_f32_16x16x32_bf16 v[44:47], v[180:183], v[204:207], v[44:47]
    v_mul_f32 v12, v231, v12
    v_mul_f32 v13, v231, v13
    v_mul_f32 v14, v231, v14
    ds_read_b64_tr_b16 v[178:179], v238 offset:18688
    s_waitcnt lgkmcnt(4)
    v_mfma_f32_16x16x32_bf16 v[48:51], v[184:187], v[196:199], v[48:51]
    v_mul_f32 v15, v231, v15
    v_cvt_pk_bf16_f32 v144, v0, v1
    v_cvt_pk_bf16_f32 v145, v2, v3
    ds_read_b64_tr_b16 v[180:181], v239 offset:12544
    v_mfma_f32_16x16x32_bf16 v[52:55], v[184:187], v[204:207], v[52:55]
    v_cvt_pk_bf16_f32 v146, v8, v9
    v_cvt_pk_bf16_f32 v147, v10, v11
    ds_read_b64_tr_b16 v[182:183], v239 offset:18688
    s_add_u32 s66, s70, 0
    buffer_store_dwordx4 v[144:147], v248, s[48:51], s66 offen offset:0 sc1
    s_waitcnt lgkmcnt(4)
    v_mfma_f32_16x16x32_bf16 v[56:59], v[188:191], v[196:199], v[56:59]
    v_cvt_pk_bf16_f32 v148, v4, v5
    v_cvt_pk_bf16_f32 v149, v6, v7
    v_cvt_pk_bf16_f32 v150, v12, v13
    ds_read_b64_tr_b16 v[184:185], v240 offset:12544
    v_mfma_f32_16x16x32_bf16 v[60:63], v[188:191], v[204:207], v[60:63]
    v_cvt_pk_bf16_f32 v151, v14, v15
    ds_read_b64_tr_b16 v[186:187], v240 offset:18688
    s_add_u32 s66, s70, 245760
    buffer_store_dwordx4 v[148:151], v248, s[48:51], s66 offen offset:0 sc1
    v_mul_f32 v16, v230, v16
    s_waitcnt lgkmcnt(4)
    v_mfma_f32_16x16x32_bf16 v[64:67], v[176:179], v[196:199], v[64:67]
    v_mul_f32 v17, v230, v17
    v_mul_f32 v18, v230, v18
    v_mul_f32 v19, v230, v19
    ds_read_b64_tr_b16 v[188:189], v241 offset:12544
    v_mfma_f32_16x16x32_bf16 v[68:71], v[176:179], v[204:207], v[68:71]
    v_mul_f32 v24, v230, v24
    v_mul_f32 v25, v230, v25
    v_mul_f32 v26, v230, v26
    ds_read_b64_tr_b16 v[190:191], v241 offset:18688
    s_waitcnt lgkmcnt(4)
    v_mfma_f32_16x16x32_bf16 v[72:75], v[180:183], v[196:199], v[72:75]
    v_mul_f32 v27, v230, v27
    v_mul_f32 v20, v231, v20
    v_mul_f32 v21, v231, v21
    v_mfma_f32_16x16x32_bf16 v[76:79], v[180:183], v[204:207], v[76:79]
    v_mul_f32 v22, v231, v22
    v_mul_f32 v23, v231, v23
    v_mul_f32 v28, v231, v28
    s_waitcnt lgkmcnt(2)
    v_mfma_f32_16x16x32_bf16 v[80:83], v[184:187], v[196:199], v[80:83]
    v_mul_f32 v29, v231, v29
    v_mul_f32 v30, v231, v30
    v_mul_f32 v31, v231, v31
    v_mfma_f32_16x16x32_bf16 v[84:87], v[184:187], v[204:207], v[84:87]
    v_cvt_pk_bf16_f32 v152, v16, v17
    v_cvt_pk_bf16_f32 v153, v18, v19
    v_cvt_pk_bf16_f32 v154, v24, v25
    s_waitcnt lgkmcnt(0)
    v_mfma_f32_16x16x32_bf16 v[88:91], v[188:191], v[196:199], v[88:91]
    v_cvt_pk_bf16_f32 v155, v26, v27
    s_add_u32 s66, s70, 0
    buffer_store_dwordx4 v[152:155], v248, s[48:51], s66 offen offset:1024 sc1
    v_cvt_pk_bf16_f32 v156, v20, v21
    v_mfma_f32_16x16x32_bf16 v[92:95], v[188:191], v[204:207], v[92:95]
    s_nop 7
    v_cvt_pk_bf16_f32 v157, v22, v23
    v_cvt_pk_bf16_f32 v158, v28, v29
    v_cvt_pk_bf16_f32 v159, v30, v31
    s_add_u32 s66, s70, 245760
    buffer_store_dwordx4 v[156:159], v248, s[48:51], s66 offen offset:1024 sc1
    v_mul_f32 v32, v230, v32
    v_mul_f32 v33, v230, v33
    v_mul_f32 v34, v230, v34
    v_mul_f32 v35, v230, v35
    v_mul_f32 v40, v230, v40
    v_mul_f32 v41, v230, v41
    v_mul_f32 v42, v230, v42
    v_mul_f32 v43, v230, v43
    v_mul_f32 v36, v231, v36
    v_mul_f32 v37, v231, v37
    v_mul_f32 v38, v231, v38
    v_mul_f32 v39, v231, v39
    v_mul_f32 v44, v231, v44
    v_mul_f32 v45, v231, v45
    v_mul_f32 v46, v231, v46
    v_mul_f32 v47, v231, v47
    v_cvt_pk_bf16_f32 v160, v32, v33
    v_cvt_pk_bf16_f32 v161, v34, v35
    v_cvt_pk_bf16_f32 v162, v40, v41
    v_cvt_pk_bf16_f32 v163, v42, v43
    s_add_u32 s66, s70, 0
    buffer_store_dwordx4 v[160:163], v248, s[48:51], s66 offen offset:2048 sc1
    v_cvt_pk_bf16_f32 v164, v36, v37
    v_cvt_pk_bf16_f32 v165, v38, v39
    v_cvt_pk_bf16_f32 v166, v44, v45
    v_cvt_pk_bf16_f32 v167, v46, v47
    s_add_u32 s66, s70, 245760
    buffer_store_dwordx4 v[164:167], v248, s[48:51], s66 offen offset:2048 sc1
    v_mul_f32 v48, v230, v48
    v_mul_f32 v49, v230, v49
    v_mul_f32 v50, v230, v50
    v_mul_f32 v51, v230, v51
    v_mul_f32 v56, v230, v56
    v_mul_f32 v57, v230, v57
    v_mul_f32 v58, v230, v58
    v_mul_f32 v59, v230, v59
    v_mul_f32 v52, v231, v52
    v_mul_f32 v53, v231, v53
    v_mul_f32 v54, v231, v54
    v_mul_f32 v55, v231, v55
    v_mul_f32 v60, v231, v60
    v_mul_f32 v61, v231, v61
    v_mul_f32 v62, v231, v62
    v_mul_f32 v63, v231, v63
    v_cvt_pk_bf16_f32 v168, v48, v49
    v_cvt_pk_bf16_f32 v169, v50, v51
    v_cvt_pk_bf16_f32 v170, v56, v57
    v_cvt_pk_bf16_f32 v171, v58, v59
    s_add_u32 s66, s70, 0
    buffer_store_dwordx4 v[168:171], v248, s[48:51], s66 offen offset:3072 sc1
    v_cvt_pk_bf16_f32 v172, v52, v53
    v_cvt_pk_bf16_f32 v173, v54, v55
    v_cvt_pk_bf16_f32 v174, v60, v61
    v_cvt_pk_bf16_f32 v175, v62, v63
    s_add_u32 s66, s70, 245760
    buffer_store_dwordx4 v[172:175], v248, s[48:51], s66 offen offset:3072 sc1
    v_mul_f32 v64, v230, v64
    v_mul_f32 v65, v230, v65
    v_mul_f32 v66, v230, v66
    v_mul_f32 v67, v230, v67
    v_mul_f32 v72, v230, v72
    v_mul_f32 v73, v230, v73
    v_mul_f32 v74, v230, v74
    v_mul_f32 v75, v230, v75
    v_mul_f32 v68, v231, v68
    v_mul_f32 v69, v231, v69
    v_mul_f32 v70, v231, v70
    v_mul_f32 v71, v231, v71
    v_mul_f32 v76, v231, v76
    v_mul_f32 v77, v231, v77
    v_mul_f32 v78, v231, v78
    v_mul_f32 v79, v231, v79
    v_cvt_pk_bf16_f32 v144, v64, v65
    v_cvt_pk_bf16_f32 v145, v66, v67
    v_cvt_pk_bf16_f32 v146, v72, v73
    v_cvt_pk_bf16_f32 v147, v74, v75
    s_add_u32 s66, s70, 4096
    buffer_store_dwordx4 v[144:147], v248, s[48:51], s66 offen offset:0 sc1
    v_cvt_pk_bf16_f32 v148, v68, v69
    v_cvt_pk_bf16_f32 v149, v70, v71
    v_cvt_pk_bf16_f32 v150, v76, v77
    v_cvt_pk_bf16_f32 v151, v78, v79
    s_add_u32 s66, s70, 249856
    buffer_store_dwordx4 v[148:151], v248, s[48:51], s66 offen offset:0 sc1
    v_mul_f32 v80, v230, v80
    v_mul_f32 v81, v230, v81
    v_mul_f32 v82, v230, v82
    v_mul_f32 v83, v230, v83
    v_mul_f32 v88, v230, v88
    v_mul_f32 v89, v230, v89
    v_mul_f32 v90, v230, v90
    v_mul_f32 v91, v230, v91
    v_mul_f32 v84, v231, v84
    v_mul_f32 v85, v231, v85
    v_mul_f32 v86, v231, v86
    v_mul_f32 v87, v231, v87
    v_mul_f32 v92, v231, v92
    v_mul_f32 v93, v231, v93
    v_mul_f32 v94, v231, v94
    v_mul_f32 v95, v231, v95
    v_cvt_pk_bf16_f32 v152, v80, v81
    v_cvt_pk_bf16_f32 v153, v82, v83
    v_cvt_pk_bf16_f32 v154, v88, v89
    v_cvt_pk_bf16_f32 v155, v90, v91
    s_add_u32 s66, s70, 4096
    buffer_store_dwordx4 v[152:155], v248, s[48:51], s66 offen offset:1024 sc1
    v_cvt_pk_bf16_f32 v156, v84, v85
    v_cvt_pk_bf16_f32 v157, v86, v87
    v_cvt_pk_bf16_f32 v158, v92, v93
    v_cvt_pk_bf16_f32 v159, v94, v95
    s_add_u32 s66, s70, 249856
    buffer_store_dwordx4 v[156:159], v248, s[48:51], s66 offen offset:1024 sc1
    s_nop 1
    v_lshrrev_b32 v166, 4, v248
    v_lshrrev_b32 v164, 2, v166
    v_and_b32 v165, 3, v166
    v_lshlrev_b32 v165, 3, v165
    v_mul_u32_u24 v167, 160, v164
    s_mul_i32 s98, s63, 10240
    s_add_u32 s98, s98, 81920
    v_add3_u32 v162, v167, v165, s98
    s_waitcnt vmcnt(16)
    s_waitcnt lgkmcnt(0)
    s_barrier
    ds_read_b64_tr_b16 v[144:145], v162 offset:0
    ds_read_b64_tr_b16 v[146:147], v162 offset:2560
    ds_read_b64_tr_b16 v[148:149], v162 offset:32
    ds_read_b64_tr_b16 v[150:151], v162 offset:2592
    ds_read_b64_tr_b16 v[152:153], v162 offset:64
    ds_read_b64_tr_b16 v[154:155], v162 offset:2624
    s_waitcnt lgkmcnt(4)
    v_mfma_f32_16x16x32_bf16 v[176:179], v[144:147], v[96:99], 0
    v_mul_u32_u24 v167, 320, v164
    ds_read_b64_tr_b16 v[156:157], v162 offset:96
    s_mul_i32 s98, s58, 20480
    v_mfma_f32_16x16x32_bf16 v[180:183], v[144:147], v[100:103], 0
    ds_read_b64_tr_b16 v[158:159], v162 offset:2656
    s_mul_i32 s98, s58, 20480
    s_add_u32 s98, s98, 0
    v_add3_u32 v167, v167, v165, s98
    v_bfe_u32 v168, v166, 4, 1
    s_lshl_b32 s62, s65, 11
    s_add_u32 s62, s62, s79
    s_add_u32 s65, s65, 1
    s_cmp_eq_u32 s65, 6
    s_cselect_b32 s65, 0, s65
    s_add_u32 s78, s62, 245760
    s_mul_i32 s60, s64, 10240
    s_add_u32 s60, s60, s80
    s_waitcnt lgkmcnt(4)
    v_mfma_f32_16x16x32_bf16 v[184:187], v[148:151], v[96:99], 0
    v_lshlrev_b32 v168, 5, v168
    ds_read_b64_tr_b16 v[144:145], v162 offset:128
    v_mfma_f32_16x16x32_bf16 v[188:191], v[148:151], v[100:103], 0
    ds_read_b64_tr_b16 v[146:147], v162 offset:2688
    v_add_u32 v160, v167, v168
    v_sub_u32 v161, v167, v168
    buffer_load_dwordx4 v[128:131], v248, s[28:31], s62 offen offset:0 sc1
    s_add_u32 m0, s61, 0
    s_add_u32 s64, s64, 1
    buffer_load_dwordx4 v248, s[32:35], s60 offen sc1 lds
    s_add_u32 s60, s60, 1024
    s_waitcnt lgkmcnt(4)
    v_mfma_f32_16x16x32_bf16 v[192:195], v[152:155], v[96:99], 0
    v_and_b32 v171, 0x30, v166
    ds_read_b64_tr_b16 v[148:149], v162 offset:5120
    v_mfma_f32_16x16x32_bf16 v[196:199], v[152:155], v[100:103], 0
    ds_read_b64_tr_b16 v[150:151], v162 offset:7680
    s_and_b32 s81, s52, 3
    s_lshl_b32 s81, s81, 4
    v_add_u32 v168, 0, v166
    buffer_load_dwordx4 v[132:135], v248, s[28:31], s78 offen offset:0 sc1
    s_add_u32 m0, s61, 1024
    s_cmp_eq_u32 s64, 6
    buffer_load_dwordx4 v248, s[32:35], s60 offen sc1 lds
    s_cselect_b32 s64, 0, s64
    s_add_u32 s60, s60, 1024
    s_waitcnt vmcnt(4)
    s_barrier
    s_and_b32 s97, s54, 3
    s_lshl_b32 s97, s97, 6
    s_and_b32 s98, s54, 4
    s_add_u32 s97, s97, s98
    s_lshr_b32 s98, s53, 3
    s_add_u32 s97, s97, s98
    s_lshl_b32 s97, s97, 7
    s_and_b32 s98, s53, 7
    s_lshl_b32 s98, s98, 2
    s_add_u32 s97, s97, s98
    s_add_u32 s97, s97, 16416
    s_cmp_eq_u32 s52, 0
    s_cselect_b32 s97, s97, 0x100000
    v_lshlrev_b32 v224, 6, v248
    v_mov_b32 v225, 1
    s_mov_b64 exec, 0xff
    buffer_store_dword v225, v224, s[88:91], s97 offen sc1
    s_mov_b64 exec, -1
    s_waitcnt lgkmcnt(4)
    v_mfma_f32_16x16x32_bf16 v[200:203], v[156:159], v[96:99], 0
    v_mul_u32_u24 v169, 3277, v168
    v_lshrrev_b32 v169, 16, v169
    ds_read_b64_tr_b16 v[152:153], v162 offset:5152
    v_mfma_f32_16x16x32_bf16 v[204:207], v[156:159], v[100:103], 0
    v_mul_u32_u24 v170, 20, v169
    ds_read_b64_tr_b16 v[154:155], v162 offset:7712
    s_add_u32 m0, s61, 2048
    s_nop 0
    buffer_load_dwordx4 v248, s[32:35], s60 offen sc1 lds
    s_add_u32 s60, s60, 1024
    s_waitcnt lgkmcnt(4)
    v_mfma_f32_16x16x32_bf16 v[208:211], v[144:147], v[96:99], 0
    v_sub_u32 v170, v168, v170
    ds_read_b64_tr_b16 v[156:157], v162 offset:5184
    v_add_u32 v169, s81, v169
    buffer_load_dwordx4 v[136:139], v248, s[28:31], s62 offen offset:1024 sc1
    v_mfma_f32_16x16x32_bf16 v[212:215], v[144:147], v[100:103], 0
    v_bfe_u32 v168, v169, 2, 1
    ds_read_b64_tr_b16 v[158:159], v162 offset:7744
    s_add_u32 m0, s61, 3072
    s_nop 0
    buffer_load_dwordx4 v248, s[32:35], s60 offen sc1 lds
    s_add_u32 s60, s60, 1024
    s_waitcnt lgkmcnt(4)
    v_mfma_f32_16x16x32_bf16 v[176:179], v[148:151], v[104:107], v[176:179]
    v_lshlrev_b32 v168, 1, v168
    v_xor_b32 v170, v170, v168
    ds_read_b64_tr_b16 v[144:145], v162 offset:5216
    buffer_load_dwordx4 v[140:143], v248, s[28:31], s78 offen offset:1024 sc1
    v_mfma_f32_16x16x32_bf16 v[180:183], v[148:151], v[108:111], v[180:183]
    v_mul_u32_u24 v169, 1280, v169
    v_lshl_add_u32 v216, v170, 4, v169
    ds_read_b64_tr_b16 v[146:147], v162 offset:7776
    s_add_u32 m0, s61, 4096
    s_nop 0
    buffer_load_dwordx4 v248, s[32:35], s60 offen sc1 lds
    s_add_u32 s60, s60, 1024
    s_waitcnt lgkmcnt(4)
    v_mfma_f32_16x16x32_bf16 v[184:187], v[152:155], v[104:107], v[184:187]
    ds_read_b64_tr_b16 v[148:149], v162 offset:5248
    v_add_u32 v168, 64, v166
    v_mfma_f32_16x16x32_bf16 v[188:191], v[152:155], v[108:111], v[188:191]
    v_mul_u32_u24 v169, 3277, v168
    v_lshrrev_b32 v169, 16, v169
    ds_read_b64_tr_b16 v[150:151], v162 offset:7808
    s_waitcnt lgkmcnt(0)
    s_barrier
    v_mfma_f32_16x16x32_bf16 v[192:195], v[156:159], v[104:107], v[192:195]
    v_mul_u32_u24 v170, 20, v169
    ds_read_b64_tr_b16 v[152:153], v162 offset:40960
    v_mfma_f32_16x16x32_bf16 v[196:199], v[156:159], v[108:111], v[196:199]
    v_sub_u32 v170, v168, v170
    ds_read_b64_tr_b16 v[154:155], v162 offset:43520
    v_add_u32 v169, s81, v169
    v_mfma_f32_16x16x32_bf16 v[200:203], v[144:147], v[104:107], v[200:203]
    v_bfe_u32 v168, v169, 2, 1
    v_lshlrev_b32 v168, 1, v168
    ds_read_b64_tr_b16 v[156:157], v162 offset:40992
    v_mfma_f32_16x16x32_bf16 v[204:207], v[144:147], v[108:111], v[204:207]
    v_xor_b32 v170, v170, v168
    ds_read_b64_tr_b16 v[158:159], v162 offset:43552
    v_mfma_f32_16x16x32_bf16 v[208:211], v[148:151], v[104:107], v[208:211]
    v_mul_u32_u24 v169, 1280, v169
    v_lshl_add_u32 v217, v170, 4, v169
    ds_read_b64_tr_b16 v[144:145], v162 offset:41024
    v_mfma_f32_16x16x32_bf16 v[212:215], v[148:151], v[108:111], v[212:215]
    ds_read_b64_tr_b16 v[146:147], v162 offset:43584
    v_add_u32 v168, 128, v166
    s_waitcnt lgkmcnt(4)
    v_mfma_f32_16x16x32_bf16 v[176:179], v[152:155], v[112:115], v[176:179]
    v_mul_u32_u24 v169, 3277, v168
    v_lshrrev_b32 v169, 16, v169
    ds_read_b64_tr_b16 v[148:149], v162 offset:41056
    v_mfma_f32_16x16x32_bf16 v[180:183], v[152:155], v[116:119], v[180:183]
    v_mul_u32_u24 v170, 20, v169
    v_sub_u32 v170, v168, v170
    ds_read_b64_tr_b16 v[150:151], v162 offset:43616
    s_lshl_b32 s62, s65, 11
    s_add_u32 s62, s62, s79
    s_add_u32 s65, s65, 1
    s_cmp_eq_u32 s65, 6
    s_cselect_b32 s65, 0, s65
    s_add_u32 s78, s62, 245760
    s_mul_i32 s60, s64, 10240
    s_add_u32 s60, s60, s80
    s_waitcnt lgkmcnt(4)
    v_mfma_f32_16x16x32_bf16 v[184:187], v[156:159], v[112:115], v[184:187]
    ds_read_b64_tr_b16 v[152:153], v162 offset:41088
    v_add_u32 v169, s81, v169
    v_mfma_f32_16x16x32_bf16 v[188:191], v[156:159], v[116:119], v[188:191]
    v_bfe_u32 v168, v169, 2, 1
    v_lshlrev_b32 v168, 1, v168
    ds_read_b64_tr_b16 v[154:155], v162 offset:43648
    buffer_load_dwordx4 v[80:83], v248, s[28:31], s62 offen offset:0 sc1
    s_add_u32 m0, s61, 40960
    s_add_u32 s64, s64, 1
    buffer_load_dwordx4 v248, s[32:35], s60 offen sc1 lds
    s_add_u32 s60, s60, 1024
    s_waitcnt lgkmcnt(4)
    v_mfma_f32_16x16x32_bf16 v[192:195], v[144:147], v[112:115], v[192:195]
    v_xor_b32 v170, v170, v168
    ds_read_b64_tr_b16 v[156:157], v162 offset:46080
    v_mfma_f32_16x16x32_bf16 v[196:199], v[144:147], v[116:119], v[196:199]
    v_mul_u32_u24 v169, 1280, v169
    v_lshl_add_u32 v218, v170, 4, v169
    ds_read_b64_tr_b16 v[158:159], v162 offset:48640
    buffer_load_dwordx4 v[84:87], v248, s[28:31], s78 offen offset:0 sc1
    s_add_u32 m0, s61, 41984
    s_cmp_eq_u32 s64, 6
    buffer_load_dwordx4 v248, s[32:35], s60 offen sc1 lds
    s_cselect_b32 s64, 0, s64
    s_add_u32 s60, s60, 1024
    s_waitcnt lgkmcnt(4)
    v_mfma_f32_16x16x32_bf16 v[200:203], v[148:151], v[112:115], v[200:203]
    ds_read_b64_tr_b16 v[144:145], v162 offset:46112
    v_add_u32 v168, 192, v166
    v_mul_u32_u24 v169, 3277, v168
    v_mfma_f32_16x16x32_bf16 v[204:207], v[148:151], v[116:119], v[204:207]
    v_lshrrev_b32 v169, 16, v169
    ds_read_b64_tr_b16 v[146:147], v162 offset:48672
    s_add_u32 m0, s61, 43008
    s_nop 0
    buffer_load_dwordx4 v248, s[32:35], s60 offen sc1 lds
    s_add_u32 s60, s60, 1024
    s_waitcnt lgkmcnt(4)
    v_mfma_f32_16x16x32_bf16 v[208:211], v[152:155], v[112:115], v[208:211]
    v_mul_u32_u24 v170, 20, v169
    v_sub_u32 v170, v168, v170
    ds_read_b64_tr_b16 v[148:149], v162 offset:46144
    buffer_load_dwordx4 v[88:91], v248, s[28:31], s62 offen offset:1024 sc1
    v_mfma_f32_16x16x32_bf16 v[212:215], v[152:155], v[116:119], v[212:215]
    ds_read_b64_tr_b16 v[150:151], v162 offset:48704
    v_add_u32 v169, s81, v169
    s_add_u32 m0, s61, 44032
    s_nop 0
    buffer_load_dwordx4 v248, s[32:35], s60 offen sc1 lds
    s_add_u32 s60, s60, 1024
    s_waitcnt lgkmcnt(4)
    v_mfma_f32_16x16x32_bf16 v[176:179], v[156:159], v[120:123], v[176:179]
    v_bfe_u32 v168, v169, 2, 1
    v_lshlrev_b32 v168, 1, v168
    ds_read_b64_tr_b16 v[152:153], v162 offset:46176
    buffer_load_dwordx4 v[92:95], v248, s[28:31], s78 offen offset:1024 sc1
    v_mfma_f32_16x16x32_bf16 v[180:183], v[156:159], v[124:127], v[180:183]
    v_xor_b32 v170, v170, v168
    v_mul_u32_u24 v169, 1280, v169
    ds_read_b64_tr_b16 v[154:155], v162 offset:48736
    s_add_u32 m0, s61, 45056
    s_nop 0
    buffer_load_dwordx4 v248, s[32:35], s60 offen sc1 lds
    s_add_u32 s60, s60, 1024
    s_waitcnt lgkmcnt(4)
    v_mfma_f32_16x16x32_bf16 v[184:187], v[144:147], v[120:123], v[184:187]
    v_lshl_add_u32 v219, v170, 4, v169
    ds_read_b64_tr_b16 v[156:157], v162 offset:46208
    v_mfma_f32_16x16x32_bf16 v[188:191], v[144:147], v[124:127], v[188:191]
    ds_read_b64_tr_b16 v[158:159], v162 offset:48768
    v_add_u32 v168, 256, v166
    v_mul_u32_u24 v169, 3277, v168
    s_waitcnt vmcnt(9)
    s_waitcnt lgkmcnt(0)
    s_barrier
    v_add_u32 v162, 4294885376, v162
    v_mfma_f32_16x16x32_bf16 v[192:195], v[148:151], v[120:123], v[192:195]
    v_lshrrev_b32 v169, 16, v169
    ds_read_b64_tr_b16 v[144:145], v162 offset:0
    v_mfma_f32_16x16x32_bf16 v[196:199], v[148:151], v[124:127], v[196:199]
    v_mul_u32_u24 v170, 20, v169
    v_sub_u32 v170, v168, v170
    ds_read_b64_tr_b16 v[146:147], v162 offset:2560
    v_mfma_f32_16x16x32_bf16 v[200:203], v[152:155], v[120:123], v[200:203]
    ds_read_b64_tr_b16 v[148:149], v162 offset:32
    v_add_u32 v169, s81, v169
    v_bfe_u32 v168, v169, 2, 1
    v_mfma_f32_16x16x32_bf16 v[204:207], v[152:155], v[124:127], v[204:207]
    v_lshlrev_b32 v168, 1, v168
    ds_read_b64_tr_b16 v[150:151], v162 offset:2592
    v_mfma_f32_16x16x32_bf16 v[208:211], v[156:159], v[120:123], v[208:211]
    v_xor_b32 v170, v170, v168
    v_mul_u32_u24 v169, 1280, v169
    ds_read_b64_tr_b16 v[152:153], v162 offset:64
    v_mfma_f32_16x16x32_bf16 v[212:215], v[156:159], v[124:127], v[212:215]
    v_lshl_add_u32 v220, v170, 4, v169
    ds_read_b64_tr_b16 v[154:155], v162 offset:2624
    s_waitcnt lgkmcnt(4)
    v_mfma_f32_16x16x32_bf16 v[176:179], v[144:147], v[128:131], v[176:179]
    ds_read_b64_tr_b16 v[156:157], v162 offset:96
    v_mfma_f32_16x16x32_bf16 v[180:183], v[144:147], v[132:135], v[180:183]
    ds_read_b64_tr_b16 v[158:159], v162 offset:2656
    s_lshl_b32 s62, s65, 11
    s_add_u32 s62, s62, s79
    s_add_u32 s65, s65, 1
    s_cmp_eq_u32 s65, 6
    s_cselect_b32 s65, 0, s65
    s_add_u32 s78, s62, 245760
    s_mul_i32 s60, s64, 10240
    s_add_u32 s60, s60, s80
    s_waitcnt lgkmcnt(4)
    v_mfma_f32_16x16x32_bf16 v[184:187], v[148:151], v[128:131], v[184:187]
    ds_read_b64_tr_b16 v[144:145], v162 offset:128
    v_mfma_f32_16x16x32_bf16 v[188:191], v[148:151], v[132:135], v[188:191]
    ds_read_b64_tr_b16 v[146:147], v162 offset:2688
    buffer_load_dwordx4 v[96:99], v248, s[28:31], s62 offen offset:0 sc1
    s_add_u32 m0, s61, 81920
    s_add_u32 s64, s64, 1
    buffer_load_dwordx4 v248, s[32:35], s60 offen sc1 lds
    s_add_u32 s60, s60, 1024
    s_waitcnt lgkmcnt(4)
    v_mfma_f32_16x16x32_bf16 v[192:195], v[152:155], v[128:131], v[192:195]
    ds_read_b64_tr_b16 v[148:149], v162 offset:5120
    v_mfma_f32_16x16x32_bf16 v[196:199], v[152:155], v[132:135], v[196:199]
    ds_read_b64_tr_b16 v[150:151], v162 offset:7680
    buffer_load_dwordx4 v[100:103], v248, s[28:31], s78 offen offset:0 sc1
    s_add_u32 m0, s61, 82944
    s_cmp_eq_u32 s64, 6
    buffer_load_dwordx4 v248, s[32:35], s60 offen sc1 lds
    s_cselect_b32 s64, 0, s64
    s_add_u32 s60, s60, 1024
    s_waitcnt lgkmcnt(4)
    v_mfma_f32_16x16x32_bf16 v[200:203], v[156:159], v[128:131], v[200:203]
    ds_read_b64_tr_b16 v[152:153], v162 offset:5152
    v_mfma_f32_16x16x32_bf16 v[204:207], v[156:159], v[132:135], v[204:207]
    ds_read_b64_tr_b16 v[154:155], v162 offset:7712
    s_add_u32 m0, s61, 83968
    s_nop 0
    buffer_load_dwordx4 v248, s[32:35], s60 offen sc1 lds
    s_add_u32 s60, s60, 1024
    s_waitcnt lgkmcnt(4)
    v_mfma_f32_16x16x32_bf16 v[208:211], v[144:147], v[128:131], v[208:211]
    ds_read_b64_tr_b16 v[156:157], v162 offset:5184
    buffer_load_dwordx4 v[104:107], v248, s[28:31], s62 offen offset:1024 sc1
    v_mfma_f32_16x16x32_bf16 v[212:215], v[144:147], v[132:135], v[212:215]
    ds_read_b64_tr_b16 v[158:159], v162 offset:7744
    s_add_u32 m0, s61, 84992
    s_nop 0
    buffer_load_dwordx4 v248, s[32:35], s60 offen sc1 lds
    s_add_u32 s60, s60, 1024
    s_waitcnt lgkmcnt(4)
    v_mfma_f32_16x16x32_bf16 v[176:179], v[148:151], v[136:139], v[176:179]
    ds_read_b64_tr_b16 v[144:145], v162 offset:5216
    buffer_load_dwordx4 v[108:111], v248, s[28:31], s78 offen offset:1024 sc1
    v_mfma_f32_16x16x32_bf16 v[180:183], v[148:151], v[140:143], v[180:183]
    ds_read_b64_tr_b16 v[146:147], v162 offset:7776
    s_add_u32 m0, s61, 86016
    s_nop 0
    buffer_load_dwordx4 v248, s[32:35], s60 offen sc1 lds
    s_add_u32 s60, s60, 1024
    s_waitcnt lgkmcnt(4)
    v_mfma_f32_16x16x32_bf16 v[184:187], v[152:155], v[136:139], v[184:187]
    ds_read_b64_tr_b16 v[148:149], v162 offset:5248
    v_mfma_f32_16x16x32_bf16 v[188:191], v[152:155], v[140:143], v[188:191]
    ds_read_b64_tr_b16 v[150:151], v162 offset:7808
    s_waitcnt vmcnt(9)
    s_waitcnt lgkmcnt(0)
    s_barrier
    v_mfma_f32_16x16x32_bf16 v[192:195], v[156:159], v[136:139], v[192:195]
    ds_read_b64_tr_b16 v[152:153], v162 offset:40960
    v_mfma_f32_16x16x32_bf16 v[196:199], v[156:159], v[140:143], v[196:199]
    ds_read_b64_tr_b16 v[154:155], v162 offset:43520
    v_mfma_f32_16x16x32_bf16 v[200:203], v[144:147], v[136:139], v[200:203]
    ds_read_b64_tr_b16 v[156:157], v162 offset:40992
    v_mfma_f32_16x16x32_bf16 v[204:207], v[144:147], v[140:143], v[204:207]
    ds_read_b64_tr_b16 v[158:159], v162 offset:43552
    v_mfma_f32_16x16x32_bf16 v[208:211], v[148:151], v[136:139], v[208:211]
    ds_read_b64_tr_b16 v[144:145], v162 offset:41024
    v_mfma_f32_16x16x32_bf16 v[212:215], v[148:151], v[140:143], v[212:215]
    ds_read_b64_tr_b16 v[146:147], v162 offset:43584
    s_waitcnt lgkmcnt(4)
    v_mfma_f32_16x16x32_bf16 v[176:179], v[152:155], v[80:83], v[176:179]
    ds_read_b64_tr_b16 v[148:149], v162 offset:41056
    v_mfma_f32_16x16x32_bf16 v[180:183], v[152:155], v[84:87], v[180:183]
    ds_read_b64_tr_b16 v[150:151], v162 offset:43616
    s_lshl_b32 s62, s65, 11
    s_add_u32 s62, s62, s79
    s_add_u32 s65, s65, 1
    s_cmp_eq_u32 s65, 6
    s_cselect_b32 s65, 0, s65
    s_add_u32 s78, s62, 245760
    s_mul_i32 s60, s64, 10240
    s_add_u32 s60, s60, s80
    s_waitcnt lgkmcnt(4)
    v_mfma_f32_16x16x32_bf16 v[184:187], v[156:159], v[80:83], v[184:187]
    ds_read_b64_tr_b16 v[152:153], v162 offset:41088
    v_mfma_f32_16x16x32_bf16 v[188:191], v[156:159], v[84:87], v[188:191]
    ds_read_b64_tr_b16 v[154:155], v162 offset:43648
    buffer_load_dwordx4 v[112:115], v248, s[28:31], s62 offen offset:0 sc1
    s_add_u32 m0, s61, 122880
    s_add_u32 s64, s64, 1
    buffer_load_dwordx4 v248, s[32:35], s60 offen sc1 lds
    s_add_u32 s60, s60, 1024
    s_waitcnt lgkmcnt(4)
    v_mfma_f32_16x16x32_bf16 v[192:195], v[144:147], v[80:83], v[192:195]
    ds_read_b64_tr_b16 v[156:157], v162 offset:46080
    v_mfma_f32_16x16x32_bf16 v[196:199], v[144:147], v[84:87], v[196:199]
    ds_read_b64_tr_b16 v[158:159], v162 offset:48640
    buffer_load_dwordx4 v[116:119], v248, s[28:31], s78 offen offset:0 sc1
    s_add_u32 m0, s61, 123904
    s_cmp_eq_u32 s64, 6
    buffer_load_dwordx4 v248, s[32:35], s60 offen sc1 lds
    s_cselect_b32 s64, 0, s64
    s_add_u32 s60, s60, 1024
    s_waitcnt lgkmcnt(4)
    v_mfma_f32_16x16x32_bf16 v[200:203], v[148:151], v[80:83], v[200:203]
    ds_read_b64_tr_b16 v[144:145], v162 offset:46112
    v_mfma_f32_16x16x32_bf16 v[204:207], v[148:151], v[84:87], v[204:207]
    ds_read_b64_tr_b16 v[146:147], v162 offset:48672
    s_add_u32 m0, s61, 124928
    s_nop 0
    buffer_load_dwordx4 v248, s[32:35], s60 offen sc1 lds
    s_add_u32 s60, s60, 1024
    s_waitcnt lgkmcnt(4)
    v_mfma_f32_16x16x32_bf16 v[208:211], v[152:155], v[80:83], v[208:211]
    ds_read_b64_tr_b16 v[148:149], v162 offset:46144
    buffer_load_dwordx4 v[120:123], v248, s[28:31], s62 offen offset:1024 sc1
    v_mfma_f32_16x16x32_bf16 v[212:215], v[152:155], v[84:87], v[212:215]
    ds_read_b64_tr_b16 v[150:151], v162 offset:48704
    s_add_u32 m0, s61, 125952
    s_nop 0
    buffer_load_dwordx4 v248, s[32:35], s60 offen sc1 lds
    s_add_u32 s60, s60, 1024
    s_waitcnt lgkmcnt(4)
    v_mfma_f32_16x16x32_bf16 v[176:179], v[156:159], v[88:91], v[176:179]
    ds_read_b64_tr_b16 v[152:153], v162 offset:46176
    buffer_load_dwordx4 v[124:127], v248, s[28:31], s78 offen offset:1024 sc1
    v_mfma_f32_16x16x32_bf16 v[180:183], v[156:159], v[92:95], v[180:183]
    ds_read_b64_tr_b16 v[154:155], v162 offset:48736
    s_add_u32 m0, s61, 126976
    s_nop 0
    buffer_load_dwordx4 v248, s[32:35], s60 offen sc1 lds
    s_add_u32 s60, s60, 1024
    s_waitcnt lgkmcnt(4)
    v_mfma_f32_16x16x32_bf16 v[184:187], v[144:147], v[88:91], v[184:187]
    ds_read_b64_tr_b16 v[156:157], v162 offset:46208
    v_mfma_f32_16x16x32_bf16 v[188:191], v[144:147], v[92:95], v[188:191]
    ds_read_b64_tr_b16 v[158:159], v162 offset:48768
    s_waitcnt vmcnt(9)
    s_waitcnt lgkmcnt(0)
    s_barrier
    v_add_u32 v162, 81920, v162
    v_mfma_f32_16x16x32_bf16 v[192:195], v[148:151], v[88:91], v[192:195]
    ds_read_b64_tr_b16 v[144:145], v162 offset:0
    v_mfma_f32_16x16x32_bf16 v[196:199], v[148:151], v[92:95], v[196:199]
    ds_read_b64_tr_b16 v[146:147], v162 offset:2560
    v_mfma_f32_16x16x32_bf16 v[200:203], v[152:155], v[88:91], v[200:203]
    ds_read_b64_tr_b16 v[148:149], v162 offset:32
    v_mfma_f32_16x16x32_bf16 v[204:207], v[152:155], v[92:95], v[204:207]
    ds_read_b64_tr_b16 v[150:151], v162 offset:2592
    v_mfma_f32_16x16x32_bf16 v[208:211], v[156:159], v[88:91], v[208:211]
    ds_read_b64_tr_b16 v[152:153], v162 offset:64
    v_mfma_f32_16x16x32_bf16 v[212:215], v[156:159], v[92:95], v[212:215]
    ds_read_b64_tr_b16 v[154:155], v162 offset:2624
    s_waitcnt lgkmcnt(4)
    v_mfma_f32_16x16x32_bf16 v[176:179], v[144:147], v[96:99], v[176:179]
    ds_read_b64_tr_b16 v[156:157], v162 offset:96
    v_mfma_f32_16x16x32_bf16 v[180:183], v[144:147], v[100:103], v[180:183]
    ds_read_b64_tr_b16 v[158:159], v162 offset:2656
    s_mul_i32 s98, s57, 320
    s_add_u32 s32, s12, s98
    s_addc_u32 s33, s13, 0
    s_and_b32 s33, s33, 0xffff
    s_mov_b32 s34, 0
    s_mov_b32 s35, 0x20000
    s_sub_u32 s34, 7864320, s98
    s_lshl_b32 s97, s55, 1
    s_add_u32 s97, s97, s58
    s_mul_i32 s80, s97, 983040
    s_mov_b32 s64, s96
    s_mul_i32 s60, s64, 81920
    s_add_u32 s60, s60, s80
    s_waitcnt lgkmcnt(4)
    v_mfma_f32_16x16x32_bf16 v[184:187], v[148:151], v[96:99], v[184:187]
    ds_read_b64_tr_b16 v[144:145], v162 offset:128
    v_mfma_f32_16x16x32_bf16 v[188:191], v[148:151], v[100:103], v[188:191]
    ds_read_b64_tr_b16 v[146:147], v162 offset:2688
    s_add_u32 m0, s61, 0
    s_add_u32 s64, s64, 1
    buffer_load_dwordx4 v216, s[32:35], s60 offen lds
    s_waitcnt lgkmcnt(4)
    v_mfma_f32_16x16x32_bf16 v[192:195], v[152:155], v[96:99], v[192:195]
    ds_read_b64_tr_b16 v[148:149], v162 offset:5120
    v_mfma_f32_16x16x32_bf16 v[196:199], v[152:155], v[100:103], v[196:199]
    ds_read_b64_tr_b16 v[150:151], v162 offset:7680
    s_add_u32 m0, s61, 1024
    s_cmp_eq_u32 s64, 12
    buffer_load_dwordx4 v217, s[32:35], s60 offen lds
    s_cselect_b32 s64, 0, s64
    s_waitcnt lgkmcnt(4)
    v_mfma_f32_16x16x32_bf16 v[200:203], v[156:159], v[96:99], v[200:203]
    ds_read_b64_tr_b16 v[152:153], v162 offset:5152
    v_lshrrev_b32 v221, 2, v248
    s_mov_b64 exec, 0xff
    buffer_load_dword v223, v221, s[88:91], s101 offen offset:32 sc1
    s_mov_b64 exec, -1
    v_mfma_f32_16x16x32_bf16 v[204:207], v[156:159], v[100:103], v[204:207]
    ds_read_b64_tr_b16 v[154:155], v162 offset:7712
    s_add_u32 m0, s61, 2048
    s_nop 0
    buffer_load_dwordx4 v218, s[32:35], s60 offen lds
    s_waitcnt lgkmcnt(4)
    v_mfma_f32_16x16x32_bf16 v[208:211], v[144:147], v[96:99], v[208:211]
    ds_read_b64_tr_b16 v[156:157], v162 offset:5184
    v_mfma_f32_16x16x32_bf16 v[212:215], v[144:147], v[100:103], v[212:215]
    ds_read_b64_tr_b16 v[158:159], v162 offset:7744
    s_add_u32 m0, s61, 3072
    s_nop 0
    buffer_load_dwordx4 v219, s[32:35], s60 offen lds
    s_waitcnt lgkmcnt(4)
    v_mfma_f32_16x16x32_bf16 v[176:179], v[148:151], v[104:107], v[176:179]
    ds_read_b64_tr_b16 v[144:145], v162 offset:5216
    v_mfma_f32_16x16x32_bf16 v[180:183], v[148:151], v[108:111], v[180:183]
    ds_read_b64_tr_b16 v[146:147], v162 offset:7776
    s_add_u32 m0, s61, 4096
    s_nop 0
    buffer_load_dwordx4 v220, s[32:35], s60 offen lds
    s_waitcnt lgkmcnt(4)
    v_mfma_f32_16x16x32_bf16 v[184:187], v[152:155], v[104:107], v[184:187]
    ds_read_b64_tr_b16 v[148:149], v162 offset:5248
    v_mfma_f32_16x16x32_bf16 v[188:191], v[152:155], v[108:111], v[188:191]
    ds_read_b64_tr_b16 v[150:151], v162 offset:7808
    s_waitcnt vmcnt(3)
    v_cmp_ne_u32 vcc, 1, v223
    s_cmp_eq_u32 s52, 0
    s_cselect_b32 s97, 0xff, 0
    s_nop 1
    s_and_b32 s97, s97, vcc_lo
    s_cbranch_scc1 L_po_spin
L_po_ok:
    s_waitcnt lgkmcnt(0)
    s_barrier
    v_mfma_f32_16x16x32_bf16 v[192:195], v[156:159], v[104:107], v[192:195]
    ds_read_b64_tr_b16 v[152:153], v162 offset:40960
    v_mfma_f32_16x16x32_bf16 v[196:199], v[156:159], v[108:111], v[196:199]
    ds_read_b64_tr_b16 v[154:155], v162 offset:43520
    v_mfma_f32_16x16x32_bf16 v[200:203], v[144:147], v[104:107], v[200:203]
    ds_read_b64_tr_b16 v[156:157], v162 offset:40992
    v_mfma_f32_16x16x32_bf16 v[204:207], v[144:147], v[108:111], v[204:207]
    ds_read_b64_tr_b16 v[158:159], v162 offset:43552
    v_mfma_f32_16x16x32_bf16 v[208:211], v[148:151], v[104:107], v[208:211]
    ds_read_b64_tr_b16 v[144:145], v162 offset:41024
    v_mfma_f32_16x16x32_bf16 v[212:215], v[148:151], v[108:111], v[212:215]
    ds_read_b64_tr_b16 v[146:147], v162 offset:43584
    s_waitcnt lgkmcnt(4)
    v_mfma_f32_16x16x32_bf16 v[176:179], v[152:155], v[112:115], v[176:179]
    ds_read_b64_tr_b16 v[148:149], v162 offset:41056
    v_mfma_f32_16x16x32_bf16 v[180:183], v[152:155], v[116:119], v[180:183]
    ds_read_b64_tr_b16 v[150:151], v162 offset:43616
    s_mul_i32 s98, s59, 491520
    s_add_u32 s28, s26, s98
    s_addc_u32 s29, s27, 0
    s_and_b32 s29, s29, 0xffff
    s_mov_b32 s30, 491520
    s_mov_b32 s31, 0x20000
    s_lshl_b32 s97, s55, 1
    s_add_u32 s97, s97, s58
    s_mul_i32 s79, s97, 24576
    s_mov_b32 s65, s96
    s_lshl_b32 s62, s65, 11
    s_add_u32 s62, s62, s79
    s_add_u32 s65, s65, 1
    s_cmp_eq_u32 s65, 12
    s_cselect_b32 s65, 0, s65
    s_add_u32 s78, s62, 245760
    s_mul_i32 s60, s64, 81920
    s_add_u32 s60, s60, s80
    s_waitcnt lgkmcnt(4)
    v_mfma_f32_16x16x32_bf16 v[184:187], v[156:159], v[112:115], v[184:187]
    ds_read_b64_tr_b16 v[152:153], v162 offset:41088
    v_mfma_f32_16x16x32_bf16 v[188:191], v[156:159], v[116:119], v[188:191]
    ds_read_b64_tr_b16 v[154:155], v162 offset:43648
    buffer_load_dwordx4 v[128:131], v248, s[28:31], s62 offen offset:0 sc1
    s_add_u32 m0, s61, 40960
    s_add_u32 s64, s64, 1
    buffer_load_dwordx4 v216, s[32:35], s60 offen lds
    s_waitcnt lgkmcnt(4)
    v_mfma_f32_16x16x32_bf16 v[192:195], v[144:147], v[112:115], v[192:195]
    ds_read_b64_tr_b16 v[156:157], v162 offset:46080
    v_mfma_f32_16x16x32_bf16 v[196:199], v[144:147], v[116:119], v[196:199]
    ds_read_b64_tr_b16 v[158:159], v162 offset:48640
    buffer_load_dwordx4 v[132:135], v248, s[28:31], s78 offen offset:0 sc1
    s_add_u32 m0, s61, 41984
    s_cmp_eq_u32 s64, 12
    buffer_load_dwordx4 v217, s[32:35], s60 offen lds
    s_cselect_b32 s64, 0, s64
    s_waitcnt lgkmcnt(4)
    v_mfma_f32_16x16x32_bf16 v[200:203], v[148:151], v[112:115], v[200:203]
    ds_read_b64_tr_b16 v[144:145], v162 offset:46112
    v_mfma_f32_16x16x32_bf16 v[204:207], v[148:151], v[116:119], v[204:207]
    ds_read_b64_tr_b16 v[146:147], v162 offset:48672
    s_add_u32 m0, s61, 43008
    s_nop 0
    buffer_load_dwordx4 v218, s[32:35], s60 offen lds
    s_waitcnt lgkmcnt(4)
    v_mfma_f32_16x16x32_bf16 v[208:211], v[152:155], v[112:115], v[208:211]
    ds_read_b64_tr_b16 v[148:149], v162 offset:46144
    buffer_load_dwordx4 v[136:139], v248, s[28:31], s62 offen offset:1024 sc1
    v_mfma_f32_16x16x32_bf16 v[212:215], v[152:155], v[116:119], v[212:215]
    ds_read_b64_tr_b16 v[150:151], v162 offset:48704
    s_add_u32 m0, s61, 44032
    s_nop 0
    buffer_load_dwordx4 v219, s[32:35], s60 offen lds
    s_waitcnt lgkmcnt(4)
    v_mfma_f32_16x16x32_bf16 v[176:179], v[156:159], v[120:123], v[176:179]
    ds_read_b64_tr_b16 v[152:153], v162 offset:46176
    buffer_load_dwordx4 v[140:143], v248, s[28:31], s78 offen offset:1024 sc1
    v_mfma_f32_16x16x32_bf16 v[180:183], v[156:159], v[124:127], v[180:183]
    ds_read_b64_tr_b16 v[154:155], v162 offset:48736
    s_add_u32 m0, s61, 45056
    s_nop 0
    buffer_load_dwordx4 v220, s[32:35], s60 offen lds
    s_waitcnt lgkmcnt(4)
    v_mfma_f32_16x16x32_bf16 v[184:187], v[144:147], v[120:123], v[184:187]
    ds_read_b64_tr_b16 v[156:157], v162 offset:46208
    v_mfma_f32_16x16x32_bf16 v[188:191], v[144:147], v[124:127], v[188:191]
    ds_read_b64_tr_b16 v[158:159], v162 offset:48768
    s_waitcnt vmcnt(9)
    s_waitcnt lgkmcnt(0)
    s_barrier
    v_mfma_f32_16x16x32_bf16 v[192:195], v[148:151], v[120:123], v[192:195]
    ds_read_b64_tr_b16 v[144:145], v160 offset:0
    v_mfma_f32_16x16x32_bf16 v[196:199], v[148:151], v[124:127], v[196:199]
    ds_read_b64_tr_b16 v[146:147], v160 offset:5120
    v_mfma_f32_16x16x32_bf16 v[200:203], v[152:155], v[120:123], v[200:203]
    ds_read_b64_tr_b16 v[148:149], v161 offset:32
    v_mfma_f32_16x16x32_bf16 v[204:207], v[152:155], v[124:127], v[204:207]
    ds_read_b64_tr_b16 v[150:151], v161 offset:5152
    v_mfma_f32_16x16x32_bf16 v[208:211], v[156:159], v[120:123], v[208:211]
    ds_read_b64_tr_b16 v[152:153], v160 offset:64
    v_mfma_f32_16x16x32_bf16 v[212:215], v[156:159], v[124:127], v[212:215]
    ds_read_b64_tr_b16 v[154:155], v160 offset:5184
    s_waitcnt vmcnt(6)
    s_waitcnt lgkmcnt(4)
    v_mfma_f32_16x16x32_bf16 v[0:3], v[144:147], v[128:131], 0
    ds_read_b64_tr_b16 v[156:157], v161 offset:96
    v_mfma_f32_16x16x32_bf16 v[4:7], v[144:147], v[132:135], 0
    ds_read_b64_tr_b16 v[158:159], v161 offset:5216
    s_lshl_b32 s62, s65, 11
    s_add_u32 s62, s62, s79
    s_add_u32 s65, s65, 1
    s_cmp_eq_u32 s65, 12
    s_cselect_b32 s65, 0, s65
    s_add_u32 s78, s62, 245760
    s_mul_i32 s60, s64, 81920
    s_add_u32 s60, s60, s80
    s_waitcnt lgkmcnt(4)
    v_mfma_f32_16x16x32_bf16 v[8:11], v[148:151], v[128:131], 0
    ds_read_b64_tr_b16 v[144:145], v160 offset:128
    v_mfma_f32_16x16x32_bf16 v[12:15], v[148:151], v[132:135], 0
    ds_read_b64_tr_b16 v[146:147], v160 offset:5248
    s_waitcnt lgkmcnt(4)
    v_mfma_f32_16x16x32_bf16 v[16:19], v[152:155], v[128:131], 0
    ds_read_b64_tr_b16 v[148:149], v161 offset:160
    v_mfma_f32_16x16x32_bf16 v[20:23], v[152:155], v[132:135], 0
    ds_read_b64_tr_b16 v[150:151], v161 offset:5280
    s_waitcnt lgkmcnt(4)
    v_mfma_f32_16x16x32_bf16 v[24:27], v[156:159], v[128:131], 0
    ds_read_b64_tr_b16 v[152:153], v160 offset:192
    s_add_u32 m0, s61, 81920
    s_add_u32 s64, s64, 1
    buffer_load_dwordx4 v216, s[32:35], s60 offen lds
    v_mfma_f32_16x16x32_bf16 v[28:31], v[156:159], v[132:135], 0
    ds_read_b64_tr_b16 v[154:155], v160 offset:5312
    buffer_load_dwordx4 v[80:83], v248, s[28:31], s62 offen offset:0 sc1
    s_waitcnt lgkmcnt(4)
    v_mfma_f32_16x16x32_bf16 v[32:35], v[144:147], v[128:131], 0
    ds_read_b64_tr_b16 v[156:157], v161 offset:224
    v_mfma_f32_16x16x32_bf16 v[36:39], v[144:147], v[132:135], 0
    ds_read_b64_tr_b16 v[158:159], v161 offset:5344
    s_waitcnt lgkmcnt(4)
    v_mfma_f32_16x16x32_bf16 v[40:43], v[148:151], v[128:131], 0
    ds_read_b64_tr_b16 v[144:145], v160 offset:256
    v_mfma_f32_16x16x32_bf16 v[44:47], v[148:151], v[132:135], 0
    ds_read_b64_tr_b16 v[146:147], v160 offset:5376
    s_add_u32 m0, s61, 82944
    s_cmp_eq_u32 s64, 12
    buffer_load_dwordx4 v217, s[32:35], s60 offen lds
    s_cselect_b32 s64, 0, s64
    s_waitcnt lgkmcnt(4)
    v_mfma_f32_16x16x32_bf16 v[48:51], v[152:155], v[128:131], 0
    ds_read_b64_tr_b16 v[148:149], v161 offset:288
    v_mfma_f32_16x16x32_bf16 v[52:55], v[152:155], v[132:135], 0
    ds_read_b64_tr_b16 v[150:151], v161 offset:5408
    buffer_load_dwordx4 v[84:87], v248, s[28:31], s78 offen offset:0 sc1
    s_waitcnt lgkmcnt(4)
    v_mfma_f32_16x16x32_bf16 v[56:59], v[156:159], v[128:131], 0
    ds_read_b64_tr_b16 v[152:153], v160 offset:10240
    v_mfma_f32_16x16x32_bf16 v[60:63], v[156:159], v[132:135], 0
    ds_read_b64_tr_b16 v[154:155], v160 offset:15360
    s_waitcnt lgkmcnt(4)
    v_mfma_f32_16x16x32_bf16 v[64:67], v[144:147], v[128:131], 0
    ds_read_b64_tr_b16 v[156:157], v161 offset:10272
    v_mfma_f32_16x16x32_bf16 v[68:71], v[144:147], v[132:135], 0
    ds_read_b64_tr_b16 v[158:159], v161 offset:15392
    s_add_u32 m0, s61, 83968
    s_nop 0
    buffer_load_dwordx4 v218, s[32:35], s60 offen lds
    s_waitcnt lgkmcnt(4)
    v_mfma_f32_16x16x32_bf16 v[72:75], v[148:151], v[128:131], 0
    ds_read_b64_tr_b16 v[144:145], v160 offset:10304
    v_mfma_f32_16x16x32_bf16 v[76:79], v[148:151], v[132:135], 0
    ds_read_b64_tr_b16 v[146:147], v160 offset:15424
    s_waitcnt vmcnt(6)
    s_waitcnt lgkmcnt(4)
    v_mfma_f32_16x16x32_bf16 v[0:3], v[152:155], v[136:139], v[0:3]
    ds_read_b64_tr_b16 v[148:149], v161 offset:10336
    buffer_load_dwordx4 v[88:91], v248, s[28:31], s62 offen offset:1024 sc1
    v_mfma_f32_16x16x32_bf16 v[4:7], v[152:155], v[140:143], v[4:7]
    ds_read_b64_tr_b16 v[150:151], v161 offset:15456
    s_waitcnt lgkmcnt(4)
    v_mfma_f32_16x16x32_bf16 v[8:11], v[156:159], v[136:139], v[8:11]
    ds_read_b64_tr_b16 v[152:153], v160 offset:10368
    s_add_u32 m0, s61, 84992
    s_nop 0
    buffer_load_dwordx4 v219, s[32:35], s60 offen lds
    v_mfma_f32_16x16x32_bf16 v[12:15], v[156:159], v[140:143], v[12:15]
    ds_read_b64_tr_b16 v[154:155], v160 offset:15488
    s_waitcnt lgkmcnt(4)
    v_mfma_f32_16x16x32_bf16 v[16:19], v[144:147], v[136:139], v[16:19]
    ds_read_b64_tr_b16 v[156:157], v161 offset:10400
    v_mfma_f32_16x16x32_bf16 v[20:23], v[144:147], v[140:143], v[20:23]
    ds_read_b64_tr_b16 v[158:159], v161 offset:15520
    s_waitcnt lgkmcnt(4)
    v_mfma_f32_16x16x32_bf16 v[24:27], v[148:151], v[136:139], v[24:27]
    ds_read_b64_tr_b16 v[144:145], v160 offset:10432
    buffer_load_dwordx4 v[92:95], v248, s[28:31], s78 offen offset:1024 sc1
    v_mfma_f32_16x16x32_bf16 v[28:31], v[148:151], v[140:143], v[28:31]
    ds_read_b64_tr_b16 v[146:147], v160 offset:15552
    s_add_u32 m0, s61, 86016
    s_nop 0
    buffer_load_dwordx4 v220, s[32:35], s60 offen lds
    s_waitcnt lgkmcnt(4)
    v_mfma_f32_16x16x32_bf16 v[32:35], v[152:155], v[136:139], v[32:35]
    ds_read_b64_tr_b16 v[148:149], v161 offset:10464
    v_mfma_f32_16x16x32_bf16 v[36:39], v[152:155], v[140:143], v[36:39]
    ds_read_b64_tr_b16 v[150:151], v161 offset:15584
    s_waitcnt lgkmcnt(4)
    v_mfma_f32_16x16x32_bf16 v[40:43], v[156:159], v[136:139], v[40:43]
    ds_read_b64_tr_b16 v[152:153], v160 offset:10496
    v_mfma_f32_16x16x32_bf16 v[44:47], v[156:159], v[140:143], v[44:47]
    ds_read_b64_tr_b16 v[154:155], v160 offset:15616
    s_waitcnt lgkmcnt(4)
    v_mfma_f32_16x16x32_bf16 v[48:51], v[144:147], v[136:139], v[48:51]
    ds_read_b64_tr_b16 v[156:157], v161 offset:10528
    v_mfma_f32_16x16x32_bf16 v[52:55], v[144:147], v[140:143], v[52:55]
    ds_read_b64_tr_b16 v[158:159], v161 offset:15648
    s_waitcnt vmcnt(9)
    s_waitcnt lgkmcnt(0)
    s_barrier
    v_mfma_f32_16x16x32_bf16 v[56:59], v[148:151], v[136:139], v[56:59]
    ds_read_b64_tr_b16 v[144:145], v160 offset:40960
    v_mfma_f32_16x16x32_bf16 v[60:63], v[148:151], v[140:143], v[60:63]
    ds_read_b64_tr_b16 v[146:147], v160 offset:46080
    v_mfma_f32_16x16x32_bf16 v[64:67], v[152:155], v[136:139], v[64:67]
    ds_read_b64_tr_b16 v[148:149], v161 offset:40992
    v_mfma_f32_16x16x32_bf16 v[68:71], v[152:155], v[140:143], v[68:71]
    ds_read_b64_tr_b16 v[150:151], v161 offset:46112
    v_mfma_f32_16x16x32_bf16 v[72:75], v[156:159], v[136:139], v[72:75]
    ds_read_b64_tr_b16 v[152:153], v160 offset:41024
    v_mfma_f32_16x16x32_bf16 v[76:79], v[156:159], v[140:143], v[76:79]
    ds_read_b64_tr_b16 v[154:155], v160 offset:46144
    s_waitcnt vmcnt(5)
    s_waitcnt lgkmcnt(4)
    v_mfma_f32_16x16x32_bf16 v[0:3], v[144:147], v[80:83], v[0:3]
    ds_read_b64_tr_b16 v[156:157], v161 offset:41056
    v_mfma_f32_16x16x32_bf16 v[4:7], v[144:147], v[84:87], v[4:7]
    ds_read_b64_tr_b16 v[158:159], v161 offset:46176
    s_lshl_b32 s62, s65, 11
    s_add_u32 s62, s62, s79
    s_add_u32 s65, s65, 1
    s_cmp_eq_u32 s65, 12
    s_cselect_b32 s65, 0, s65
    s_add_u32 s78, s62, 245760
    s_mul_i32 s60, s64, 81920
    s_add_u32 s60, s60, s80
    s_waitcnt lgkmcnt(4)
    v_mfma_f32_16x16x32_bf16 v[8:11], v[148:151], v[80:83], v[8:11]
    ds_read_b64_tr_b16 v[144:145], v160 offset:41088
    v_mfma_f32_16x16x32_bf16 v[12:15], v[148:151], v[84:87], v[12:15]
    ds_read_b64_tr_b16 v[146:147], v160 offset:46208
    s_waitcnt lgkmcnt(4)
    v_mfma_f32_16x16x32_bf16 v[16:19], v[152:155], v[80:83], v[16:19]
    ds_read_b64_tr_b16 v[148:149], v161 offset:41120
    v_mfma_f32_16x16x32_bf16 v[20:23], v[152:155], v[84:87], v[20:23]
    ds_read_b64_tr_b16 v[150:151], v161 offset:46240
    s_waitcnt lgkmcnt(4)
    v_mfma_f32_16x16x32_bf16 v[24:27], v[156:159], v[80:83], v[24:27]
    ds_read_b64_tr_b16 v[152:153], v160 offset:41152
    s_add_u32 m0, s61, 122880
    s_add_u32 s64, s64, 1
    buffer_load_dwordx4 v216, s[32:35], s60 offen lds
    v_mfma_f32_16x16x32_bf16 v[28:31], v[156:159], v[84:87], v[28:31]
    ds_read_b64_tr_b16 v[154:155], v160 offset:46272
    buffer_load_dwordx4 v[96:99], v248, s[28:31], s62 offen offset:0 sc1
    s_waitcnt lgkmcnt(4)
    v_mfma_f32_16x16x32_bf16 v[32:35], v[144:147], v[80:83], v[32:35]
    ds_read_b64_tr_b16 v[156:157], v161 offset:41184
    v_mfma_f32_16x16x32_bf16 v[36:39], v[144:147], v[84:87], v[36:39]
    ds_read_b64_tr_b16 v[158:159], v161 offset:46304
    s_waitcnt lgkmcnt(4)
    v_mfma_f32_16x16x32_bf16 v[40:43], v[148:151], v[80:83], v[40:43]
    ds_read_b64_tr_b16 v[144:145], v160 offset:41216
    v_mfma_f32_16x16x32_bf16 v[44:47], v[148:151], v[84:87], v[44:47]
    ds_read_b64_tr_b16 v[146:147], v160 offset:46336
    s_add_u32 m0, s61, 123904
    s_cmp_eq_u32 s64, 12
    buffer_load_dwordx4 v217, s[32:35], s60 offen lds
    s_cselect_b32 s64, 0, s64
    s_waitcnt lgkmcnt(4)
    v_mfma_f32_16x16x32_bf16 v[48:51], v[152:155], v[80:83], v[48:51]
    ds_read_b64_tr_b16 v[148:149], v161 offset:41248
    v_mfma_f32_16x16x32_bf16 v[52:55], v[152:155], v[84:87], v[52:55]
    ds_read_b64_tr_b16 v[150:151], v161 offset:46368
    buffer_load_dwordx4 v[100:103], v248, s[28:31], s78 offen offset:0 sc1
    s_waitcnt lgkmcnt(4)
    v_mfma_f32_16x16x32_bf16 v[56:59], v[156:159], v[80:83], v[56:59]
    ds_read_b64_tr_b16 v[152:153], v160 offset:51200
    v_mfma_f32_16x16x32_bf16 v[60:63], v[156:159], v[84:87], v[60:63]
    ds_read_b64_tr_b16 v[154:155], v160 offset:56320
    s_waitcnt lgkmcnt(4)
    v_mfma_f32_16x16x32_bf16 v[64:67], v[144:147], v[80:83], v[64:67]
    ds_read_b64_tr_b16 v[156:157], v161 offset:51232
    v_mfma_f32_16x16x32_bf16 v[68:71], v[144:147], v[84:87], v[68:71]
    ds_read_b64_tr_b16 v[158:159], v161 offset:56352
    s_add_u32 m0, s61, 124928
    s_nop 0
    buffer_load_dwordx4 v218, s[32:35], s60 offen lds
    s_waitcnt lgkmcnt(4)
    v_mfma_f32_16x16x32_bf16 v[72:75], v[148:151], v[80:83], v[72:75]
    ds_read_b64_tr_b16 v[144:145], v160 offset:51264
    v_mfma_f32_16x16x32_bf16 v[76:79], v[148:151], v[84:87], v[76:79]
    ds_read_b64_tr_b16 v[146:147], v160 offset:56384
    s_waitcnt vmcnt(6)
    s_waitcnt lgkmcnt(4)
    v_mfma_f32_16x16x32_bf16 v[0:3], v[152:155], v[88:91], v[0:3]
    ds_read_b64_tr_b16 v[148:149], v161 offset:51296
    buffer_load_dwordx4 v[104:107], v248, s[28:31], s62 offen offset:1024 sc1
    v_mfma_f32_16x16x32_bf16 v[4:7], v[152:155], v[92:95], v[4:7]
    ds_read_b64_tr_b16 v[150:151], v161 offset:56416
    s_waitcnt lgkmcnt(4)
    v_mfma_f32_16x16x32_bf16 v[8:11], v[156:159], v[88:91], v[8:11]
    ds_read_b64_tr_b16 v[152:153], v160 offset:51328
    s_add_u32 m0, s61, 125952
    s_nop 0
    buffer_load_dwordx4 v219, s[32:35], s60 offen lds
    v_mfma_f32_16x16x32_bf16 v[12:15], v[156:159], v[92:95], v[12:15]
    ds_read_b64_tr_b16 v[154:155], v160 offset:56448
    s_waitcnt lgkmcnt(4)
    v_mfma_f32_16x16x32_bf16 v[16:19], v[144:147], v[88:91], v[16:19]
    ds_read_b64_tr_b16 v[156:157], v161 offset:51360
    v_mfma_f32_16x16x32_bf16 v[20:23], v[144:147], v[92:95], v[20:23]
    ds_read_b64_tr_b16 v[158:159], v161 offset:56480
    s_waitcnt lgkmcnt(4)
    v_mfma_f32_16x16x32_bf16 v[24:27], v[148:151], v[88:91], v[24:27]
    ds_read_b64_tr_b16 v[144:145], v160 offset:51392
    buffer_load_dwordx4 v[108:111], v248, s[28:31], s78 offen offset:1024 sc1
    v_mfma_f32_16x16x32_bf16 v[28:31], v[148:151], v[92:95], v[28:31]
    ds_read_b64_tr_b16 v[146:147], v160 offset:56512
    s_add_u32 m0, s61, 126976
    s_nop 0
    buffer_load_dwordx4 v220, s[32:35], s60 offen lds
    s_waitcnt lgkmcnt(4)
    v_mfma_f32_16x16x32_bf16 v[32:35], v[152:155], v[88:91], v[32:35]
    ds_read_b64_tr_b16 v[148:149], v161 offset:51424
    v_mfma_f32_16x16x32_bf16 v[36:39], v[152:155], v[92:95], v[36:39]
    ds_read_b64_tr_b16 v[150:151], v161 offset:56544
    s_waitcnt lgkmcnt(4)
    v_mfma_f32_16x16x32_bf16 v[40:43], v[156:159], v[88:91], v[40:43]
    ds_read_b64_tr_b16 v[152:153], v160 offset:51456
    v_mfma_f32_16x16x32_bf16 v[44:47], v[156:159], v[92:95], v[44:47]
    ds_read_b64_tr_b16 v[154:155], v160 offset:56576
    s_waitcnt lgkmcnt(4)
    v_mfma_f32_16x16x32_bf16 v[48:51], v[144:147], v[88:91], v[48:51]
    ds_read_b64_tr_b16 v[156:157], v161 offset:51488
    v_mfma_f32_16x16x32_bf16 v[52:55], v[144:147], v[92:95], v[52:55]
    ds_read_b64_tr_b16 v[158:159], v161 offset:56608
    s_waitcnt vmcnt(9)
    s_waitcnt lgkmcnt(0)
    s_barrier
    v_add_u32 v160, 81920, v160
    v_add_u32 v161, 81920, v161
    v_mfma_f32_16x16x32_bf16 v[56:59], v[148:151], v[88:91], v[56:59]
    ds_read_b64_tr_b16 v[144:145], v160 offset:0
    v_mfma_f32_16x16x32_bf16 v[60:63], v[148:151], v[92:95], v[60:63]
    ds_read_b64_tr_b16 v[146:147], v160 offset:5120
    v_mfma_f32_16x16x32_bf16 v[64:67], v[152:155], v[88:91], v[64:67]
    ds_read_b64_tr_b16 v[148:149], v161 offset:32
    v_mfma_f32_16x16x32_bf16 v[68:71], v[152:155], v[92:95], v[68:71]
    ds_read_b64_tr_b16 v[150:151], v161 offset:5152
    v_mfma_f32_16x16x32_bf16 v[72:75], v[156:159], v[88:91], v[72:75]
    ds_read_b64_tr_b16 v[152:153], v160 offset:64
    v_mfma_f32_16x16x32_bf16 v[76:79], v[156:159], v[92:95], v[76:79]
    ds_read_b64_tr_b16 v[154:155], v160 offset:5184
    s_waitcnt vmcnt(5)
    s_waitcnt lgkmcnt(4)
    v_mfma_f32_16x16x32_bf16 v[0:3], v[144:147], v[96:99], v[0:3]
    ds_read_b64_tr_b16 v[156:157], v161 offset:96
    v_mfma_f32_16x16x32_bf16 v[4:7], v[144:147], v[100:103], v[4:7]
    ds_read_b64_tr_b16 v[158:159], v161 offset:5216
    s_lshl_b32 s62, s65, 11
    s_add_u32 s62, s62, s79
    s_add_u32 s65, s65, 1
    s_cmp_eq_u32 s65, 12
    s_cselect_b32 s65, 0, s65
    s_add_u32 s78, s62, 245760
    s_mul_i32 s60, s64, 81920
    s_add_u32 s60, s60, s80
    s_waitcnt lgkmcnt(4)
    v_mfma_f32_16x16x32_bf16 v[8:11], v[148:151], v[96:99], v[8:11]
    ds_read_b64_tr_b16 v[144:145], v160 offset:128
    v_mfma_f32_16x16x32_bf16 v[12:15], v[148:151], v[100:103], v[12:15]
    ds_read_b64_tr_b16 v[146:147], v160 offset:5248
    s_waitcnt lgkmcnt(4)
    v_mfma_f32_16x16x32_bf16 v[16:19], v[152:155], v[96:99], v[16:19]
    ds_read_b64_tr_b16 v[148:149], v161 offset:160
    v_mfma_f32_16x16x32_bf16 v[20:23], v[152:155], v[100:103], v[20:23]
    ds_read_b64_tr_b16 v[150:151], v161 offset:5280
    s_waitcnt lgkmcnt(4)
    v_mfma_f32_16x16x32_bf16 v[24:27], v[156:159], v[96:99], v[24:27]
    ds_read_b64_tr_b16 v[152:153], v160 offset:192
    s_add_u32 m0, s61, 0
    s_add_u32 s64, s64, 1
    buffer_load_dwordx4 v216, s[32:35], s60 offen lds
    v_mfma_f32_16x16x32_bf16 v[28:31], v[156:159], v[100:103], v[28:31]
    ds_read_b64_tr_b16 v[154:155], v160 offset:5312
    buffer_load_dwordx4 v[112:115], v248, s[28:31], s62 offen offset:0 sc1
    s_waitcnt lgkmcnt(4)
    v_mfma_f32_16x16x32_bf16 v[32:35], v[144:147], v[96:99], v[32:35]
    ds_read_b64_tr_b16 v[156:157], v161 offset:224
    v_mfma_f32_16x16x32_bf16 v[36:39], v[144:147], v[100:103], v[36:39]
    ds_read_b64_tr_b16 v[158:159], v161 offset:5344
    s_waitcnt lgkmcnt(4)
    v_mfma_f32_16x16x32_bf16 v[40:43], v[148:151], v[96:99], v[40:43]
    ds_read_b64_tr_b16 v[144:145], v160 offset:256
    v_mfma_f32_16x16x32_bf16 v[44:47], v[148:151], v[100:103], v[44:47]
    ds_read_b64_tr_b16 v[146:147], v160 offset:5376
    s_add_u32 m0, s61, 1024
    s_cmp_eq_u32 s64, 12
    buffer_load_dwordx4 v217, s[32:35], s60 offen lds
    s_cselect_b32 s64, 0, s64
    s_waitcnt lgkmcnt(4)
    v_mfma_f32_16x16x32_bf16 v[48:51], v[152:155], v[96:99], v[48:51]
    ds_read_b64_tr_b16 v[148:149], v161 offset:288
    v_mfma_f32_16x16x32_bf16 v[52:55], v[152:155], v[100:103], v[52:55]
    ds_read_b64_tr_b16 v[150:151], v161 offset:5408
    buffer_load_dwordx4 v[116:119], v248, s[28:31], s78 offen offset:0 sc1
    s_waitcnt lgkmcnt(4)
    v_mfma_f32_16x16x32_bf16 v[56:59], v[156:159], v[96:99], v[56:59]
    ds_read_b64_tr_b16 v[152:153], v160 offset:10240
    v_mfma_f32_16x16x32_bf16 v[60:63], v[156:159], v[100:103], v[60:63]
    ds_read_b64_tr_b16 v[154:155], v160 offset:15360
    s_waitcnt lgkmcnt(4)
    v_mfma_f32_16x16x32_bf16 v[64:67], v[144:147], v[96:99], v[64:67]
    ds_read_b64_tr_b16 v[156:157], v161 offset:10272
    v_mfma_f32_16x16x32_bf16 v[68:71], v[144:147], v[100:103], v[68:71]
    ds_read_b64_tr_b16 v[158:159], v161 offset:15392
    s_add_u32 m0, s61, 2048
    s_nop 0
    buffer_load_dwordx4 v218, s[32:35], s60 offen lds
    s_waitcnt lgkmcnt(4)
    v_mfma_f32_16x16x32_bf16 v[72:75], v[148:151], v[96:99], v[72:75]
    ds_read_b64_tr_b16 v[144:145], v160 offset:10304
    v_mfma_f32_16x16x32_bf16 v[76:79], v[148:151], v[100:103], v[76:79]
    ds_read_b64_tr_b16 v[146:147], v160 offset:15424
    s_waitcnt vmcnt(6)
    s_waitcnt lgkmcnt(4)
    v_mfma_f32_16x16x32_bf16 v[0:3], v[152:155], v[104:107], v[0:3]
    ds_read_b64_tr_b16 v[148:149], v161 offset:10336
    buffer_load_dwordx4 v[120:123], v248, s[28:31], s62 offen offset:1024 sc1
    v_mfma_f32_16x16x32_bf16 v[4:7], v[152:155], v[108:111], v[4:7]
    ds_read_b64_tr_b16 v[150:151], v161 offset:15456
    s_waitcnt lgkmcnt(4)
    v_mfma_f32_16x16x32_bf16 v[8:11], v[156:159], v[104:107], v[8:11]
    ds_read_b64_tr_b16 v[152:153], v160 offset:10368
    s_add_u32 m0, s61, 3072
    s_nop 0
    buffer_load_dwordx4 v219, s[32:35], s60 offen lds
    v_mfma_f32_16x16x32_bf16 v[12:15], v[156:159], v[108:111], v[12:15]
    ds_read_b64_tr_b16 v[154:155], v160 offset:15488
    s_waitcnt lgkmcnt(4)
    v_mfma_f32_16x16x32_bf16 v[16:19], v[144:147], v[104:107], v[16:19]
    ds_read_b64_tr_b16 v[156:157], v161 offset:10400
    v_mfma_f32_16x16x32_bf16 v[20:23], v[144:147], v[108:111], v[20:23]
    ds_read_b64_tr_b16 v[158:159], v161 offset:15520
    s_waitcnt lgkmcnt(4)
    v_mfma_f32_16x16x32_bf16 v[24:27], v[148:151], v[104:107], v[24:27]
    ds_read_b64_tr_b16 v[144:145], v160 offset:10432
    buffer_load_dwordx4 v[124:127], v248, s[28:31], s78 offen offset:1024 sc1
    v_mfma_f32_16x16x32_bf16 v[28:31], v[148:151], v[108:111], v[28:31]
    ds_read_b64_tr_b16 v[146:147], v160 offset:15552
    s_add_u32 m0, s61, 4096
    s_nop 0
    buffer_load_dwordx4 v220, s[32:35], s60 offen lds
    s_waitcnt lgkmcnt(4)
    v_mfma_f32_16x16x32_bf16 v[32:35], v[152:155], v[104:107], v[32:35]
    ds_read_b64_tr_b16 v[148:149], v161 offset:10464
    v_mfma_f32_16x16x32_bf16 v[36:39], v[152:155], v[108:111], v[36:39]
    ds_read_b64_tr_b16 v[150:151], v161 offset:15584
    s_waitcnt lgkmcnt(4)
    v_mfma_f32_16x16x32_bf16 v[40:43], v[156:159], v[104:107], v[40:43]
    ds_read_b64_tr_b16 v[152:153], v160 offset:10496
    v_mfma_f32_16x16x32_bf16 v[44:47], v[156:159], v[108:111], v[44:47]
    ds_read_b64_tr_b16 v[154:155], v160 offset:15616
    s_waitcnt lgkmcnt(4)
    v_mfma_f32_16x16x32_bf16 v[48:51], v[144:147], v[104:107], v[48:51]
    ds_read_b64_tr_b16 v[156:157], v161 offset:10528
    v_mfma_f32_16x16x32_bf16 v[52:55], v[144:147], v[108:111], v[52:55]
    ds_read_b64_tr_b16 v[158:159], v161 offset:15648
    s_waitcnt vmcnt(9)
    s_waitcnt lgkmcnt(0)
    s_barrier
    v_mfma_f32_16x16x32_bf16 v[56:59], v[148:151], v[104:107], v[56:59]
    ds_read_b64_tr_b16 v[144:145], v160 offset:40960
    v_mfma_f32_16x16x32_bf16 v[60:63], v[148:151], v[108:111], v[60:63]
    ds_read_b64_tr_b16 v[146:147], v160 offset:46080
    v_mfma_f32_16x16x32_bf16 v[64:67], v[152:155], v[104:107], v[64:67]
    ds_read_b64_tr_b16 v[148:149], v161 offset:40992
    v_mfma_f32_16x16x32_bf16 v[68:71], v[152:155], v[108:111], v[68:71]
    ds_read_b64_tr_b16 v[150:151], v161 offset:46112
    v_mfma_f32_16x16x32_bf16 v[72:75], v[156:159], v[104:107], v[72:75]
    ds_read_b64_tr_b16 v[152:153], v160 offset:41024
    v_mfma_f32_16x16x32_bf16 v[76:79], v[156:159], v[108:111], v[76:79]
    ds_read_b64_tr_b16 v[154:155], v160 offset:46144
    s_waitcnt vmcnt(5)
    s_waitcnt lgkmcnt(4)
    v_mfma_f32_16x16x32_bf16 v[0:3], v[144:147], v[112:115], v[0:3]
    ds_read_b64_tr_b16 v[156:157], v161 offset:41056
    v_mfma_f32_16x16x32_bf16 v[4:7], v[144:147], v[116:119], v[4:7]
    ds_read_b64_tr_b16 v[158:159], v161 offset:46176
    s_lshl_b32 s62, s65, 11
    s_add_u32 s62, s62, s79
    s_add_u32 s65, s65, 1
    s_cmp_eq_u32 s65, 12
    s_cselect_b32 s65, 0, s65
    s_add_u32 s78, s62, 245760
    s_mul_i32 s60, s64, 81920
    s_add_u32 s60, s60, s80
    s_waitcnt lgkmcnt(4)
    v_mfma_f32_16x16x32_bf16 v[8:11], v[148:151], v[112:115], v[8:11]
    ds_read_b64_tr_b16 v[144:145], v160 offset:41088
    v_mfma_f32_16x16x32_bf16 v[12:15], v[148:151], v[116:119], v[12:15]
    ds_read_b64_tr_b16 v[146:147], v160 offset:46208
    s_waitcnt lgkmcnt(4)
    v_mfma_f32_16x16x32_bf16 v[16:19], v[152:155], v[112:115], v[16:19]
    ds_read_b64_tr_b16 v[148:149], v161 offset:41120
    v_mfma_f32_16x16x32_bf16 v[20:23], v[152:155], v[116:119], v[20:23]
    ds_read_b64_tr_b16 v[150:151], v161 offset:46240
    s_waitcnt lgkmcnt(4)
    v_mfma_f32_16x16x32_bf16 v[24:27], v[156:159], v[112:115], v[24:27]
    ds_read_b64_tr_b16 v[152:153], v160 offset:41152
    s_add_u32 m0, s61, 40960
    s_add_u32 s64, s64, 1
    buffer_load_dwordx4 v216, s[32:35], s60 offen lds
    v_mfma_f32_16x16x32_bf16 v[28:31], v[156:159], v[116:119], v[28:31]
    ds_read_b64_tr_b16 v[154:155], v160 offset:46272
    buffer_load_dwordx4 v[128:131], v248, s[28:31], s62 offen offset:0 sc1
    s_waitcnt lgkmcnt(4)
    v_mfma_f32_16x16x32_bf16 v[32:35], v[144:147], v[112:115], v[32:35]
    ds_read_b64_tr_b16 v[156:157], v161 offset:41184
    v_mfma_f32_16x16x32_bf16 v[36:39], v[144:147], v[116:119], v[36:39]
    ds_read_b64_tr_b16 v[158:159], v161 offset:46304
    s_waitcnt lgkmcnt(4)
    v_mfma_f32_16x16x32_bf16 v[40:43], v[148:151], v[112:115], v[40:43]
    ds_read_b64_tr_b16 v[144:145], v160 offset:41216
    v_mfma_f32_16x16x32_bf16 v[44:47], v[148:151], v[116:119], v[44:47]
    ds_read_b64_tr_b16 v[146:147], v160 offset:46336
    s_add_u32 m0, s61, 41984
    s_cmp_eq_u32 s64, 12
    buffer_load_dwordx4 v217, s[32:35], s60 offen lds
    s_cselect_b32 s64, 0, s64
    s_waitcnt lgkmcnt(4)
    v_mfma_f32_16x16x32_bf16 v[48:51], v[152:155], v[112:115], v[48:51]
    ds_read_b64_tr_b16 v[148:149], v161 offset:41248
    v_mfma_f32_16x16x32_bf16 v[52:55], v[152:155], v[116:119], v[52:55]
    ds_read_b64_tr_b16 v[150:151], v161 offset:46368
    buffer_load_dwordx4 v[132:135], v248, s[28:31], s78 offen offset:0 sc1
    s_waitcnt lgkmcnt(4)
    v_mfma_f32_16x16x32_bf16 v[56:59], v[156:159], v[112:115], v[56:59]
    ds_read_b64_tr_b16 v[152:153], v160 offset:51200
    v_mfma_f32_16x16x32_bf16 v[60:63], v[156:159], v[116:119], v[60:63]
    ds_read_b64_tr_b16 v[154:155], v160 offset:56320
    s_waitcnt lgkmcnt(4)
    v_mfma_f32_16x16x32_bf16 v[64:67], v[144:147], v[112:115], v[64:67]
    ds_read_b64_tr_b16 v[156:157], v161 offset:51232
    v_mfma_f32_16x16x32_bf16 v[68:71], v[144:147], v[116:119], v[68:71]
    ds_read_b64_tr_b16 v[158:159], v161 offset:56352
    s_add_u32 m0, s61, 43008
    s_nop 0
    buffer_load_dwordx4 v218, s[32:35], s60 offen lds
    s_waitcnt lgkmcnt(4)
    v_mfma_f32_16x16x32_bf16 v[72:75], v[148:151], v[112:115], v[72:75]
    ds_read_b64_tr_b16 v[144:145], v160 offset:51264
    v_mfma_f32_16x16x32_bf16 v[76:79], v[148:151], v[116:119], v[76:79]
    ds_read_b64_tr_b16 v[146:147], v160 offset:56384
    s_waitcnt vmcnt(6)
    s_waitcnt lgkmcnt(4)
    v_mfma_f32_16x16x32_bf16 v[0:3], v[152:155], v[120:123], v[0:3]
    ds_read_b64_tr_b16 v[148:149], v161 offset:51296
    buffer_load_dwordx4 v[136:139], v248, s[28:31], s62 offen offset:1024 sc1
    v_mfma_f32_16x16x32_bf16 v[4:7], v[152:155], v[124:127], v[4:7]
    ds_read_b64_tr_b16 v[150:151], v161 offset:56416
    s_waitcnt lgkmcnt(4)
    v_mfma_f32_16x16x32_bf16 v[8:11], v[156:159], v[120:123], v[8:11]
    ds_read_b64_tr_b16 v[152:153], v160 offset:51328
    s_add_u32 m0, s61, 44032
    s_nop 0
    buffer_load_dwordx4 v219, s[32:35], s60 offen lds
    v_mfma_f32_16x16x32_bf16 v[12:15], v[156:159], v[124:127], v[12:15]
    ds_read_b64_tr_b16 v[154:155], v160 offset:56448
    s_waitcnt lgkmcnt(4)
    v_mfma_f32_16x16x32_bf16 v[16:19], v[144:147], v[120:123], v[16:19]
    ds_read_b64_tr_b16 v[156:157], v161 offset:51360
    v_mfma_f32_16x16x32_bf16 v[20:23], v[144:147], v[124:127], v[20:23]
    ds_read_b64_tr_b16 v[158:159], v161 offset:56480
    s_waitcnt lgkmcnt(4)
    v_mfma_f32_16x16x32_bf16 v[24:27], v[148:151], v[120:123], v[24:27]
    ds_read_b64_tr_b16 v[144:145], v160 offset:51392
    buffer_load_dwordx4 v[140:143], v248, s[28:31], s78 offen offset:1024 sc1
    v_mfma_f32_16x16x32_bf16 v[28:31], v[148:151], v[124:127], v[28:31]
    ds_read_b64_tr_b16 v[146:147], v160 offset:56512
    s_add_u32 m0, s61, 45056
    s_nop 0
    buffer_load_dwordx4 v220, s[32:35], s60 offen lds
    s_waitcnt lgkmcnt(4)
    v_mfma_f32_16x16x32_bf16 v[32:35], v[152:155], v[120:123], v[32:35]
    ds_read_b64_tr_b16 v[148:149], v161 offset:51424
    v_mfma_f32_16x16x32_bf16 v[36:39], v[152:155], v[124:127], v[36:39]
    ds_read_b64_tr_b16 v[150:151], v161 offset:56544
    s_waitcnt lgkmcnt(4)
    v_mfma_f32_16x16x32_bf16 v[40:43], v[156:159], v[120:123], v[40:43]
    ds_read_b64_tr_b16 v[152:153], v160 offset:51456
    v_mfma_f32_16x16x32_bf16 v[44:47], v[156:159], v[124:127], v[44:47]
    ds_read_b64_tr_b16 v[154:155], v160 offset:56576
    s_waitcnt lgkmcnt(4)
    v_mfma_f32_16x16x32_bf16 v[48:51], v[144:147], v[120:123], v[48:51]
    ds_read_b64_tr_b16 v[156:157], v161 offset:51488
    v_mfma_f32_16x16x32_bf16 v[52:55], v[144:147], v[124:127], v[52:55]
    ds_read_b64_tr_b16 v[158:159], v161 offset:56608
    s_waitcnt vmcnt(9)
    s_waitcnt lgkmcnt(0)
    s_barrier
    v_add_u32 v160, 4294885376, v160
    v_add_u32 v161, 4294885376, v161
    v_mfma_f32_16x16x32_bf16 v[56:59], v[148:151], v[120:123], v[56:59]
    ds_read_b64_tr_b16 v[144:145], v160 offset:0
    v_mfma_f32_16x16x32_bf16 v[60:63], v[148:151], v[124:127], v[60:63]
    ds_read_b64_tr_b16 v[146:147], v160 offset:5120
    v_mfma_f32_16x16x32_bf16 v[64:67], v[152:155], v[120:123], v[64:67]
    ds_read_b64_tr_b16 v[148:149], v161 offset:32
    v_mfma_f32_16x16x32_bf16 v[68:71], v[152:155], v[124:127], v[68:71]
    ds_read_b64_tr_b16 v[150:151], v161 offset:5152
    v_mfma_f32_16x16x32_bf16 v[72:75], v[156:159], v[120:123], v[72:75]
    ds_read_b64_tr_b16 v[152:153], v160 offset:64
    v_mfma_f32_16x16x32_bf16 v[76:79], v[156:159], v[124:127], v[76:79]
    ds_read_b64_tr_b16 v[154:155], v160 offset:5184
    s_waitcnt vmcnt(5)
    s_waitcnt lgkmcnt(4)
    v_mfma_f32_16x16x32_bf16 v[0:3], v[144:147], v[128:131], v[0:3]
    ds_read_b64_tr_b16 v[156:157], v161 offset:96
    v_mfma_f32_16x16x32_bf16 v[4:7], v[144:147], v[132:135], v[4:7]
    ds_read_b64_tr_b16 v[158:159], v161 offset:5216
    s_lshl_b32 s62, s65, 11
    s_add_u32 s62, s62, s79
    s_add_u32 s65, s65, 1
    s_cmp_eq_u32 s65, 12
    s_cselect_b32 s65, 0, s65
    s_add_u32 s78, s62, 245760
    s_mul_i32 s60, s64, 81920
    s_add_u32 s60, s60, s80
    s_waitcnt lgkmcnt(4)
    v_mfma_f32_16x16x32_bf16 v[8:11], v[148:151], v[128:131], v[8:11]
    ds_read_b64_tr_b16 v[144:145], v160 offset:128
    v_mfma_f32_16x16x32_bf16 v[12:15], v[148:151], v[132:135], v[12:15]
    ds_read_b64_tr_b16 v[146:147], v160 offset:5248
    s_waitcnt lgkmcnt(4)
    v_mfma_f32_16x16x32_bf16 v[16:19], v[152:155], v[128:131], v[16:19]
    ds_read_b64_tr_b16 v[148:149], v161 offset:160
    v_mfma_f32_16x16x32_bf16 v[20:23], v[152:155], v[132:135], v[20:23]
    ds_read_b64_tr_b16 v[150:151], v161 offset:5280
    s_waitcnt lgkmcnt(4)
    v_mfma_f32_16x16x32_bf16 v[24:27], v[156:159], v[128:131], v[24:27]
    ds_read_b64_tr_b16 v[152:153], v160 offset:192
    s_add_u32 m0, s61, 81920
    s_add_u32 s64, s64, 1
    buffer_load_dwordx4 v216, s[32:35], s60 offen lds
    v_mfma_f32_16x16x32_bf16 v[28:31], v[156:159], v[132:135], v[28:31]
    ds_read_b64_tr_b16 v[154:155], v160 offset:5312
    buffer_load_dwordx4 v[80:83], v248, s[28:31], s62 offen offset:0 sc1
    s_waitcnt lgkmcnt(4)
    v_mfma_f32_16x16x32_bf16 v[32:35], v[144:147], v[128:131], v[32:35]
    ds_read_b64_tr_b16 v[156:157], v161 offset:224
    v_mfma_f32_16x16x32_bf16 v[36:39], v[144:147], v[132:135], v[36:39]
    ds_read_b64_tr_b16 v[158:159], v161 offset:5344
    s_waitcnt lgkmcnt(4)
    v_mfma_f32_16x16x32_bf16 v[40:43], v[148:151], v[128:131], v[40:43]
    ds_read_b64_tr_b16 v[144:145], v160 offset:256
    v_mfma_f32_16x16x32_bf16 v[44:47], v[148:151], v[132:135], v[44:47]
    ds_read_b64_tr_b16 v[146:147], v160 offset:5376
    s_add_u32 m0, s61, 82944
    s_cmp_eq_u32 s64, 12
    buffer_load_dwordx4 v217, s[32:35], s60 offen lds
    s_cselect_b32 s64, 0, s64
    s_waitcnt lgkmcnt(4)
    v_mfma_f32_16x16x32_bf16 v[48:51], v[152:155], v[128:131], v[48:51]
    ds_read_b64_tr_b16 v[148:149], v161 offset:288
    v_mfma_f32_16x16x32_bf16 v[52:55], v[152:155], v[132:135], v[52:55]
    ds_read_b64_tr_b16 v[150:151], v161 offset:5408
    buffer_load_dwordx4 v[84:87], v248, s[28:31], s78 offen offset:0 sc1
    s_waitcnt lgkmcnt(4)
    v_mfma_f32_16x16x32_bf16 v[56:59], v[156:159], v[128:131], v[56:59]
    ds_read_b64_tr_b16 v[152:153], v160 offset:10240
    v_mfma_f32_16x16x32_bf16 v[60:63], v[156:159], v[132:135], v[60:63]
    ds_read_b64_tr_b16 v[154:155], v160 offset:15360
    s_waitcnt lgkmcnt(4)
    v_mfma_f32_16x16x32_bf16 v[64:67], v[144:147], v[128:131], v[64:67]
    ds_read_b64_tr_b16 v[156:157], v161 offset:10272
    v_mfma_f32_16x16x32_bf16 v[68:71], v[144:147], v[132:135], v[68:71]
    ds_read_b64_tr_b16 v[158:159], v161 offset:15392
    s_add_u32 m0, s61, 83968
    s_nop 0
    buffer_load_dwordx4 v218, s[32:35], s60 offen lds
    s_waitcnt lgkmcnt(4)
    v_mfma_f32_16x16x32_bf16 v[72:75], v[148:151], v[128:131], v[72:75]
    ds_read_b64_tr_b16 v[144:145], v160 offset:10304
    v_mfma_f32_16x16x32_bf16 v[76:79], v[148:151], v[132:135], v[76:79]
    ds_read_b64_tr_b16 v[146:147], v160 offset:15424
    s_waitcnt vmcnt(6)
    s_waitcnt lgkmcnt(4)
    v_mfma_f32_16x16x32_bf16 v[0:3], v[152:155], v[136:139], v[0:3]
    ds_read_b64_tr_b16 v[148:149], v161 offset:10336
    buffer_load_dwordx4 v[88:91], v248, s[28:31], s62 offen offset:1024 sc1
    v_mfma_f32_16x16x32_bf16 v[4:7], v[152:155], v[140:143], v[4:7]
    ds_read_b64_tr_b16 v[150:151], v161 offset:15456
    s_waitcnt lgkmcnt(4)
    v_mfma_f32_16x16x32_bf16 v[8:11], v[156:159], v[136:139], v[8:11]
    ds_read_b64_tr_b16 v[152:153], v160 offset:10368
    s_add_u32 m0, s61, 84992
    s_nop 0
    buffer_load_dwordx4 v219, s[32:35], s60 offen lds
    v_mfma_f32_16x16x32_bf16 v[12:15], v[156:159], v[140:143], v[12:15]
    ds_read_b64_tr_b16 v[154:155], v160 offset:15488
    s_waitcnt lgkmcnt(4)
    v_mfma_f32_16x16x32_bf16 v[16:19], v[144:147], v[136:139], v[16:19]
    ds_read_b64_tr_b16 v[156:157], v161 offset:10400
    v_mfma_f32_16x16x32_bf16 v[20:23], v[144:147], v[140:143], v[20:23]
    ds_read_b64_tr_b16 v[158:159], v161 offset:15520
    s_waitcnt lgkmcnt(4)
    v_mfma_f32_16x16x32_bf16 v[24:27], v[148:151], v[136:139], v[24:27]
    ds_read_b64_tr_b16 v[144:145], v160 offset:10432
    buffer_load_dwordx4 v[92:95], v248, s[28:31], s78 offen offset:1024 sc1
    v_mfma_f32_16x16x32_bf16 v[28:31], v[148:151], v[140:143], v[28:31]
    ds_read_b64_tr_b16 v[146:147], v160 offset:15552
    s_add_u32 m0, s61, 86016
    s_nop 0
    buffer_load_dwordx4 v220, s[32:35], s60 offen lds
    s_waitcnt lgkmcnt(4)
    v_mfma_f32_16x16x32_bf16 v[32:35], v[152:155], v[136:139], v[32:35]
    ds_read_b64_tr_b16 v[148:149], v161 offset:10464
    v_mfma_f32_16x16x32_bf16 v[36:39], v[152:155], v[140:143], v[36:39]
    ds_read_b64_tr_b16 v[150:151], v161 offset:15584
    s_waitcnt lgkmcnt(4)
    v_mfma_f32_16x16x32_bf16 v[40:43], v[156:159], v[136:139], v[40:43]
    ds_read_b64_tr_b16 v[152:153], v160 offset:10496
    v_mfma_f32_16x16x32_bf16 v[44:47], v[156:159], v[140:143], v[44:47]
    ds_read_b64_tr_b16 v[154:155], v160 offset:15616
    s_waitcnt lgkmcnt(4)
    v_mfma_f32_16x16x32_bf16 v[48:51], v[144:147], v[136:139], v[48:51]
    ds_read_b64_tr_b16 v[156:157], v161 offset:10528
    v_mfma_f32_16x16x32_bf16 v[52:55], v[144:147], v[140:143], v[52:55]
    ds_read_b64_tr_b16 v[158:159], v161 offset:15648
    s_waitcnt vmcnt(9)
    s_waitcnt lgkmcnt(0)
    s_barrier
    v_mfma_f32_16x16x32_bf16 v[56:59], v[148:151], v[136:139], v[56:59]
    ds_read_b64_tr_b16 v[144:145], v160 offset:40960
    v_mfma_f32_16x16x32_bf16 v[60:63], v[148:151], v[140:143], v[60:63]
    ds_read_b64_tr_b16 v[146:147], v160 offset:46080
    v_mfma_f32_16x16x32_bf16 v[64:67], v[152:155], v[136:139], v[64:67]
    ds_read_b64_tr_b16 v[148:149], v161 offset:40992
    v_mfma_f32_16x16x32_bf16 v[68:71], v[152:155], v[140:143], v[68:71]
    ds_read_b64_tr_b16 v[150:151], v161 offset:46112
    v_mfma_f32_16x16x32_bf16 v[72:75], v[156:159], v[136:139], v[72:75]
    ds_read_b64_tr_b16 v[152:153], v160 offset:41024
    v_mfma_f32_16x16x32_bf16 v[76:79], v[156:159], v[140:143], v[76:79]
    ds_read_b64_tr_b16 v[154:155], v160 offset:46144
    s_waitcnt vmcnt(5)
    s_waitcnt lgkmcnt(4)
    v_mfma_f32_16x16x32_bf16 v[0:3], v[144:147], v[80:83], v[0:3]
    ds_read_b64_tr_b16 v[156:157], v161 offset:41056
    v_mfma_f32_16x16x32_bf16 v[4:7], v[144:147], v[84:87], v[4:7]
    ds_read_b64_tr_b16 v[158:159], v161 offset:46176
    s_lshl_b32 s62, s65, 11
    s_add_u32 s62, s62, s79
    s_add_u32 s65, s65, 1
    s_cmp_eq_u32 s65, 12
    s_cselect_b32 s65, 0, s65
    s_add_u32 s78, s62, 245760
    s_mul_i32 s60, s64, 81920
    s_add_u32 s60, s60, s80
    s_waitcnt lgkmcnt(4)
    v_mfma_f32_16x16x32_bf16 v[8:11], v[148:151], v[80:83], v[8:11]
    ds_read_b64_tr_b16 v[144:145], v160 offset:41088
    v_mfma_f32_16x16x32_bf16 v[12:15], v[148:151], v[84:87], v[12:15]
    ds_read_b64_tr_b16 v[146:147], v160 offset:46208
    s_waitcnt lgkmcnt(4)
    v_mfma_f32_16x16x32_bf16 v[16:19], v[152:155], v[80:83], v[16:19]
    ds_read_b64_tr_b16 v[148:149], v161 offset:41120
    v_mfma_f32_16x16x32_bf16 v[20:23], v[152:155], v[84:87], v[20:23]
    ds_read_b64_tr_b16 v[150:151], v161 offset:46240
    s_waitcnt lgkmcnt(4)
    v_mfma_f32_16x16x32_bf16 v[24:27], v[156:159], v[80:83], v[24:27]
    ds_read_b64_tr_b16 v[152:153], v160 offset:41152
    s_add_u32 m0, s61, 122880
    s_add_u32 s64, s64, 1
    buffer_load_dwordx4 v216, s[32:35], s60 offen lds
    v_mfma_f32_16x16x32_bf16 v[28:31], v[156:159], v[84:87], v[28:31]
    ds_read_b64_tr_b16 v[154:155], v160 offset:46272
    buffer_load_dwordx4 v[96:99], v248, s[28:31], s62 offen offset:0 sc1
    s_waitcnt lgkmcnt(4)
    v_mfma_f32_16x16x32_bf16 v[32:35], v[144:147], v[80:83], v[32:35]
    ds_read_b64_tr_b16 v[156:157], v161 offset:41184
    v_mfma_f32_16x16x32_bf16 v[36:39], v[144:147], v[84:87], v[36:39]
    ds_read_b64_tr_b16 v[158:159], v161 offset:46304
    s_waitcnt lgkmcnt(4)
    v_mfma_f32_16x16x32_bf16 v[40:43], v[148:151], v[80:83], v[40:43]
    ds_read_b64_tr_b16 v[144:145], v160 offset:41216
    v_mfma_f32_16x16x32_bf16 v[44:47], v[148:151], v[84:87], v[44:47]
    ds_read_b64_tr_b16 v[146:147], v160 offset:46336
    s_add_u32 m0, s61, 123904
    s_cmp_eq_u32 s64, 12
    buffer_load_dwordx4 v217, s[32:35], s60 offen lds
    s_cselect_b32 s64, 0, s64
    s_waitcnt lgkmcnt(4)
    v_mfma_f32_16x16x32_bf16 v[48:51], v[152:155], v[80:83], v[48:51]
    ds_read_b64_tr_b16 v[148:149], v161 offset:41248
    v_mfma_f32_16x16x32_bf16 v[52:55], v[152:155], v[84:87], v[52:55]
    ds_read_b64_tr_b16 v[150:151], v161 offset:46368
    buffer_load_dwordx4 v[100:103], v248, s[28:31], s78 offen offset:0 sc1
    s_waitcnt lgkmcnt(4)
    v_mfma_f32_16x16x32_bf16 v[56:59], v[156:159], v[80:83], v[56:59]
    ds_read_b64_tr_b16 v[152:153], v160 offset:51200
    v_mfma_f32_16x16x32_bf16 v[60:63], v[156:159], v[84:87], v[60:63]
    ds_read_b64_tr_b16 v[154:155], v160 offset:56320
    s_waitcnt lgkmcnt(4)
    v_mfma_f32_16x16x32_bf16 v[64:67], v[144:147], v[80:83], v[64:67]
    ds_read_b64_tr_b16 v[156:157], v161 offset:51232
    v_mfma_f32_16x16x32_bf16 v[68:71], v[144:147], v[84:87], v[68:71]
    ds_read_b64_tr_b16 v[158:159], v161 offset:56352
    s_add_u32 m0, s61, 124928
    s_nop 0
    buffer_load_dwordx4 v218, s[32:35], s60 offen lds
    s_waitcnt lgkmcnt(4)
    v_mfma_f32_16x16x32_bf16 v[72:75], v[148:151], v[80:83], v[72:75]
    ds_read_b64_tr_b16 v[144:145], v160 offset:51264
    v_mfma_f32_16x16x32_bf16 v[76:79], v[148:151], v[84:87], v[76:79]
    ds_read_b64_tr_b16 v[146:147], v160 offset:56384
    s_waitcnt vmcnt(6)
    s_waitcnt lgkmcnt(4)
    v_mfma_f32_16x16x32_bf16 v[0:3], v[152:155], v[88:91], v[0:3]
    ds_read_b64_tr_b16 v[148:149], v161 offset:51296
    buffer_load_dwordx4 v[104:107], v248, s[28:31], s62 offen offset:1024 sc1
    v_mfma_f32_16x16x32_bf16 v[4:7], v[152:155], v[92:95], v[4:7]
    ds_read_b64_tr_b16 v[150:151], v161 offset:56416
    s_waitcnt lgkmcnt(4)
    v_mfma_f32_16x16x32_bf16 v[8:11], v[156:159], v[88:91], v[8:11]
    ds_read_b64_tr_b16 v[152:153], v160 offset:51328
    s_add_u32 m0, s61, 125952
    s_nop 0
    buffer_load_dwordx4 v219, s[32:35], s60 offen lds
    v_mfma_f32_16x16x32_bf16 v[12:15], v[156:159], v[92:95], v[12:15]
    ds_read_b64_tr_b16 v[154:155], v160 offset:56448
    s_waitcnt lgkmcnt(4)
    v_mfma_f32_16x16x32_bf16 v[16:19], v[144:147], v[88:91], v[16:19]
    ds_read_b64_tr_b16 v[156:157], v161 offset:51360
    v_mfma_f32_16x16x32_bf16 v[20:23], v[144:147], v[92:95], v[20:23]
    ds_read_b64_tr_b16 v[158:159], v161 offset:56480
    s_waitcnt lgkmcnt(4)
    v_mfma_f32_16x16x32_bf16 v[24:27], v[148:151], v[88:91], v[24:27]
    ds_read_b64_tr_b16 v[144:145], v160 offset:51392
    buffer_load_dwordx4 v[108:111], v248, s[28:31], s78 offen offset:1024 sc1
    v_mfma_f32_16x16x32_bf16 v[28:31], v[148:151], v[92:95], v[28:31]
    ds_read_b64_tr_b16 v[146:147], v160 offset:56512
    s_add_u32 m0, s61, 126976
    s_nop 0
    buffer_load_dwordx4 v220, s[32:35], s60 offen lds
    s_waitcnt lgkmcnt(4)
    v_mfma_f32_16x16x32_bf16 v[32:35], v[152:155], v[88:91], v[32:35]
    ds_read_b64_tr_b16 v[148:149], v161 offset:51424
    v_mfma_f32_16x16x32_bf16 v[36:39], v[152:155], v[92:95], v[36:39]
    ds_read_b64_tr_b16 v[150:151], v161 offset:56544
    s_waitcnt lgkmcnt(4)
    v_mfma_f32_16x16x32_bf16 v[40:43], v[156:159], v[88:91], v[40:43]
    ds_read_b64_tr_b16 v[152:153], v160 offset:51456
    v_mfma_f32_16x16x32_bf16 v[44:47], v[156:159], v[92:95], v[44:47]
    ds_read_b64_tr_b16 v[154:155], v160 offset:56576
    s_waitcnt lgkmcnt(4)
    v_mfma_f32_16x16x32_bf16 v[48:51], v[144:147], v[88:91], v[48:51]
    ds_read_b64_tr_b16 v[156:157], v161 offset:51488
    v_mfma_f32_16x16x32_bf16 v[52:55], v[144:147], v[92:95], v[52:55]
    ds_read_b64_tr_b16 v[158:159], v161 offset:56608
    s_waitcnt vmcnt(9)
    s_waitcnt lgkmcnt(0)
    s_barrier
    v_add_u32 v160, 81920, v160
    v_add_u32 v161, 81920, v161
    v_mfma_f32_16x16x32_bf16 v[56:59], v[148:151], v[88:91], v[56:59]
    ds_read_b64_tr_b16 v[144:145], v160 offset:0
    v_mfma_f32_16x16x32_bf16 v[60:63], v[148:151], v[92:95], v[60:63]
    ds_read_b64_tr_b16 v[146:147], v160 offset:5120
    v_mfma_f32_16x16x32_bf16 v[64:67], v[152:155], v[88:91], v[64:67]
    ds_read_b64_tr_b16 v[148:149], v161 offset:32
    v_mfma_f32_16x16x32_bf16 v[68:71], v[152:155], v[92:95], v[68:71]
    ds_read_b64_tr_b16 v[150:151], v161 offset:5152
    v_mfma_f32_16x16x32_bf16 v[72:75], v[156:159], v[88:91], v[72:75]
    ds_read_b64_tr_b16 v[152:153], v160 offset:64
    v_mfma_f32_16x16x32_bf16 v[76:79], v[156:159], v[92:95], v[76:79]
    ds_read_b64_tr_b16 v[154:155], v160 offset:5184
    s_waitcnt vmcnt(5)
    s_waitcnt lgkmcnt(4)
    v_mfma_f32_16x16x32_bf16 v[0:3], v[144:147], v[96:99], v[0:3]
    ds_read_b64_tr_b16 v[156:157], v161 offset:96
    v_mfma_f32_16x16x32_bf16 v[4:7], v[144:147], v[100:103], v[4:7]
    ds_read_b64_tr_b16 v[158:159], v161 offset:5216
    s_lshl_b32 s62, s65, 11
    s_add_u32 s62, s62, s79
    s_add_u32 s65, s65, 1
    s_cmp_eq_u32 s65, 12
    s_cselect_b32 s65, 0, s65
    s_add_u32 s78, s62, 245760
    s_mul_i32 s60, s64, 81920
    s_add_u32 s60, s60, s80
    s_waitcnt lgkmcnt(4)
    v_mfma_f32_16x16x32_bf16 v[8:11], v[148:151], v[96:99], v[8:11]
    ds_read_b64_tr_b16 v[144:145], v160 offset:128
    v_mfma_f32_16x16x32_bf16 v[12:15], v[148:151], v[100:103], v[12:15]
    ds_read_b64_tr_b16 v[146:147], v160 offset:5248
    s_waitcnt lgkmcnt(4)
    v_mfma_f32_16x16x32_bf16 v[16:19], v[152:155], v[96:99], v[16:19]
    ds_read_b64_tr_b16 v[148:149], v161 offset:160
    v_mfma_f32_16x16x32_bf16 v[20:23], v[152:155], v[100:103], v[20:23]
    ds_read_b64_tr_b16 v[150:151], v161 offset:5280
    s_waitcnt lgkmcnt(4)
    v_mfma_f32_16x16x32_bf16 v[24:27], v[156:159], v[96:99], v[24:27]
    ds_read_b64_tr_b16 v[152:153], v160 offset:192
    s_add_u32 m0, s61, 0
    s_add_u32 s64, s64, 1
    buffer_load_dwordx4 v216, s[32:35], s60 offen lds
    v_mfma_f32_16x16x32_bf16 v[28:31], v[156:159], v[100:103], v[28:31]
    ds_read_b64_tr_b16 v[154:155], v160 offset:5312
    buffer_load_dwordx4 v[112:115], v248, s[28:31], s62 offen offset:0 sc1
    s_waitcnt lgkmcnt(4)
    v_mfma_f32_16x16x32_bf16 v[32:35], v[144:147], v[96:99], v[32:35]
    ds_read_b64_tr_b16 v[156:157], v161 offset:224
    v_mfma_f32_16x16x32_bf16 v[36:39], v[144:147], v[100:103], v[36:39]
    ds_read_b64_tr_b16 v[158:159], v161 offset:5344
    s_waitcnt lgkmcnt(4)
    v_mfma_f32_16x16x32_bf16 v[40:43], v[148:151], v[96:99], v[40:43]
    ds_read_b64_tr_b16 v[144:145], v160 offset:256
    v_mfma_f32_16x16x32_bf16 v[44:47], v[148:151], v[100:103], v[44:47]
    ds_read_b64_tr_b16 v[146:147], v160 offset:5376
    s_add_u32 m0, s61, 1024
    s_cmp_eq_u32 s64, 12
    buffer_load_dwordx4 v217, s[32:35], s60 offen lds
    s_cselect_b32 s64, 0, s64
    s_waitcnt lgkmcnt(4)
    v_mfma_f32_16x16x32_bf16 v[48:51], v[152:155], v[96:99], v[48:51]
    ds_read_b64_tr_b16 v[148:149], v161 offset:288
    v_mfma_f32_16x16x32_bf16 v[52:55], v[152:155], v[100:103], v[52:55]
    ds_read_b64_tr_b16 v[150:151], v161 offset:5408
    buffer_load_dwordx4 v[116:119], v248, s[28:31], s78 offen offset:0 sc1
    s_waitcnt lgkmcnt(4)
    v_mfma_f32_16x16x32_bf16 v[56:59], v[156:159], v[96:99], v[56:59]
    ds_read_b64_tr_b16 v[152:153], v160 offset:10240
    v_mfma_f32_16x16x32_bf16 v[60:63], v[156:159], v[100:103], v[60:63]
    ds_read_b64_tr_b16 v[154:155], v160 offset:15360
    s_waitcnt lgkmcnt(4)
    v_mfma_f32_16x16x32_bf16 v[64:67], v[144:147], v[96:99], v[64:67]
    ds_read_b64_tr_b16 v[156:157], v161 offset:10272
    v_mfma_f32_16x16x32_bf16 v[68:71], v[144:147], v[100:103], v[68:71]
    ds_read_b64_tr_b16 v[158:159], v161 offset:15392
    s_add_u32 m0, s61, 2048
    s_nop 0
    buffer_load_dwordx4 v218, s[32:35], s60 offen lds
    s_waitcnt lgkmcnt(4)
    v_mfma_f32_16x16x32_bf16 v[72:75], v[148:151], v[96:99], v[72:75]
    ds_read_b64_tr_b16 v[144:145], v160 offset:10304
    v_mfma_f32_16x16x32_bf16 v[76:79], v[148:151], v[100:103], v[76:79]
    ds_read_b64_tr_b16 v[146:147], v160 offset:15424
    s_waitcnt vmcnt(6)
    s_waitcnt lgkmcnt(4)
    v_mfma_f32_16x16x32_bf16 v[0:3], v[152:155], v[104:107], v[0:3]
    ds_read_b64_tr_b16 v[148:149], v161 offset:10336
    buffer_load_dwordx4 v[120:123], v248, s[28:31], s62 offen offset:1024 sc1
    v_mfma_f32_16x16x32_bf16 v[4:7], v[152:155], v[108:111], v[4:7]
    ds_read_b64_tr_b16 v[150:151], v161 offset:15456
    s_waitcnt lgkmcnt(4)
    v_mfma_f32_16x16x32_bf16 v[8:11], v[156:159], v[104:107], v[8:11]
    ds_read_b64_tr_b16 v[152:153], v160 offset:10368
    s_add_u32 m0, s61, 3072
    s_nop 0
    buffer_load_dwordx4 v219, s[32:35], s60 offen lds
    v_mfma_f32_16x16x32_bf16 v[12:15], v[156:159], v[108:111], v[12:15]
    ds_read_b64_tr_b16 v[154:155], v160 offset:15488
    s_waitcnt lgkmcnt(4)
    v_mfma_f32_16x16x32_bf16 v[16:19], v[144:147], v[104:107], v[16:19]
    ds_read_b64_tr_b16 v[156:157], v161 offset:10400
    v_mfma_f32_16x16x32_bf16 v[20:23], v[144:147], v[108:111], v[20:23]
    ds_read_b64_tr_b16 v[158:159], v161 offset:15520
    s_waitcnt lgkmcnt(4)
    v_mfma_f32_16x16x32_bf16 v[24:27], v[148:151], v[104:107], v[24:27]
    ds_read_b64_tr_b16 v[144:145], v160 offset:10432
    buffer_load_dwordx4 v[124:127], v248, s[28:31], s78 offen offset:1024 sc1
    v_mfma_f32_16x16x32_bf16 v[28:31], v[148:151], v[108:111], v[28:31]
    ds_read_b64_tr_b16 v[146:147], v160 offset:15552
    s_add_u32 m0, s61, 4096
    s_nop 0
    buffer_load_dwordx4 v220, s[32:35], s60 offen lds
    s_waitcnt lgkmcnt(4)
    v_mfma_f32_16x16x32_bf16 v[32:35], v[152:155], v[104:107], v[32:35]
    ds_read_b64_tr_b16 v[148:149], v161 offset:10464
    v_mfma_f32_16x16x32_bf16 v[36:39], v[152:155], v[108:111], v[36:39]
    ds_read_b64_tr_b16 v[150:151], v161 offset:15584
    s_waitcnt lgkmcnt(4)
    v_mfma_f32_16x16x32_bf16 v[40:43], v[156:159], v[104:107], v[40:43]
    ds_read_b64_tr_b16 v[152:153], v160 offset:10496
    v_mfma_f32_16x16x32_bf16 v[44:47], v[156:159], v[108:111], v[44:47]
    ds_read_b64_tr_b16 v[154:155], v160 offset:15616
    s_waitcnt lgkmcnt(4)
    v_mfma_f32_16x16x32_bf16 v[48:51], v[144:147], v[104:107], v[48:51]
    ds_read_b64_tr_b16 v[156:157], v161 offset:10528
    v_mfma_f32_16x16x32_bf16 v[52:55], v[144:147], v[108:111], v[52:55]
    ds_read_b64_tr_b16 v[158:159], v161 offset:15648
    s_waitcnt vmcnt(9)
    s_waitcnt lgkmcnt(0)
    s_barrier
    v_mfma_f32_16x16x32_bf16 v[56:59], v[148:151], v[104:107], v[56:59]
    ds_read_b64_tr_b16 v[144:145], v160 offset:40960
    v_mfma_f32_16x16x32_bf16 v[60:63], v[148:151], v[108:111], v[60:63]
    ds_read_b64_tr_b16 v[146:147], v160 offset:46080
    v_mfma_f32_16x16x32_bf16 v[64:67], v[152:155], v[104:107], v[64:67]
    ds_read_b64_tr_b16 v[148:149], v161 offset:40992
    v_mfma_f32_16x16x32_bf16 v[68:71], v[152:155], v[108:111], v[68:71]
    ds_read_b64_tr_b16 v[150:151], v161 offset:46112
    v_mfma_f32_16x16x32_bf16 v[72:75], v[156:159], v[104:107], v[72:75]
    ds_read_b64_tr_b16 v[152:153], v160 offset:41024
    v_mfma_f32_16x16x32_bf16 v[76:79], v[156:159], v[108:111], v[76:79]
    ds_read_b64_tr_b16 v[154:155], v160 offset:46144
    s_waitcnt vmcnt(5)
    s_waitcnt lgkmcnt(4)
    v_mfma_f32_16x16x32_bf16 v[0:3], v[144:147], v[112:115], v[0:3]
    ds_read_b64_tr_b16 v[156:157], v161 offset:41056
    v_mfma_f32_16x16x32_bf16 v[4:7], v[144:147], v[116:119], v[4:7]
    ds_read_b64_tr_b16 v[158:159], v161 offset:46176
    s_lshl_b32 s62, s65, 11
    s_add_u32 s62, s62, s79
    s_add_u32 s65, s65, 1
    s_cmp_eq_u32 s65, 12
    s_cselect_b32 s65, 0, s65
    s_add_u32 s78, s62, 245760
    s_mul_i32 s60, s64, 81920
    s_add_u32 s60, s60, s80
    s_waitcnt lgkmcnt(4)
    v_mfma_f32_16x16x32_bf16 v[8:11], v[148:151], v[112:115], v[8:11]
    ds_read_b64_tr_b16 v[144:145], v160 offset:41088
    v_mfma_f32_16x16x32_bf16 v[12:15], v[148:151], v[116:119], v[12:15]
    ds_read_b64_tr_b16 v[146:147], v160 offset:46208
    s_waitcnt lgkmcnt(4)
    v_mfma_f32_16x16x32_bf16 v[16:19], v[152:155], v[112:115], v[16:19]
    ds_read_b64_tr_b16 v[148:149], v161 offset:41120
    v_mfma_f32_16x16x32_bf16 v[20:23], v[152:155], v[116:119], v[20:23]
    ds_read_b64_tr_b16 v[150:151], v161 offset:46240
    s_waitcnt lgkmcnt(4)
    v_mfma_f32_16x16x32_bf16 v[24:27], v[156:159], v[112:115], v[24:27]
    ds_read_b64_tr_b16 v[152:153], v160 offset:41152
    s_add_u32 m0, s61, 40960
    s_add_u32 s64, s64, 1
    buffer_load_dwordx4 v216, s[32:35], s60 offen lds
    v_mfma_f32_16x16x32_bf16 v[28:31], v[156:159], v[116:119], v[28:31]
    ds_read_b64_tr_b16 v[154:155], v160 offset:46272
    buffer_load_dwordx4 v[128:131], v248, s[28:31], s62 offen offset:0 sc1
    s_waitcnt lgkmcnt(4)
    v_mfma_f32_16x16x32_bf16 v[32:35], v[144:147], v[112:115], v[32:35]
    ds_read_b64_tr_b16 v[156:157], v161 offset:41184
    v_mfma_f32_16x16x32_bf16 v[36:39], v[144:147], v[116:119], v[36:39]
    ds_read_b64_tr_b16 v[158:159], v161 offset:46304
    s_waitcnt lgkmcnt(4)
    v_mfma_f32_16x16x32_bf16 v[40:43], v[148:151], v[112:115], v[40:43]
    ds_read_b64_tr_b16 v[144:145], v160 offset:41216
    v_mfma_f32_16x16x32_bf16 v[44:47], v[148:151], v[116:119], v[44:47]
    ds_read_b64_tr_b16 v[146:147], v160 offset:46336
    s_add_u32 m0, s61, 41984
    s_cmp_eq_u32 s64, 12
    buffer_load_dwordx4 v217, s[32:35], s60 offen lds
    s_cselect_b32 s64, 0, s64
    s_waitcnt lgkmcnt(4)
    v_mfma_f32_16x16x32_bf16 v[48:51], v[152:155], v[112:115], v[48:51]
    ds_read_b64_tr_b16 v[148:149], v161 offset:41248
    v_mfma_f32_16x16x32_bf16 v[52:55], v[152:155], v[116:119], v[52:55]
    ds_read_b64_tr_b16 v[150:151], v161 offset:46368
    buffer_load_dwordx4 v[132:135], v248, s[28:31], s78 offen offset:0 sc1
    s_waitcnt lgkmcnt(4)
    v_mfma_f32_16x16x32_bf16 v[56:59], v[156:159], v[112:115], v[56:59]
    ds_read_b64_tr_b16 v[152:153], v160 offset:51200
    v_mfma_f32_16x16x32_bf16 v[60:63], v[156:159], v[116:119], v[60:63]
    ds_read_b64_tr_b16 v[154:155], v160 offset:56320
    s_waitcnt lgkmcnt(4)
    v_mfma_f32_16x16x32_bf16 v[64:67], v[144:147], v[112:115], v[64:67]
    ds_read_b64_tr_b16 v[156:157], v161 offset:51232
    v_mfma_f32_16x16x32_bf16 v[68:71], v[144:147], v[116:119], v[68:71]
    ds_read_b64_tr_b16 v[158:159], v161 offset:56352
    s_add_u32 m0, s61, 43008
    s_nop 0
    buffer_load_dwordx4 v218, s[32:35], s60 offen lds
    s_waitcnt lgkmcnt(4)
    v_mfma_f32_16x16x32_bf16 v[72:75], v[148:151], v[112:115], v[72:75]
    ds_read_b64_tr_b16 v[144:145], v160 offset:51264
    v_mfma_f32_16x16x32_bf16 v[76:79], v[148:151], v[116:119], v[76:79]
    ds_read_b64_tr_b16 v[146:147], v160 offset:56384
    s_waitcnt vmcnt(6)
    s_waitcnt lgkmcnt(4)
    v_mfma_f32_16x16x32_bf16 v[0:3], v[152:155], v[120:123], v[0:3]
    ds_read_b64_tr_b16 v[148:149], v161 offset:51296
    buffer_load_dwordx4 v[136:139], v248, s[28:31], s62 offen offset:1024 sc1
    v_mfma_f32_16x16x32_bf16 v[4:7], v[152:155], v[124:127], v[4:7]
    ds_read_b64_tr_b16 v[150:151], v161 offset:56416
    s_waitcnt lgkmcnt(4)
    v_mfma_f32_16x16x32_bf16 v[8:11], v[156:159], v[120:123], v[8:11]
    ds_read_b64_tr_b16 v[152:153], v160 offset:51328
    s_add_u32 m0, s61, 44032
    s_nop 0
    buffer_load_dwordx4 v219, s[32:35], s60 offen lds
    v_mfma_f32_16x16x32_bf16 v[12:15], v[156:159], v[124:127], v[12:15]
    ds_read_b64_tr_b16 v[154:155], v160 offset:56448
    s_waitcnt lgkmcnt(4)
    v_mfma_f32_16x16x32_bf16 v[16:19], v[144:147], v[120:123], v[16:19]
    ds_read_b64_tr_b16 v[156:157], v161 offset:51360
    v_mfma_f32_16x16x32_bf16 v[20:23], v[144:147], v[124:127], v[20:23]
    ds_read_b64_tr_b16 v[158:159], v161 offset:56480
    s_waitcnt lgkmcnt(4)
    v_mfma_f32_16x16x32_bf16 v[24:27], v[148:151], v[120:123], v[24:27]
    ds_read_b64_tr_b16 v[144:145], v160 offset:51392
    buffer_load_dwordx4 v[140:143], v248, s[28:31], s78 offen offset:1024 sc1
    v_mfma_f32_16x16x32_bf16 v[28:31], v[148:151], v[124:127], v[28:31]
    ds_read_b64_tr_b16 v[146:147], v160 offset:56512
    s_add_u32 m0, s61, 45056
    s_nop 0
    buffer_load_dwordx4 v220, s[32:35], s60 offen lds
    s_waitcnt lgkmcnt(4)
    v_mfma_f32_16x16x32_bf16 v[32:35], v[152:155], v[120:123], v[32:35]
    ds_read_b64_tr_b16 v[148:149], v161 offset:51424
    v_mfma_f32_16x16x32_bf16 v[36:39], v[152:155], v[124:127], v[36:39]
    ds_read_b64_tr_b16 v[150:151], v161 offset:56544
    s_waitcnt lgkmcnt(4)
    v_mfma_f32_16x16x32_bf16 v[40:43], v[156:159], v[120:123], v[40:43]
    ds_read_b64_tr_b16 v[152:153], v160 offset:51456
    v_mfma_f32_16x16x32_bf16 v[44:47], v[156:159], v[124:127], v[44:47]
    ds_read_b64_tr_b16 v[154:155], v160 offset:56576
    s_waitcnt lgkmcnt(4)
    v_mfma_f32_16x16x32_bf16 v[48:51], v[144:147], v[120:123], v[48:51]
    ds_read_b64_tr_b16 v[156:157], v161 offset:51488
    v_mfma_f32_16x16x32_bf16 v[52:55], v[144:147], v[124:127], v[52:55]
    ds_read_b64_tr_b16 v[158:159], v161 offset:56608
    s_waitcnt vmcnt(9)
    s_waitcnt lgkmcnt(0)
    s_barrier
    v_add_u32 v160, 4294885376, v160
    v_add_u32 v161, 4294885376, v161
    v_mfma_f32_16x16x32_bf16 v[56:59], v[148:151], v[120:123], v[56:59]
    ds_read_b64_tr_b16 v[144:145], v160 offset:0
    v_mfma_f32_16x16x32_bf16 v[60:63], v[148:151], v[124:127], v[60:63]
    ds_read_b64_tr_b16 v[146:147], v160 offset:5120
    v_mfma_f32_16x16x32_bf16 v[64:67], v[152:155], v[120:123], v[64:67]
    ds_read_b64_tr_b16 v[148:149], v161 offset:32
    v_mfma_f32_16x16x32_bf16 v[68:71], v[152:155], v[124:127], v[68:71]
    ds_read_b64_tr_b16 v[150:151], v161 offset:5152
    v_mfma_f32_16x16x32_bf16 v[72:75], v[156:159], v[120:123], v[72:75]
    ds_read_b64_tr_b16 v[152:153], v160 offset:64
    v_mfma_f32_16x16x32_bf16 v[76:79], v[156:159], v[124:127], v[76:79]
    ds_read_b64_tr_b16 v[154:155], v160 offset:5184
    s_waitcnt vmcnt(5)
    s_waitcnt lgkmcnt(4)
    v_mfma_f32_16x16x32_bf16 v[0:3], v[144:147], v[128:131], v[0:3]
    ds_read_b64_tr_b16 v[156:157], v161 offset:96
    v_mfma_f32_16x16x32_bf16 v[4:7], v[144:147], v[132:135], v[4:7]
    ds_read_b64_tr_b16 v[158:159], v161 offset:5216
    s_lshl_b32 s62, s65, 11
    s_add_u32 s62, s62, s79
    s_add_u32 s65, s65, 1
    s_cmp_eq_u32 s65, 12
    s_cselect_b32 s65, 0, s65
    s_add_u32 s78, s62, 245760
    s_mul_i32 s60, s64, 81920
    s_add_u32 s60, s60, s80
    s_waitcnt lgkmcnt(4)
    v_mfma_f32_16x16x32_bf16 v[8:11], v[148:151], v[128:131], v[8:11]
    ds_read_b64_tr_b16 v[144:145], v160 offset:128
    v_mfma_f32_16x16x32_bf16 v[12:15], v[148:151], v[132:135], v[12:15]
    ds_read_b64_tr_b16 v[146:147], v160 offset:5248
    s_waitcnt lgkmcnt(4)
    v_mfma_f32_16x16x32_bf16 v[16:19], v[152:155], v[128:131], v[16:19]
    ds_read_b64_tr_b16 v[148:149], v161 offset:160
    v_mfma_f32_16x16x32_bf16 v[20:23], v[152:155], v[132:135], v[20:23]
    ds_read_b64_tr_b16 v[150:151], v161 offset:5280
    s_waitcnt lgkmcnt(4)
    v_mfma_f32_16x16x32_bf16 v[24:27], v[156:159], v[128:131], v[24:27]
    ds_read_b64_tr_b16 v[152:153], v160 offset:192
    s_add_u32 m0, s61, 81920
    s_add_u32 s64, s64, 1
    buffer_load_dwordx4 v216, s[32:35], s60 offen lds
    v_mfma_f32_16x16x32_bf16 v[28:31], v[156:159], v[132:135], v[28:31]
    ds_read_b64_tr_b16 v[154:155], v160 offset:5312
    buffer_load_dwordx4 v[80:83], v248, s[28:31], s62 offen offset:0 sc1
    s_waitcnt lgkmcnt(4)
    v_mfma_f32_16x16x32_bf16 v[32:35], v[144:147], v[128:131], v[32:35]
    ds_read_b64_tr_b16 v[156:157], v161 offset:224
    v_mfma_f32_16x16x32_bf16 v[36:39], v[144:147], v[132:135], v[36:39]
    ds_read_b64_tr_b16 v[158:159], v161 offset:5344
    s_waitcnt lgkmcnt(4)
    v_mfma_f32_16x16x32_bf16 v[40:43], v[148:151], v[128:131], v[40:43]
    ds_read_b64_tr_b16 v[144:145], v160 offset:256
    v_mfma_f32_16x16x32_bf16 v[44:47], v[148:151], v[132:135], v[44:47]
    ds_read_b64_tr_b16 v[146:147], v160 offset:5376
    s_add_u32 m0, s61, 82944
    s_cmp_eq_u32 s64, 12
    buffer_load_dwordx4 v217, s[32:35], s60 offen lds
    s_cselect_b32 s64, 0, s64
    s_waitcnt lgkmcnt(4)
    v_mfma_f32_16x16x32_bf16 v[48:51], v[152:155], v[128:131], v[48:51]
    ds_read_b64_tr_b16 v[148:149], v161 offset:288
    v_mfma_f32_16x16x32_bf16 v[52:55], v[152:155], v[132:135], v[52:55]
    ds_read_b64_tr_b16 v[150:151], v161 offset:5408
    buffer_load_dwordx4 v[84:87], v248, s[28:31], s78 offen offset:0 sc1
    s_waitcnt lgkmcnt(4)
    v_mfma_f32_16x16x32_bf16 v[56:59], v[156:159], v[128:131], v[56:59]
    ds_read_b64_tr_b16 v[152:153], v160 offset:10240
    v_mfma_f32_16x16x32_bf16 v[60:63], v[156:159], v[132:135], v[60:63]
    ds_read_b64_tr_b16 v[154:155], v160 offset:15360
    s_waitcnt lgkmcnt(4)
    v_mfma_f32_16x16x32_bf16 v[64:67], v[144:147], v[128:131], v[64:67]
    ds_read_b64_tr_b16 v[156:157], v161 offset:10272
    v_mfma_f32_16x16x32_bf16 v[68:71], v[144:147], v[132:135], v[68:71]
    ds_read_b64_tr_b16 v[158:159], v161 offset:15392
    s_add_u32 m0, s61, 83968
    s_nop 0
    buffer_load_dwordx4 v218, s[32:35], s60 offen lds
    s_waitcnt lgkmcnt(4)
    v_mfma_f32_16x16x32_bf16 v[72:75], v[148:151], v[128:131], v[72:75]
    ds_read_b64_tr_b16 v[144:145], v160 offset:10304
    v_mfma_f32_16x16x32_bf16 v[76:79], v[148:151], v[132:135], v[76:79]
    ds_read_b64_tr_b16 v[146:147], v160 offset:15424
    s_waitcnt vmcnt(6)
    s_waitcnt lgkmcnt(4)
    v_mfma_f32_16x16x32_bf16 v[0:3], v[152:155], v[136:139], v[0:3]
    ds_read_b64_tr_b16 v[148:149], v161 offset:10336
    buffer_load_dwordx4 v[88:91], v248, s[28:31], s62 offen offset:1024 sc1
    v_mfma_f32_16x16x32_bf16 v[4:7], v[152:155], v[140:143], v[4:7]
    ds_read_b64_tr_b16 v[150:151], v161 offset:15456
    s_waitcnt lgkmcnt(4)
    v_mfma_f32_16x16x32_bf16 v[8:11], v[156:159], v[136:139], v[8:11]
    ds_read_b64_tr_b16 v[152:153], v160 offset:10368
    s_add_u32 m0, s61, 84992
    s_nop 0
    buffer_load_dwordx4 v219, s[32:35], s60 offen lds
    v_mfma_f32_16x16x32_bf16 v[12:15], v[156:159], v[140:143], v[12:15]
    ds_read_b64_tr_b16 v[154:155], v160 offset:15488
    s_waitcnt lgkmcnt(4)
    v_mfma_f32_16x16x32_bf16 v[16:19], v[144:147], v[136:139], v[16:19]
    ds_read_b64_tr_b16 v[156:157], v161 offset:10400
    v_mfma_f32_16x16x32_bf16 v[20:23], v[144:147], v[140:143], v[20:23]
    ds_read_b64_tr_b16 v[158:159], v161 offset:15520
    s_waitcnt lgkmcnt(4)
    v_mfma_f32_16x16x32_bf16 v[24:27], v[148:151], v[136:139], v[24:27]
    ds_read_b64_tr_b16 v[144:145], v160 offset:10432
    buffer_load_dwordx4 v[92:95], v248, s[28:31], s78 offen offset:1024 sc1
    v_mfma_f32_16x16x32_bf16 v[28:31], v[148:151], v[140:143], v[28:31]
    ds_read_b64_tr_b16 v[146:147], v160 offset:15552
    s_add_u32 m0, s61, 86016
    s_nop 0
    buffer_load_dwordx4 v220, s[32:35], s60 offen lds
    s_waitcnt lgkmcnt(4)
    v_mfma_f32_16x16x32_bf16 v[32:35], v[152:155], v[136:139], v[32:35]
    ds_read_b64_tr_b16 v[148:149], v161 offset:10464
    v_mfma_f32_16x16x32_bf16 v[36:39], v[152:155], v[140:143], v[36:39]
    ds_read_b64_tr_b16 v[150:151], v161 offset:15584
    s_waitcnt lgkmcnt(4)
    v_mfma_f32_16x16x32_bf16 v[40:43], v[156:159], v[136:139], v[40:43]
    ds_read_b64_tr_b16 v[152:153], v160 offset:10496
    v_mfma_f32_16x16x32_bf16 v[44:47], v[156:159], v[140:143], v[44:47]
    ds_read_b64_tr_b16 v[154:155], v160 offset:15616
    s_waitcnt lgkmcnt(4)
    v_mfma_f32_16x16x32_bf16 v[48:51], v[144:147], v[136:139], v[48:51]
    ds_read_b64_tr_b16 v[156:157], v161 offset:10528
    v_mfma_f32_16x16x32_bf16 v[52:55], v[144:147], v[140:143], v[52:55]
    ds_read_b64_tr_b16 v[158:159], v161 offset:15648
    s_waitcnt vmcnt(9)
    s_waitcnt lgkmcnt(0)
    s_barrier
    v_mfma_f32_16x16x32_bf16 v[56:59], v[148:151], v[136:139], v[56:59]
    ds_read_b64_tr_b16 v[144:145], v160 offset:40960
    v_mfma_f32_16x16x32_bf16 v[60:63], v[148:151], v[140:143], v[60:63]
    ds_read_b64_tr_b16 v[146:147], v160 offset:46080
    v_mfma_f32_16x16x32_bf16 v[64:67], v[152:155], v[136:139], v[64:67]
    ds_read_b64_tr_b16 v[148:149], v161 offset:40992
    v_mfma_f32_16x16x32_bf16 v[68:71], v[152:155], v[140:143], v[68:71]
    ds_read_b64_tr_b16 v[150:151], v161 offset:46112
    v_mfma_f32_16x16x32_bf16 v[72:75], v[156:159], v[136:139], v[72:75]
    ds_read_b64_tr_b16 v[152:153], v160 offset:41024
    v_mfma_f32_16x16x32_bf16 v[76:79], v[156:159], v[140:143], v[76:79]
    ds_read_b64_tr_b16 v[154:155], v160 offset:46144
    s_waitcnt vmcnt(5)
    s_waitcnt lgkmcnt(4)
    v_mfma_f32_16x16x32_bf16 v[0:3], v[144:147], v[80:83], v[0:3]
    ds_read_b64_tr_b16 v[156:157], v161 offset:41056
    v_mfma_f32_16x16x32_bf16 v[4:7], v[144:147], v[84:87], v[4:7]
    ds_read_b64_tr_b16 v[158:159], v161 offset:46176
    s_lshl_b32 s62, s65, 11
    s_add_u32 s62, s62, s79
    s_add_u32 s65, s65, 1
    s_cmp_eq_u32 s65, 12
    s_cselect_b32 s65, 0, s65
    s_add_u32 s78, s62, 245760
    s_mul_i32 s60, s64, 81920
    s_add_u32 s60, s60, s80
    s_waitcnt lgkmcnt(4)
    v_mfma_f32_16x16x32_bf16 v[8:11], v[148:151], v[80:83], v[8:11]
    ds_read_b64_tr_b16 v[144:145], v160 offset:41088
    v_mfma_f32_16x16x32_bf16 v[12:15], v[148:151], v[84:87], v[12:15]
    ds_read_b64_tr_b16 v[146:147], v160 offset:46208
    s_waitcnt lgkmcnt(4)
    v_mfma_f32_16x16x32_bf16 v[16:19], v[152:155], v[80:83], v[16:19]
    ds_read_b64_tr_b16 v[148:149], v161 offset:41120
    v_mfma_f32_16x16x32_bf16 v[20:23], v[152:155], v[84:87], v[20:23]
    ds_read_b64_tr_b16 v[150:151], v161 offset:46240
    s_waitcnt lgkmcnt(4)
    v_mfma_f32_16x16x32_bf16 v[24:27], v[156:159], v[80:83], v[24:27]
    ds_read_b64_tr_b16 v[152:153], v160 offset:41152
    s_add_u32 m0, s61, 122880
    s_add_u32 s64, s64, 1
    buffer_load_dwordx4 v216, s[32:35], s60 offen lds
    v_mfma_f32_16x16x32_bf16 v[28:31], v[156:159], v[84:87], v[28:31]
    ds_read_b64_tr_b16 v[154:155], v160 offset:46272
    buffer_load_dwordx4 v[96:99], v248, s[28:31], s62 offen offset:0 sc1
    s_waitcnt lgkmcnt(4)
    v_mfma_f32_16x16x32_bf16 v[32:35], v[144:147], v[80:83], v[32:35]
    ds_read_b64_tr_b16 v[156:157], v161 offset:41184
    v_mfma_f32_16x16x32_bf16 v[36:39], v[144:147], v[84:87], v[36:39]
    ds_read_b64_tr_b16 v[158:159], v161 offset:46304
    s_waitcnt lgkmcnt(4)
    v_mfma_f32_16x16x32_bf16 v[40:43], v[148:151], v[80:83], v[40:43]
    ds_read_b64_tr_b16 v[144:145], v160 offset:41216
    v_mfma_f32_16x16x32_bf16 v[44:47], v[148:151], v[84:87], v[44:47]
    ds_read_b64_tr_b16 v[146:147], v160 offset:46336
    s_add_u32 m0, s61, 123904
    s_cmp_eq_u32 s64, 12
    buffer_load_dwordx4 v217, s[32:35], s60 offen lds
    s_cselect_b32 s64, 0, s64
    s_waitcnt lgkmcnt(4)
    v_mfma_f32_16x16x32_bf16 v[48:51], v[152:155], v[80:83], v[48:51]
    ds_read_b64_tr_b16 v[148:149], v161 offset:41248
    v_mfma_f32_16x16x32_bf16 v[52:55], v[152:155], v[84:87], v[52:55]
    ds_read_b64_tr_b16 v[150:151], v161 offset:46368
    buffer_load_dwordx4 v[100:103], v248, s[28:31], s78 offen offset:0 sc1
    s_waitcnt lgkmcnt(4)
    v_mfma_f32_16x16x32_bf16 v[56:59], v[156:159], v[80:83], v[56:59]
    ds_read_b64_tr_b16 v[152:153], v160 offset:51200
    v_mfma_f32_16x16x32_bf16 v[60:63], v[156:159], v[84:87], v[60:63]
    ds_read_b64_tr_b16 v[154:155], v160 offset:56320
    s_waitcnt lgkmcnt(4)
    v_mfma_f32_16x16x32_bf16 v[64:67], v[144:147], v[80:83], v[64:67]
    ds_read_b64_tr_b16 v[156:157], v161 offset:51232
    v_mfma_f32_16x16x32_bf16 v[68:71], v[144:147], v[84:87], v[68:71]
    ds_read_b64_tr_b16 v[158:159], v161 offset:56352
    s_add_u32 m0, s61, 124928
    s_nop 0
    buffer_load_dwordx4 v218, s[32:35], s60 offen lds
    s_waitcnt lgkmcnt(4)
    v_mfma_f32_16x16x32_bf16 v[72:75], v[148:151], v[80:83], v[72:75]
    ds_read_b64_tr_b16 v[144:145], v160 offset:51264
    v_mfma_f32_16x16x32_bf16 v[76:79], v[148:151], v[84:87], v[76:79]
    ds_read_b64_tr_b16 v[146:147], v160 offset:56384
    s_waitcnt vmcnt(6)
    s_waitcnt lgkmcnt(4)
    v_mfma_f32_16x16x32_bf16 v[0:3], v[152:155], v[88:91], v[0:3]
    ds_read_b64_tr_b16 v[148:149], v161 offset:51296
    buffer_load_dwordx4 v[104:107], v248, s[28:31], s62 offen offset:1024 sc1
    v_mfma_f32_16x16x32_bf16 v[4:7], v[152:155], v[92:95], v[4:7]
    ds_read_b64_tr_b16 v[150:151], v161 offset:56416
    s_waitcnt lgkmcnt(4)
    v_mfma_f32_16x16x32_bf16 v[8:11], v[156:159], v[88:91], v[8:11]
    ds_read_b64_tr_b16 v[152:153], v160 offset:51328
    s_add_u32 m0, s61, 125952
    s_nop 0
    buffer_load_dwordx4 v219, s[32:35], s60 offen lds
    v_mfma_f32_16x16x32_bf16 v[12:15], v[156:159], v[92:95], v[12:15]
    ds_read_b64_tr_b16 v[154:155], v160 offset:56448
    s_waitcnt lgkmcnt(4)
    v_mfma_f32_16x16x32_bf16 v[16:19], v[144:147], v[88:91], v[16:19]
    ds_read_b64_tr_b16 v[156:157], v161 offset:51360
    v_mfma_f32_16x16x32_bf16 v[20:23], v[144:147], v[92:95], v[20:23]
    ds_read_b64_tr_b16 v[158:159], v161 offset:56480
    s_waitcnt lgkmcnt(4)
    v_mfma_f32_16x16x32_bf16 v[24:27], v[148:151], v[88:91], v[24:27]
    ds_read_b64_tr_b16 v[144:145], v160 offset:51392
    buffer_load_dwordx4 v[108:111], v248, s[28:31], s78 offen offset:1024 sc1
    v_mfma_f32_16x16x32_bf16 v[28:31], v[148:151], v[92:95], v[28:31]
    ds_read_b64_tr_b16 v[146:147], v160 offset:56512
    s_add_u32 m0, s61, 126976
    s_nop 0
    buffer_load_dwordx4 v220, s[32:35], s60 offen lds
    s_waitcnt lgkmcnt(4)
    v_mfma_f32_16x16x32_bf16 v[32:35], v[152:155], v[88:91], v[32:35]
    ds_read_b64_tr_b16 v[148:149], v161 offset:51424
    v_mfma_f32_16x16x32_bf16 v[36:39], v[152:155], v[92:95], v[36:39]
    ds_read_b64_tr_b16 v[150:151], v161 offset:56544
    s_waitcnt lgkmcnt(4)
    v_mfma_f32_16x16x32_bf16 v[40:43], v[156:159], v[88:91], v[40:43]
    ds_read_b64_tr_b16 v[152:153], v160 offset:51456
    v_mfma_f32_16x16x32_bf16 v[44:47], v[156:159], v[92:95], v[44:47]
    ds_read_b64_tr_b16 v[154:155], v160 offset:56576
    s_waitcnt lgkmcnt(4)
    v_mfma_f32_16x16x32_bf16 v[48:51], v[144:147], v[88:91], v[48:51]
    ds_read_b64_tr_b16 v[156:157], v161 offset:51488
    v_mfma_f32_16x16x32_bf16 v[52:55], v[144:147], v[92:95], v[52:55]
    ds_read_b64_tr_b16 v[158:159], v161 offset:56608
    s_waitcnt vmcnt(9)
    s_waitcnt lgkmcnt(0)
    s_barrier
    v_add_u32 v160, 81920, v160
    v_add_u32 v161, 81920, v161
    v_mfma_f32_16x16x32_bf16 v[56:59], v[148:151], v[88:91], v[56:59]
    ds_read_b64_tr_b16 v[144:145], v160 offset:0
    v_mfma_f32_16x16x32_bf16 v[60:63], v[148:151], v[92:95], v[60:63]
    ds_read_b64_tr_b16 v[146:147], v160 offset:5120
    v_mfma_f32_16x16x32_bf16 v[64:67], v[152:155], v[88:91], v[64:67]
    ds_read_b64_tr_b16 v[148:149], v161 offset:32
    v_mfma_f32_16x16x32_bf16 v[68:71], v[152:155], v[92:95], v[68:71]
    ds_read_b64_tr_b16 v[150:151], v161 offset:5152
    v_mfma_f32_16x16x32_bf16 v[72:75], v[156:159], v[88:91], v[72:75]
    ds_read_b64_tr_b16 v[152:153], v160 offset:64
    v_mfma_f32_16x16x32_bf16 v[76:79], v[156:159], v[92:95], v[76:79]
    ds_read_b64_tr_b16 v[154:155], v160 offset:5184
    s_waitcnt vmcnt(5)
    s_waitcnt lgkmcnt(4)
    v_mfma_f32_16x16x32_bf16 v[0:3], v[144:147], v[96:99], v[0:3]
    ds_read_b64_tr_b16 v[156:157], v161 offset:96
    v_mfma_f32_16x16x32_bf16 v[4:7], v[144:147], v[100:103], v[4:7]
    ds_read_b64_tr_b16 v[158:159], v161 offset:5216
    s_lshl_b32 s62, s65, 11
    s_add_u32 s62, s62, s79
    s_add_u32 s65, s65, 1
    s_cmp_eq_u32 s65, 12
    s_cselect_b32 s65, 0, s65
    s_add_u32 s78, s62, 245760
    s_waitcnt lgkmcnt(4)
    v_mfma_f32_16x16x32_bf16 v[8:11], v[148:151], v[96:99], v[8:11]
    ds_read_b64_tr_b16 v[144:145], v160 offset:128
    v_mfma_f32_16x16x32_bf16 v[12:15], v[148:151], v[100:103], v[12:15]
    ds_read_b64_tr_b16 v[146:147], v160 offset:5248
    s_waitcnt lgkmcnt(4)
    v_mfma_f32_16x16x32_bf16 v[16:19], v[152:155], v[96:99], v[16:19]
    ds_read_b64_tr_b16 v[148:149], v161 offset:160
    v_mfma_f32_16x16x32_bf16 v[20:23], v[152:155], v[100:103], v[20:23]
    ds_read_b64_tr_b16 v[150:151], v161 offset:5280
    s_waitcnt lgkmcnt(4)
    v_mfma_f32_16x16x32_bf16 v[24:27], v[156:159], v[96:99], v[24:27]
    ds_read_b64_tr_b16 v[152:153], v160 offset:192
    v_mfma_f32_16x16x32_bf16 v[28:31], v[156:159], v[100:103], v[28:31]
    ds_read_b64_tr_b16 v[154:155], v160 offset:5312
    buffer_load_dwordx4 v[112:115], v248, s[28:31], s62 offen offset:0 sc1
    s_waitcnt lgkmcnt(4)
    v_mfma_f32_16x16x32_bf16 v[32:35], v[144:147], v[96:99], v[32:35]
    ds_read_b64_tr_b16 v[156:157], v161 offset:224
    v_mfma_f32_16x16x32_bf16 v[36:39], v[144:147], v[100:103], v[36:39]
    ds_read_b64_tr_b16 v[158:159], v161 offset:5344
    s_waitcnt lgkmcnt(4)
    v_mfma_f32_16x16x32_bf16 v[40:43], v[148:151], v[96:99], v[40:43]
    ds_read_b64_tr_b16 v[144:145], v160 offset:256
    v_mfma_f32_16x16x32_bf16 v[44:47], v[148:151], v[100:103], v[44:47]
    ds_read_b64_tr_b16 v[146:147], v160 offset:5376
    s_waitcnt lgkmcnt(4)
    v_mfma_f32_16x16x32_bf16 v[48:51], v[152:155], v[96:99], v[48:51]
    ds_read_b64_tr_b16 v[148:149], v161 offset:288
    v_mfma_f32_16x16x32_bf16 v[52:55], v[152:155], v[100:103], v[52:55]
    ds_read_b64_tr_b16 v[150:151], v161 offset:5408
    buffer_load_dwordx4 v[116:119], v248, s[28:31], s78 offen offset:0 sc1
    s_waitcnt lgkmcnt(4)
    v_mfma_f32_16x16x32_bf16 v[56:59], v[156:159], v[96:99], v[56:59]
    ds_read_b64_tr_b16 v[152:153], v160 offset:10240
    v_mfma_f32_16x16x32_bf16 v[60:63], v[156:159], v[100:103], v[60:63]
    ds_read_b64_tr_b16 v[154:155], v160 offset:15360
    s_waitcnt lgkmcnt(4)
    v_mfma_f32_16x16x32_bf16 v[64:67], v[144:147], v[96:99], v[64:67]
    ds_read_b64_tr_b16 v[156:157], v161 offset:10272
    v_mfma_f32_16x16x32_bf16 v[68:71], v[144:147], v[100:103], v[68:71]
    ds_read_b64_tr_b16 v[158:159], v161 offset:15392
    s_waitcnt lgkmcnt(4)
    v_mfma_f32_16x16x32_bf16 v[72:75], v[148:151], v[96:99], v[72:75]
    ds_read_b64_tr_b16 v[144:145], v160 offset:10304
    v_mfma_f32_16x16x32_bf16 v[76:79], v[148:151], v[100:103], v[76:79]
    ds_read_b64_tr_b16 v[146:147], v160 offset:15424
    s_waitcnt vmcnt(3)
    s_waitcnt lgkmcnt(4)
    v_mfma_f32_16x16x32_bf16 v[0:3], v[152:155], v[104:107], v[0:3]
    ds_read_b64_tr_b16 v[148:149], v161 offset:10336
    buffer_load_dwordx4 v[120:123], v248, s[28:31], s62 offen offset:1024 sc1
    v_mfma_f32_16x16x32_bf16 v[4:7], v[152:155], v[108:111], v[4:7]
    ds_read_b64_tr_b16 v[150:151], v161 offset:15456
    s_waitcnt lgkmcnt(4)
    v_mfma_f32_16x16x32_bf16 v[8:11], v[156:159], v[104:107], v[8:11]
    ds_read_b64_tr_b16 v[152:153], v160 offset:10368
    v_mfma_f32_16x16x32_bf16 v[12:15], v[156:159], v[108:111], v[12:15]
    ds_read_b64_tr_b16 v[154:155], v160 offset:15488
    s_waitcnt lgkmcnt(4)
    v_mfma_f32_16x16x32_bf16 v[16:19], v[144:147], v[104:107], v[16:19]
    ds_read_b64_tr_b16 v[156:157], v161 offset:10400
    v_mfma_f32_16x16x32_bf16 v[20:23], v[144:147], v[108:111], v[20:23]
    ds_read_b64_tr_b16 v[158:159], v161 offset:15520
    s_waitcnt lgkmcnt(4)
    v_mfma_f32_16x16x32_bf16 v[24:27], v[148:151], v[104:107], v[24:27]
    ds_read_b64_tr_b16 v[144:145], v160 offset:10432
    buffer_load_dwordx4 v[124:127], v248, s[28:31], s78 offen offset:1024 sc1
    v_mfma_f32_16x16x32_bf16 v[28:31], v[148:151], v[108:111], v[28:31]
    ds_read_b64_tr_b16 v[146:147], v160 offset:15552
    s_waitcnt lgkmcnt(4)
    v_mfma_f32_16x16x32_bf16 v[32:35], v[152:155], v[104:107], v[32:35]
    ds_read_b64_tr_b16 v[148:149], v161 offset:10464
    v_mfma_f32_16x16x32_bf16 v[36:39], v[152:155], v[108:111], v[36:39]
    ds_read_b64_tr_b16 v[150:151], v161 offset:15584
    s_waitcnt lgkmcnt(4)
    v_mfma_f32_16x16x32_bf16 v[40:43], v[156:159], v[104:107], v[40:43]
    ds_read_b64_tr_b16 v[152:153], v160 offset:10496
    v_mfma_f32_16x16x32_bf16 v[44:47], v[156:159], v[108:111], v[44:47]
    ds_read_b64_tr_b16 v[154:155], v160 offset:15616
    s_waitcnt lgkmcnt(4)
    v_mfma_f32_16x16x32_bf16 v[48:51], v[144:147], v[104:107], v[48:51]
    ds_read_b64_tr_b16 v[156:157], v161 offset:10528
    v_mfma_f32_16x16x32_bf16 v[52:55], v[144:147], v[108:111], v[52:55]
    ds_read_b64_tr_b16 v[158:159], v161 offset:15648
    s_waitcnt vmcnt(4)
    s_waitcnt lgkmcnt(0)
    s_barrier
    v_mfma_f32_16x16x32_bf16 v[56:59], v[148:151], v[104:107], v[56:59]
    ds_read_b64_tr_b16 v[144:145], v160 offset:40960
    v_mfma_f32_16x16x32_bf16 v[60:63], v[148:151], v[108:111], v[60:63]
    ds_read_b64_tr_b16 v[146:147], v160 offset:46080
    v_mfma_f32_16x16x32_bf16 v[64:67], v[152:155], v[104:107], v[64:67]
    ds_read_b64_tr_b16 v[148:149], v161 offset:40992
    v_mfma_f32_16x16x32_bf16 v[68:71], v[152:155], v[108:111], v[68:71]
    ds_read_b64_tr_b16 v[150:151], v161 offset:46112
    v_mfma_f32_16x16x32_bf16 v[72:75], v[156:159], v[104:107], v[72:75]
    ds_read_b64_tr_b16 v[152:153], v160 offset:41024
    v_mfma_f32_16x16x32_bf16 v[76:79], v[156:159], v[108:111], v[76:79]
    ds_read_b64_tr_b16 v[154:155], v160 offset:46144
    s_waitcnt vmcnt(2)
    s_waitcnt lgkmcnt(4)
    v_mfma_f32_16x16x32_bf16 v[0:3], v[144:147], v[112:115], v[0:3]
    ds_read_b64_tr_b16 v[156:157], v161 offset:41056
    v_mfma_f32_16x16x32_bf16 v[4:7], v[144:147], v[116:119], v[4:7]
    ds_read_b64_tr_b16 v[158:159], v161 offset:46176
    s_waitcnt lgkmcnt(4)
    v_mfma_f32_16x16x32_bf16 v[8:11], v[148:151], v[112:115], v[8:11]
    ds_read_b64_tr_b16 v[144:145], v160 offset:41088
    v_mfma_f32_16x16x32_bf16 v[12:15], v[148:151], v[116:119], v[12:15]
    ds_read_b64_tr_b16 v[146:147], v160 offset:46208
    s_waitcnt lgkmcnt(4)
    v_mfma_f32_16x16x32_bf16 v[16:19], v[152:155], v[112:115], v[16:19]
    ds_read_b64_tr_b16 v[148:149], v161 offset:41120
    v_mfma_f32_16x16x32_bf16 v[20:23], v[152:155], v[116:119], v[20:23]
    ds_read_b64_tr_b16 v[150:151], v161 offset:46240
    s_waitcnt lgkmcnt(4)
    v_mfma_f32_16x16x32_bf16 v[24:27], v[156:159], v[112:115], v[24:27]
    ds_read_b64_tr_b16 v[152:153], v160 offset:41152
    v_mfma_f32_16x16x32_bf16 v[28:31], v[156:159], v[116:119], v[28:31]
    ds_read_b64_tr_b16 v[154:155], v160 offset:46272
    s_waitcnt lgkmcnt(4)
    v_mfma_f32_16x16x32_bf16 v[32:35], v[144:147], v[112:115], v[32:35]
    ds_read_b64_tr_b16 v[156:157], v161 offset:41184
    v_mfma_f32_16x16x32_bf16 v[36:39], v[144:147], v[116:119], v[36:39]
    ds_read_b64_tr_b16 v[158:159], v161 offset:46304
    s_waitcnt lgkmcnt(4)
    v_mfma_f32_16x16x32_bf16 v[40:43], v[148:151], v[112:115], v[40:43]
    ds_read_b64_tr_b16 v[144:145], v160 offset:41216
    v_mfma_f32_16x16x32_bf16 v[44:47], v[148:151], v[116:119], v[44:47]
    ds_read_b64_tr_b16 v[146:147], v160 offset:46336
    s_waitcnt lgkmcnt(4)
    v_mfma_f32_16x16x32_bf16 v[48:51], v[152:155], v[112:115], v[48:51]
    ds_read_b64_tr_b16 v[148:149], v161 offset:41248
    v_mfma_f32_16x16x32_bf16 v[52:55], v[152:155], v[116:119], v[52:55]
    ds_read_b64_tr_b16 v[150:151], v161 offset:46368
    s_waitcnt lgkmcnt(4)
    v_mfma_f32_16x16x32_bf16 v[56:59], v[156:159], v[112:115], v[56:59]
    ds_read_b64_tr_b16 v[152:153], v160 offset:51200
    v_mfma_f32_16x16x32_bf16 v[60:63], v[156:159], v[116:119], v[60:63]
    ds_read_b64_tr_b16 v[154:155], v160 offset:56320
    s_waitcnt lgkmcnt(4)
    v_mfma_f32_16x16x32_bf16 v[64:67], v[144:147], v[112:115], v[64:67]
    ds_read_b64_tr_b16 v[156:157], v161 offset:51232
    v_mfma_f32_16x16x32_bf16 v[68:71], v[144:147], v[116:119], v[68:71]
    ds_read_b64_tr_b16 v[158:159], v161 offset:56352
    s_waitcnt lgkmcnt(4)
    v_mfma_f32_16x16x32_bf16 v[72:75], v[148:151], v[112:115], v[72:75]
    ds_read_b64_tr_b16 v[144:145], v160 offset:51264
    v_mfma_f32_16x16x32_bf16 v[76:79], v[148:151], v[116:119], v[76:79]
    ds_read_b64_tr_b16 v[146:147], v160 offset:56384
    s_waitcnt vmcnt(0)
    s_waitcnt lgkmcnt(4)
    v_mfma_f32_16x16x32_bf16 v[0:3], v[152:155], v[120:123], v[0:3]
    ds_read_b64_tr_b16 v[148:149], v161 offset:51296
    v_mfma_f32_16x16x32_bf16 v[4:7], v[152:155], v[124:127], v[4:7]
    ds_read_b64_tr_b16 v[150:151], v161 offset:56416
    s_waitcnt lgkmcnt(4)
    v_mfma_f32_16x16x32_bf16 v[8:11], v[156:159], v[120:123], v[8:11]
    ds_read_b64_tr_b16 v[152:153], v160 offset:51328
    v_mfma_f32_16x16x32_bf16 v[12:15], v[156:159], v[124:127], v[12:15]
    ds_read_b64_tr_b16 v[154:155], v160 offset:56448
    s_waitcnt lgkmcnt(4)
    v_mfma_f32_16x16x32_bf16 v[16:19], v[144:147], v[120:123], v[16:19]
    ds_read_b64_tr_b16 v[156:157], v161 offset:51360
    v_mfma_f32_16x16x32_bf16 v[20:23], v[144:147], v[124:127], v[20:23]
    ds_read_b64_tr_b16 v[158:159], v161 offset:56480
    s_waitcnt lgkmcnt(4)
    v_mfma_f32_16x16x32_bf16 v[24:27], v[148:151], v[120:123], v[24:27]
    ds_read_b64_tr_b16 v[144:145], v160 offset:51392
    v_mfma_f32_16x16x32_bf16 v[28:31], v[148:151], v[124:127], v[28:31]
    ds_read_b64_tr_b16 v[146:147], v160 offset:56512
    s_waitcnt lgkmcnt(4)
    v_mfma_f32_16x16x32_bf16 v[32:35], v[152:155], v[120:123], v[32:35]
    ds_read_b64_tr_b16 v[148:149], v161 offset:51424
    v_mfma_f32_16x16x32_bf16 v[36:39], v[152:155], v[124:127], v[36:39]
    ds_read_b64_tr_b16 v[150:151], v161 offset:56544
    s_waitcnt lgkmcnt(4)
    v_mfma_f32_16x16x32_bf16 v[40:43], v[156:159], v[120:123], v[40:43]
    ds_read_b64_tr_b16 v[152:153], v160 offset:51456
    v_mfma_f32_16x16x32_bf16 v[44:47], v[156:159], v[124:127], v[44:47]
    ds_read_b64_tr_b16 v[154:155], v160 offset:56576
    s_waitcnt lgkmcnt(4)
    v_mfma_f32_16x16x32_bf16 v[48:51], v[144:147], v[120:123], v[48:51]
    ds_read_b64_tr_b16 v[156:157], v161 offset:51488
    v_mfma_f32_16x16x32_bf16 v[52:55], v[144:147], v[124:127], v[52:55]
    ds_read_b64_tr_b16 v[158:159], v161 offset:56608
    s_waitcnt lgkmcnt(4)
    v_mfma_f32_16x16x32_bf16 v[56:59], v[148:151], v[120:123], v[56:59]
    v_mfma_f32_16x16x32_bf16 v[60:63], v[148:151], v[124:127], v[60:63]
    s_waitcnt lgkmcnt(2)
    v_mfma_f32_16x16x32_bf16 v[64:67], v[152:155], v[120:123], v[64:67]
    v_mfma_f32_16x16x32_bf16 v[68:71], v[152:155], v[124:127], v[68:71]
    s_waitcnt lgkmcnt(0)
    v_mfma_f32_16x16x32_bf16 v[72:75], v[156:159], v[120:123], v[72:75]
    v_mfma_f32_16x16x32_bf16 v[76:79], v[156:159], v[124:127], v[76:79]
    s_waitcnt vmcnt(0) lgkmcnt(0)
    s_barrier
    s_mul_i32 s97, s52, 10240
    v_add_u32 v164, s97, v248
    v_add_u32 v166, 81920, v164
    s_xor_b32 s98, s52, 4
    s_mul_i32 s98, s98, 10240
    v_add_u32 v165, s98, v248
    s_lshl_b32 s66, s56, 2
    s_add_u32 s66, s66, s57
    s_mul_i32 s98, s66, 40960
    s_add_u32 s98, s98, 31457280
    s_add_u32 s36, s26, s98
    s_addc_u32 s37, s27, 0
    s_and_b32 s37, s37, 0xffff
    s_mov_b32 s38, 7905280
    s_mov_b32 s39, 0x20000
    s_lshl_b32 s66, s66, 7
    s_and_b32 s81, s52, 2
    s_add_u32 s81, s81, s58
    s_lshl_b32 s97, s81, 1
    s_and_b32 s98, s52, 1
    s_add_u32 s97, s97, s98
    s_mul_i32 s97, s97, 5120
    s_mul_i32 s98, s55, 2621440
    s_add_u32 s60, s97, s98
    s_add_u32 s62, s60, 4096
    s_cmp_eq_u32 s58, 0
    s_cbranch_scc0 L_p2_g1
    ds_write_b128 v164, v[40:43] offset:0
    ds_write_b128 v164, v[44:47] offset:1024
    ds_write_b128 v164, v[48:51] offset:2048
    ds_write_b128 v164, v[52:55] offset:3072
    ds_write_b128 v164, v[56:59] offset:4096
    ds_write_b128 v164, v[60:63] offset:5120
    ds_write_b128 v164, v[64:67] offset:6144
    ds_write_b128 v164, v[68:71] offset:7168
    ds_write_b128 v164, v[72:75] offset:8192
    ds_write_b128 v164, v[76:79] offset:9216
    s_waitcnt lgkmcnt(0)
    s_barrier
    ds_read_b128 v[80:83], v165 offset:0
    ds_read_b128 v[84:87], v165 offset:1024
    ds_read_b128 v[88:91], v165 offset:2048
    ds_read_b128 v[92:95], v165 offset:3072
    ds_read_b128 v[96:99], v165 offset:4096
    ds_read_b128 v[100:103], v165 offset:5120
    ds_read_b128 v[104:107], v165 offset:6144
    ds_read_b128 v[108:111], v165 offset:7168
    ds_read_b128 v[112:115], v165 offset:8192
    ds_read_b128 v[116:119], v165 offset:9216
    s_waitcnt lgkmcnt(9)
    v_add_f32 v80, v0, v80
    v_add_f32 v81, v1, v81
    v_add_f32 v82, v2, v82
    v_add_f32 v83, v3, v83
    s_waitcnt lgkmcnt(8)
    v_add_f32 v84, v4, v84
    v_add_f32 v85, v5, v85
    v_add_f32 v86, v6, v86
    v_add_f32 v87, v7, v87
    s_waitcnt lgkmcnt(7)
    v_add_f32 v88, v8, v88
    v_add_f32 v89, v9, v89
    v_add_f32 v90, v10, v90
    v_add_f32 v91, v11, v91
    s_waitcnt lgkmcnt(6)
    v_add_f32 v92, v12, v92
    v_add_f32 v93, v13, v93
    v_add_f32 v94, v14, v94
    v_add_f32 v95, v15, v95
    s_waitcnt lgkmcnt(5)
    v_add_f32 v96, v16, v96
    v_add_f32 v97, v17, v97
    v_add_f32 v98, v18, v98
    v_add_f32 v99, v19, v99
    s_waitcnt lgkmcnt(4)
    v_add_f32 v100, v20, v100
    v_add_f32 v101, v21, v101
    v_add_f32 v102, v22, v102
    v_add_f32 v103, v23, v103
    s_waitcnt lgkmcnt(3)
    v_add_f32 v104, v24, v104
    v_add_f32 v105, v25, v105
    v_add_f32 v106, v26, v106
    v_add_f32 v107, v27, v107
    s_waitcnt lgkmcnt(2)
    v_add_f32 v108, v28, v108
    v_add_f32 v109, v29, v109
    v_add_f32 v110, v30, v110
    v_add_f32 v111, v31, v111
    s_waitcnt lgkmcnt(1)
    v_add_f32 v112, v32, v112
    v_add_f32 v113, v33, v113
    v_add_f32 v114, v34, v114
    v_add_f32 v115, v35, v115
    s_waitcnt lgkmcnt(0)
    v_add_f32 v116, v36, v116
    v_add_f32 v117, v37, v117
    v_add_f32 v118, v38, v118
    v_add_f32 v119, v39, v119
    s_branch L_p2_red2
L_p2_g1:
    ds_write_b128 v164, v[0:3] offset:0
    ds_write_b128 v164, v[4:7] offset:1024
    ds_write_b128 v164, v[8:11] offset:2048
    ds_write_b128 v164, v[12:15] offset:3072
    ds_write_b128 v164, v[16:19] offset:4096
    ds_write_b128 v164, v[20:23] offset:5120
    ds_write_b128 v164, v[24:27] offset:6144
    ds_write_b128 v164, v[28:31] offset:7168
    ds_write_b128 v164, v[32:35] offset:8192
    ds_write_b128 v164, v[36:39] offset:9216
    s_waitcnt lgkmcnt(0)
    s_barrier
    ds_read_b128 v[80:83], v165 offset:0
    ds_read_b128 v[84:87], v165 offset:1024
    ds_read_b128 v[88:91], v165 offset:2048
    ds_read_b128 v[92:95], v165 offset:3072
    ds_read_b128 v[96:99], v165 offset:4096
    ds_read_b128 v[100:103], v165 offset:5120
    ds_read_b128 v[104:107], v165 offset:6144
    ds_read_b128 v[108:111], v165 offset:7168
    ds_read_b128 v[112:115], v165 offset:8192
    ds_read_b128 v[116:119], v165 offset:9216
    s_waitcnt lgkmcnt(9)
    v_add_f32 v80, v40, v80
    v_add_f32 v81, v41, v81
    v_add_f32 v82, v42, v82
    v_add_f32 v83, v43, v83
    s_waitcnt lgkmcnt(8)
    v_add_f32 v84, v44, v84
    v_add_f32 v85, v45, v85
    v_add_f32 v86, v46, v86
    v_add_f32 v87, v47, v87
    s_waitcnt lgkmcnt(7)
    v_add_f32 v88, v48, v88
    v_add_f32 v89, v49, v89
    v_add_f32 v90, v50, v90
    v_add_f32 v91, v51, v91
    s_waitcnt lgkmcnt(6)
    v_add_f32 v92, v52, v92
    v_add_f32 v93, v53, v93
    v_add_f32 v94, v54, v94
    v_add_f32 v95, v55, v95
    s_waitcnt lgkmcnt(5)
    v_add_f32 v96, v56, v96
    v_add_f32 v97, v57, v97
    v_add_f32 v98, v58, v98
    v_add_f32 v99, v59, v99
    s_waitcnt lgkmcnt(4)
    v_add_f32 v100, v60, v100
    v_add_f32 v101, v61, v101
    v_add_f32 v102, v62, v102
    v_add_f32 v103, v63, v103
    s_waitcnt lgkmcnt(3)
    v_add_f32 v104, v64, v104
    v_add_f32 v105, v65, v105
    v_add_f32 v106, v66, v106
    v_add_f32 v107, v67, v107
    s_waitcnt lgkmcnt(2)
    v_add_f32 v108, v68, v108
    v_add_f32 v109, v69, v109
    v_add_f32 v110, v70, v110
    v_add_f32 v111, v71, v111
    s_waitcnt lgkmcnt(1)
    v_add_f32 v112, v72, v112
    v_add_f32 v113, v73, v113
    v_add_f32 v114, v74, v114
    v_add_f32 v115, v75, v115
    s_waitcnt lgkmcnt(0)
    v_add_f32 v116, v76, v116
    v_add_f32 v117, v77, v117
    v_add_f32 v118, v78, v118
    v_add_f32 v119, v79, v119
L_p2_red2:
    s_cmp_eq_u32 s81, s55
    s_cbranch_scc1 L_p2_own
    v_cvt_pk_bf16_f32 v0, v80, v81
    v_cvt_pk_bf16_f32 v1, v82, v83
    v_cvt_pk_bf16_f32 v2, v84, v85
    v_cvt_pk_bf16_f32 v3, v86, v87
    buffer_store_dwordx4 v[0:3], v248, s[36:39], s60 offen offset:0 sc1
    v_cvt_pk_bf16_f32 v4, v88, v89
    v_cvt_pk_bf16_f32 v5, v90, v91
    v_cvt_pk_bf16_f32 v6, v92, v93
    v_cvt_pk_bf16_f32 v7, v94, v95
    buffer_store_dwordx4 v[4:7], v248, s[36:39], s60 offen offset:1024 sc1
    v_cvt_pk_bf16_f32 v8, v96, v97
    v_cvt_pk_bf16_f32 v9, v98, v99
    v_cvt_pk_bf16_f32 v10, v100, v101
    v_cvt_pk_bf16_f32 v11, v102, v103
    buffer_store_dwordx4 v[8:11], v248, s[36:39], s60 offen offset:2048 sc1
    v_cvt_pk_bf16_f32 v12, v104, v105
    v_cvt_pk_bf16_f32 v13, v106, v107
    v_cvt_pk_bf16_f32 v14, v108, v109
    v_cvt_pk_bf16_f32 v15, v110, v111
    buffer_store_dwordx4 v[12:15], v248, s[36:39], s60 offen offset:3072 sc1
    v_cvt_pk_bf16_f32 v16, v112, v113
    v_cvt_pk_bf16_f32 v17, v114, v115
    v_cvt_pk_bf16_f32 v18, v116, v117
    v_cvt_pk_bf16_f32 v19, v118, v119
    buffer_store_dwordx4 v[16:19], v248, s[36:39], s62 offen offset:0 sc1
    s_branch L_p2_pub
L_p2_own:
    ds_write_b128 v165, v[80:83] offset:0
    ds_write_b128 v165, v[84:87] offset:1024
    ds_write_b128 v165, v[88:91] offset:2048
    ds_write_b128 v165, v[92:95] offset:3072
    ds_write_b128 v165, v[96:99] offset:4096
    ds_write_b128 v165, v[100:103] offset:5120
    ds_write_b128 v165, v[104:107] offset:6144
    ds_write_b128 v165, v[108:111] offset:7168
    ds_write_b128 v165, v[112:115] offset:8192
    ds_write_b128 v165, v[116:119] offset:9216
L_p2_pub:
    ds_write_b128 v166, v[176:179] offset:0
    ds_write_b128 v166, v[180:183] offset:1024
    ds_write_b128 v166, v[184:187] offset:2048
    ds_write_b128 v166, v[188:191] offset:3072
    ds_write_b128 v166, v[192:195] offset:4096
    ds_write_b128 v166, v[196:199] offset:5120
    ds_write_b128 v166, v[200:203] offset:6144
    ds_write_b128 v166, v[204:207] offset:7168
    ds_write_b128 v166, v[208:211] offset:8192
    ds_write_b128 v166, v[212:215] offset:9216
    s_lshl_b32 s98, s56, 1
    s_lshr_b32 s97, s55, 1
    s_add_u32 s98, s98, s97
    s_mul_i32 s98, s98, 81920
    s_mul_i32 s97, s57, 320
    s_add_u32 s98, s98, s97
    s_and_b32 s97, s55, 1
    s_mul_i32 s97, s97, 160
    s_add_u32 s98, s98, s97
    s_add_u32 s40, s4, s98
    s_addc_u32 s41, s5, 0
    s_and_b32 s41, s41, 0xffff
    s_mov_b32 s42, 0
    s_mov_b32 s43, 0x20000
    s_sub_u32 s42, 2621440, s98
    s_add_u32 s44, s22, s98
    s_addc_u32 s45, s23, 0
    s_and_b32 s45, s45, 0xffff
    s_mov_b32 s46, 0
    s_mov_b32 s47, 0x20000
    s_sub_u32 s46, 2621440, s98
    v_bfe_u32 v170, v248, 4, 4
    v_mul_u32_u24 v170, 1280, v170
    v_lshrrev_b32 v168, 8, v248
    v_lshl_add_u32 v170, v168, 3, v170
    v_add_u32 v171, 20480, v170
    s_and_b32 s97, s55, 1
    s_xor_b32 s97, s97, 1
    s_lshl_b32 s97, s97, 2
    s_and_b32 s98, s55, 2
    s_add_u32 s97, s97, s98
    s_mul_i32 s63, s97, 10240
    s_add_u32 s97, s52, 0
    s_min_u32 s98, s97, 9
    s_lshl_b32 s81, s98, 11
    s_add_u32 s80, s81, 81920
    v_add_u32 v172, s80, v248
    s_add_u32 s80, s81, s63
    v_add_u32 v174, s80, v248
    s_lshl_b32 s78, s98, 5
    s_cmp_ge_u32 s98, 5
    s_cselect_b32 s81, 40800, 0
    s_add_u32 s78, s78, s81
    s_mul_i32 s81, s55, 10240
    s_lshl_b32 s64, s98, 10
    s_add_u32 s64, s64, s81
    s_cmp_ge_u32 s97, 10
    s_cselect_b32 s78, 0x1000000, s78
    s_cselect_b32 s64, 0x4000000, s64
    s_add_u32 s97, s52, 8
    s_min_u32 s98, s97, 9
    s_lshl_b32 s81, s98, 11
    s_add_u32 s80, s81, 81920
    v_add_u32 v173, s80, v248
    s_add_u32 s80, s81, s63
    v_add_u32 v175, s80, v248
    s_lshl_b32 s79, s98, 5
    s_cmp_ge_u32 s98, 5
    s_cselect_b32 s81, 40800, 0
    s_add_u32 s79, s79, s81
    s_mul_i32 s81, s55, 10240
    s_lshl_b32 s65, s98, 10
    s_add_u32 s65, s65, s81
    s_cmp_ge_u32 s97, 10
    s_cselect_b32 s79, 0x1000000, s79
    s_cselect_b32 s65, 0x4000000, s65
    s_waitcnt vmcnt(0) lgkmcnt(0)
    s_barrier
    v_mov_b32 v221, 0
    s_cmp_eq_u32 s52, 0
    s_cbranch_scc1 L_ps_sig
L_ps_sigr:
    buffer_load_dwordx2 v[120:121], v170, s[40:43], s78 offen
    buffer_load_dwordx2 v[122:123], v171, s[40:43], s78 offen
    buffer_load_dwordx2 v[124:125], v170, s[40:43], s79 offen
    buffer_load_dwordx2 v[126:127], v171, s[40:43], s79 offen
    ds_read_b128 v[0:3], v172 offset:0
    ds_read_b128 v[4:7], v172 offset:1024
    ds_read_b128 v[8:11], v172 offset:20480
    ds_read_b128 v[12:15], v172 offset:21504
    ds_read_b128 v[16:19], v172 offset:40960
    ds_read_b128 v[20:23], v172 offset:41984
    ds_read_b128 v[24:27], v172 offset:61440
    ds_read_b128 v[28:31], v172 offset:62464
    s_waitcnt lgkmcnt(0)
    ds_read_b128 v[64:67], v174 offset:0
    ds_read_b128 v[68:71], v174 offset:1024
    ds_read_b128 v[32:35], v173 offset:0
    ds_read_b128 v[36:39], v173 offset:1024
    ds_read_b128 v[40:43], v173 offset:20480
    ds_read_b128 v[44:47], v173 offset:21504
    ds_read_b128 v[48:51], v173 offset:40960
    ds_read_b128 v[52:55], v173 offset:41984
    ds_read_b128 v[56:59], v173 offset:61440
    ds_read_b128 v[60:63], v173 offset:62464
    s_waitcnt lgkmcnt(0)
    ds_read_b128 v[72:75], v175 offset:0
    ds_read_b128 v[76:79], v175 offset:1024
    buffer_load_dword v223, v221, s[88:91], s66 offen sc1
    v_add_f32 v0, v0, v8
    v_add_f32 v1, v1, v9
    v_add_f32 v2, v2, v10
    v_add_f32 v3, v3, v11
    v_add_f32 v4, v4, v12
    v_add_f32 v5, v5, v13
    v_add_f32 v6, v6, v14
    v_add_f32 v7, v7, v15
    v_add_f32 v16, v16, v24
    v_add_f32 v17, v17, v25
    v_add_f32 v18, v18, v26
    v_add_f32 v19, v19, v27
    v_add_f32 v20, v20, v28
    v_add_f32 v21, v21, v29
    v_add_f32 v22, v22, v30
    v_add_f32 v23, v23, v31
    v_add_f32 v0, v0, v16
    v_add_f32 v1, v1, v17
    v_add_f32 v2, v2, v18
    v_add_f32 v3, v3, v19
    v_add_f32 v4, v4, v20
    v_add_f32 v5, v5, v21
    v_add_f32 v6, v6, v22
    v_add_f32 v7, v7, v23
    v_mul_f32 v8, 0xbfb8aa3b, v0
    v_mul_f32 v9, 0xbfb8aa3b, v1
    v_mul_f32 v10, 0xbfb8aa3b, v2
    v_mul_f32 v11, 0xbfb8aa3b, v3
    v_mul_f32 v12, 0xbfb8aa3b, v4
    v_mul_f32 v13, 0xbfb8aa3b, v5
    v_mul_f32 v14, 0xbfb8aa3b, v6
    v_mul_f32 v15, 0xbfb8aa3b, v7
    v_exp_f32 v8, v8
    v_exp_f32 v9, v9
    v_exp_f32 v10, v10
    v_exp_f32 v11, v11
    v_exp_f32 v12, v12
    v_exp_f32 v13, v13
    v_exp_f32 v14, v14
    v_exp_f32 v15, v15
    v_add_f32 v8, 1.0, v8
    v_add_f32 v9, 1.0, v9
    v_add_f32 v10, 1.0, v10
    v_add_f32 v11, 1.0, v11
    v_add_f32 v12, 1.0, v12
    v_add_f32 v13, 1.0, v13
    v_add_f32 v14, 1.0, v14
    v_add_f32 v15, 1.0, v15
    v_rcp_f32 v8, v8
    v_rcp_f32 v9, v9
    v_rcp_f32 v10, v10
    v_rcp_f32 v11, v11
    v_rcp_f32 v12, v12
    v_rcp_f32 v13, v13
    v_rcp_f32 v14, v14
    v_rcp_f32 v15, v15
    v_mul_f32 v0, v0, v8
    v_mul_f32 v1, v1, v9
    v_mul_f32 v2, v2, v10
    v_mul_f32 v3, v3, v11
    v_mul_f32 v4, v4, v12
    v_mul_f32 v5, v5, v13
    v_mul_f32 v6, v6, v14
    v_mul_f32 v7, v7, v15
    v_add_f32 v32, v32, v40
    v_add_f32 v33, v33, v41
    v_add_f32 v34, v34, v42
    v_add_f32 v35, v35, v43
    v_add_f32 v36, v36, v44
    v_add_f32 v37, v37, v45
    v_add_f32 v38, v38, v46
    v_add_f32 v39, v39, v47
    v_add_f32 v48, v48, v56
    v_add_f32 v49, v49, v57
    v_add_f32 v50, v50, v58
    v_add_f32 v51, v51, v59
    v_add_f32 v52, v52, v60
    v_add_f32 v53, v53, v61
    v_add_f32 v54, v54, v62
    v_add_f32 v55, v55, v63
    v_add_f32 v32, v32, v48
    v_add_f32 v33, v33, v49
    v_add_f32 v34, v34, v50
    v_add_f32 v35, v35, v51
    v_add_f32 v36, v36, v52
    v_add_f32 v37, v37, v53
    v_add_f32 v38, v38, v54
    v_add_f32 v39, v39, v55
    v_mul_f32 v40, 0xbfb8aa3b, v32
    v_mul_f32 v41, 0xbfb8aa3b, v33
    v_mul_f32 v42, 0xbfb8aa3b, v34
    v_mul_f32 v43, 0xbfb8aa3b, v35
    v_mul_f32 v44, 0xbfb8aa3b, v36
    v_mul_f32 v45, 0xbfb8aa3b, v37
    v_mul_f32 v46, 0xbfb8aa3b, v38
    v_mul_f32 v47, 0xbfb8aa3b, v39
    v_exp_f32 v40, v40
    v_exp_f32 v41, v41
    v_exp_f32 v42, v42
    v_exp_f32 v43, v43
    v_exp_f32 v44, v44
    v_exp_f32 v45, v45
    v_exp_f32 v46, v46
    v_exp_f32 v47, v47
    v_add_f32 v40, 1.0, v40
    v_add_f32 v41, 1.0, v41
    v_add_f32 v42, 1.0, v42
    v_add_f32 v43, 1.0, v43
    v_add_f32 v44, 1.0, v44
    v_add_f32 v45, 1.0, v45
    v_add_f32 v46, 1.0, v46
    v_add_f32 v47, 1.0, v47
    v_rcp_f32 v40, v40
    v_rcp_f32 v41, v41
    v_rcp_f32 v42, v42
    v_rcp_f32 v43, v43
    v_rcp_f32 v44, v44
    v_rcp_f32 v45, v45
    v_rcp_f32 v46, v46
    v_rcp_f32 v47, v47
    v_mul_f32 v32, v32, v40
    v_mul_f32 v33, v33, v41
    v_mul_f32 v34, v34, v42
    v_mul_f32 v35, v35, v43
    v_mul_f32 v36, v36, v44
    v_mul_f32 v37, v37, v45
    v_mul_f32 v38, v38, v46
    v_mul_f32 v39, v39, v47
    s_waitcnt lgkmcnt(0)
    s_waitcnt vmcnt(0)
    v_readfirstlane_b32 s98, v223
    s_nop 3
    s_cmp_ge_u32 s98, 4
    s_cbranch_scc0 L_pp_spin
L_pp_ok:
    s_add_u32 s97, s55, 1
    s_and_b32 s97, s97, 3
    s_mul_i32 s97, s97, 2621440
    s_add_u32 s97, s97, s64
    buffer_load_dwordx4 v[80:83], v248, s[36:39], s97 offen sc1
    s_add_u32 s97, s55, 2
    s_and_b32 s97, s97, 3
    s_mul_i32 s97, s97, 2621440
    s_add_u32 s97, s97, s64
    buffer_load_dwordx4 v[84:87], v248, s[36:39], s97 offen sc1
    s_add_u32 s97, s55, 3
    s_and_b32 s97, s97, 3
    s_mul_i32 s97, s97, 2621440
    s_add_u32 s97, s97, s64
    buffer_load_dwordx4 v[88:91], v248, s[36:39], s97 offen sc1
    s_add_u32 s97, s55, 1
    s_and_b32 s97, s97, 3
    s_mul_i32 s97, s97, 2621440
    s_add_u32 s97, s97, s65
    buffer_load_dwordx4 v[92:95], v248, s[36:39], s97 offen sc1
    s_add_u32 s97, s55, 2
    s_and_b32 s97, s97, 3
    s_mul_i32 s97, s97, 2621440
    s_add_u32 s97, s97, s65
    buffer_load_dwordx4 v[96:99], v248, s[36:39], s97 offen sc1
    s_add_u32 s97, s55, 3
    s_and_b32 s97, s97, 3
    s_mul_i32 s97, s97, 2621440
    s_add_u32 s97, s97, s65
    buffer_load_dwordx4 v[100:103], v248, s[36:39], s97 offen sc1
    v_lshlrev_b32 v8, 16, v120
    v_and_b32 v9, 0xffff0000, v120
    v_lshlrev_b32 v10, 16, v121
    v_and_b32 v11, 0xffff0000, v121
    v_lshlrev_b32 v12, 16, v122
    v_and_b32 v13, 0xffff0000, v122
    v_lshlrev_b32 v14, 16, v123
    v_and_b32 v15, 0xffff0000, v123
    s_waitcnt vmcnt(5)
    v_lshlrev_b32 v16, 16, v80
    v_and_b32 v17, 0xffff0000, v80
    v_lshlrev_b32 v18, 16, v81
    v_and_b32 v19, 0xffff0000, v81
    v_lshlrev_b32 v20, 16, v82
    v_and_b32 v21, 0xffff0000, v82
    v_lshlrev_b32 v22, 16, v83
    v_and_b32 v23, 0xffff0000, v83
    v_add_f32 v64, v64, v16
    v_add_f32 v65, v65, v17
    v_add_f32 v66, v66, v18
    v_add_f32 v67, v67, v19
    v_add_f32 v68, v68, v20
    v_add_f32 v69, v69, v21
    v_add_f32 v70, v70, v22
    v_add_f32 v71, v71, v23
    s_waitcnt vmcnt(4)
    v_lshlrev_b32 v16, 16, v84
    v_and_b32 v17, 0xffff0000, v84
    v_lshlrev_b32 v18, 16, v85
    v_and_b32 v19, 0xffff0000, v85
    v_lshlrev_b32 v20, 16, v86
    v_and_b32 v21, 0xffff0000, v86
    v_lshlrev_b32 v22, 16, v87
    v_and_b32 v23, 0xffff0000, v87
    v_add_f32 v64, v64, v16
    v_add_f32 v65, v65, v17
    v_add_f32 v66, v66, v18
    v_add_f32 v67, v67, v19
    v_add_f32 v68, v68, v20
    v_add_f32 v69, v69, v21
    v_add_f32 v70, v70, v22
    v_add_f32 v71, v71, v23
    s_waitcnt vmcnt(3)
    v_lshlrev_b32 v16, 16, v88
    v_and_b32 v17, 0xffff0000, v88
    v_lshlrev_b32 v18, 16, v89
    v_and_b32 v19, 0xffff0000, v89
    v_lshlrev_b32 v20, 16, v90
    v_and_b32 v21, 0xffff0000, v90
    v_lshlrev_b32 v22, 16, v91
    v_and_b32 v23, 0xffff0000, v91
    v_add_f32 v64, v64, v16
    v_add_f32 v65, v65, v17
    v_add_f32 v66, v66, v18
    v_add_f32 v67, v67, v19
    v_add_f32 v68, v68, v20
    v_add_f32 v69, v69, v21
    v_add_f32 v70, v70, v22
    v_add_f32 v71, v71, v23
    v_fma_f32 v8, v64, v0, v8
    v_fma_f32 v9, v65, v1, v9
    v_fma_f32 v10, v66, v2, v10
    v_fma_f32 v11, v67, v3, v11
    v_fma_f32 v12, v68, v4, v12
    v_fma_f32 v13, v69, v5, v13
    v_fma_f32 v14, v70, v6, v14
    v_fma_f32 v15, v71, v7, v15
    v_cvt_pk_bf16_f32 v120, v8, v9
    v_cvt_pk_bf16_f32 v121, v10, v11
    v_cvt_pk_bf16_f32 v122, v12, v13
    v_cvt_pk_bf16_f32 v123, v14, v15
    buffer_store_dwordx2 v[120:121], v170, s[44:47], s78 offen
    buffer_store_dwordx2 v[122:123], v171, s[44:47], s78 offen
    v_lshlrev_b32 v40, 16, v124
    v_and_b32 v41, 0xffff0000, v124
    v_lshlrev_b32 v42, 16, v125
    v_and_b32 v43, 0xffff0000, v125
    v_lshlrev_b32 v44, 16, v126
    v_and_b32 v45, 0xffff0000, v126
    v_lshlrev_b32 v46, 16, v127
    v_and_b32 v47, 0xffff0000, v127
    s_waitcnt vmcnt(4)
    v_lshlrev_b32 v48, 16, v92
    v_and_b32 v49, 0xffff0000, v92
    v_lshlrev_b32 v50, 16, v93
    v_and_b32 v51, 0xffff0000, v93
    v_lshlrev_b32 v52, 16, v94
    v_and_b32 v53, 0xffff0000, v94
    v_lshlrev_b32 v54, 16, v95
    v_and_b32 v55, 0xffff0000, v95
    v_add_f32 v72, v72, v48
    v_add_f32 v73, v73, v49
    v_add_f32 v74, v74, v50
    v_add_f32 v75, v75, v51
    v_add_f32 v76, v76, v52
    v_add_f32 v77, v77, v53
    v_add_f32 v78, v78, v54
    v_add_f32 v79, v79, v55
    s_waitcnt vmcnt(3)
    v_lshlrev_b32 v48, 16, v96
    v_and_b32 v49, 0xffff0000, v96
    v_lshlrev_b32 v50, 16, v97
    v_and_b32 v51, 0xffff0000, v97
    v_lshlrev_b32 v52, 16, v98
    v_and_b32 v53, 0xffff0000, v98
    v_lshlrev_b32 v54, 16, v99
    v_and_b32 v55, 0xffff0000, v99
    v_add_f32 v72, v72, v48
    v_add_f32 v73, v73, v49
    v_add_f32 v74, v74, v50
    v_add_f32 v75, v75, v51
    v_add_f32 v76, v76, v52
    v_add_f32 v77, v77, v53
    v_add_f32 v78, v78, v54
    v_add_f32 v79, v79, v55
    s_waitcnt vmcnt(2)
    v_lshlrev_b32 v48, 16, v100
    v_and_b32 v49, 0xffff0000, v100
    v_lshlrev_b32 v50, 16, v101
    v_and_b32 v51, 0xffff0000, v101
    v_lshlrev_b32 v52, 16, v102
    v_and_b32 v53, 0xffff0000, v102
    v_lshlrev_b32 v54, 16, v103
    v_and_b32 v55, 0xffff0000, v103
    v_add_f32 v72, v72, v48
    v_add_f32 v73, v73, v49
    v_add_f32 v74, v74, v50
    v_add_f32 v75, v75, v51
    v_add_f32 v76, v76, v52
    v_add_f32 v77, v77, v53
    v_add_f32 v78, v78, v54
    v_add_f32 v79, v79, v55
    v_fma_f32 v40, v72, v32, v40
    v_fma_f32 v41, v73, v33, v41
    v_fma_f32 v42, v74, v34, v42
    v_fma_f32 v43, v75, v35, v43
    v_fma_f32 v44, v76, v36, v44
    v_fma_f32 v45, v77, v37, v45
    v_fma_f32 v46, v78, v38, v46
    v_fma_f32 v47, v79, v39, v47
    v_cvt_pk_bf16_f32 v124, v40, v41
    v_cvt_pk_bf16_f32 v125, v42, v43
    v_cvt_pk_bf16_f32 v126, v44, v45
    v_cvt_pk_bf16_f32 v127, v46, v47
    buffer_store_dwordx2 v[124:125], v170, s[44:47], s79 offen
    buffer_store_dwordx2 v[126:127], v171, s[44:47], s79 offen
L_k1_done:
    s_endpgm
L_xs_sig:
    v_lshrrev_b32 v42, 4, v248
    s_lshl_b32 s97, s54, 5
    s_lshl_b32 s97, s97, 7
    s_add_u32 s97, s97, 16384
    v_lshlrev_b32 v42, 7, v42
    v_mov_b32 v41, 1
    s_mov_b64 exec, 0xffffffff
    buffer_store_dword v41, v42, s[88:91], s97 offen offset:0 sc1
    s_mov_b64 exec, -1
    s_branch L_xs_sigr
L_px_spin:
    s_mov_b32 s97, 0
    v_mov_b32 v43, 0
    s_mov_b64 exec, 1
L_px_poll:
    buffer_load_dword v42, v43, s[88:91], s99 offen offset:0 sc1
    s_add_u32 s97, s97, 1
    s_waitcnt vmcnt(0)
    v_cmp_ne_u32 vcc, 1, v42
    s_cbranch_vccz L_px_done
    s_sleep 2
    s_cmp_lt_u32 s97, 0x20000
    s_cbranch_scc1 L_px_poll
L_px_done:
    s_mov_b64 exec, -1
    s_mul_i32 s56, s55, 786432
    s_mul_i32 s57, s55, 196608
    s_add_u32 m0, s69, 0
    s_add_u32 s58, s57, 24576
    buffer_load_dwordx4 v244, s[32:35], s56 offen lds
    s_add_u32 m0, s69, 1024
    s_add_u32 s55, s55, 1
    buffer_load_dwordx4 v245, s[32:35], s56 offen lds
    s_add_u32 m0, s69, 2048
    s_cmp_eq_u32 s55, 10
    buffer_load_dwordx4 v246, s[32:35], s56 offen lds
    s_cselect_b32 s55, 1, s55
    s_add_u32 m0, s59, 0
    s_mov_b64 exec, s[62:63]
    buffer_load_dwordx4 v243, s[36:39], s57 offen lds
    s_mov_b64 exec, -1
    s_add_u32 m0, s59, 1664
    s_mov_b64 exec, s[62:63]
    buffer_load_dwordx4 v243, s[36:39], s58 offen lds
    s_mov_b64 exec, -1
    s_branch L_px_ok
L_k1_tr0_1:
    s_call_b64 s[76:77], L_k1_slow1
    s_branch L_k1_back0_1
L_k1_tr1_0:
    s_call_b64 s[76:77], L_k1_slow0
    s_branch L_k1_back1_0
L_k1_tr1_1:
    s_call_b64 s[76:77], L_k1_slow1
    s_branch L_k1_back1_1
L_k1_tr2_0:
    s_call_b64 s[76:77], L_k1_slow0
    s_branch L_k1_back2_0
L_k1_tr2_1:
    s_call_b64 s[76:77], L_k1_slow1
    s_branch L_k1_back2_1
L_k1_tr3_0:
    s_call_b64 s[76:77], L_k1_slow0
    s_branch L_k1_back3_0
L_k1_tr3_1:
    s_call_b64 s[76:77], L_k1_slow1
    s_branch L_k1_back3_1
L_k1_tr4_0:
    s_call_b64 s[76:77], L_k1_slow0
    s_branch L_k1_back4_0
L_k1_tr4_1:
    s_call_b64 s[76:77], L_k1_slow1
    s_branch L_k1_back4_1
L_k1_tr5_0:
    s_call_b64 s[76:77], L_k1_slow0
    s_branch L_k1_back5_0
L_k1_tr5_1:
    s_call_b64 s[76:77], L_k1_slow1
    s_branch L_k1_back5_1
L_k1_tr6_0:
    s_call_b64 s[76:77], L_k1_slow0
    s_branch L_k1_back6_0
L_k1_tr6_1:
    s_call_b64 s[76:77], L_k1_slow1
    s_branch L_k1_back6_1
L_k1_tr7_0:
    s_call_b64 s[76:77], L_k1_slow0
    s_branch L_k1_back7_0
L_k1_tr7_1:
    s_call_b64 s[76:77], L_k1_slow1
    s_branch L_k1_back7_1
L_ph_spin:
    s_mov_b32 s97, 0
    s_mov_b64 exec, 0xff
L_ph_poll:
    s_sleep 16
    buffer_load_dword v246, v244, s[92:95], 0 offen offset:4 sc1
    s_add_u32 s97, s97, 1
    s_waitcnt vmcnt(0)
    v_add_u32 v246, -1, v246
    v_and_b32 v246, 0x8000001f, v246
    v_cmp_ne_u32 vcc, 31, v246
    s_cbranch_vccz L_ph_done
    s_cmp_lt_u32 s97, 0x20000
    s_cbranch_scc1 L_ph_poll
L_ph_done:
    s_mov_b64 exec, -1
    s_branch L_ph_ok
L_po_spin:
    s_mov_b32 s97, 0
    s_mov_b64 exec, 0xff
L_po_poll:
    buffer_load_dword v223, v221, s[88:91], s101 offen offset:32 sc1
    s_add_u32 s97, s97, 1
    s_waitcnt vmcnt(0)
    v_cmp_ne_u32 vcc, 1, v223
    s_cbranch_vccz L_po_done
    s_sleep 1
    s_cmp_lt_u32 s97, 0x20000
    s_cbranch_scc1 L_po_poll
L_po_done:
    s_mov_b64 exec, -1
    s_branch L_po_ok
L_ps_sig:
    s_mov_b32 s97, s66
    v_mov_b32 v221, 0
    v_mov_b32 v222, 1
    s_mov_b64 exec, 1
    buffer_atomic_add v222, v221, s[88:91], s97 offen sc1
    s_mov_b64 exec, -1
    s_branch L_ps_sigr
L_pp_spin:
    s_mov_b32 s97, 0
L_pp_poll:
    s_sleep 8
    buffer_load_dword v223, v221, s[88:91], s66 offen sc1
    s_waitcnt vmcnt(0)
    v_readfirstlane_b32 s98, v223
    s_add_u32 s97, s97, 1
    s_nop 1
    s_cmp_ge_u32 s98, 4
    s_cbranch_scc1 L_pp_ok
    s_cmp_lt_u32 s97, 0x20000
    s_cbranch_scc1 L_pp_poll
    s_branch L_pp_ok
L_k1_slow0:
    s_nop 15
    v_max3_f32 v230, v144, v145, v146
    v_max3_f32 v230, v230, v147, v152
    v_max3_f32 v230, v230, v153, v154
    v_max_f32 v230, v230, v155
    v_max3_f32 v231, v148, v149, v150
    v_max3_f32 v231, v231, v151, v156
    v_max3_f32 v231, v231, v157, v158
    v_max_f32 v231, v231, v159
    v_mov_b32 v234, v230
    v_mov_b32 v235, v231
    s_nop 1
    v_permlane32_swap_b32 v230, v234
    v_permlane32_swap_b32 v231, v235
    v_max_f32 v230, v230, v234
    v_max_f32 v231, v231, v235
    v_mov_b32 v234, v230
    v_mov_b32 v235, v231
    s_nop 1
    v_permlane16_swap_b32 v230, v234
    v_permlane16_swap_b32 v231, v235
    v_max_f32 v230, v230, v234
    v_max_f32 v231, v231, v235
    v_max_f32 v230, 0, v230
    v_exp_f32 v232, -v230
    v_max_f32 v231, 0, v231
    v_exp_f32 v233, -v231
    v_sub_f32 v208, v208, v230
    v_sub_f32 v209, v209, v230
    v_sub_f32 v210, v210, v230
    v_sub_f32 v211, v211, v230
    v_sub_f32 v144, v144, v230
    v_sub_f32 v145, v145, v230
    v_sub_f32 v146, v146, v230
    v_sub_f32 v147, v147, v230
    v_sub_f32 v152, v152, v230
    v_sub_f32 v153, v153, v230
    v_sub_f32 v154, v154, v230
    v_sub_f32 v155, v155, v230
    v_sub_f32 v160, v160, v230
    v_sub_f32 v161, v161, v230
    v_sub_f32 v162, v162, v230
    v_sub_f32 v163, v163, v230
    v_sub_f32 v168, v168, v230
    v_sub_f32 v169, v169, v230
    v_sub_f32 v170, v170, v230
    v_sub_f32 v171, v171, v230
    v_mul_f32 v228, v228, v232
    v_mul_f32 v0, v0, v232
    v_mul_f32 v1, v1, v232
    v_mul_f32 v2, v2, v232
    v_mul_f32 v3, v3, v232
    v_mul_f32 v8, v8, v232
    v_mul_f32 v9, v9, v232
    v_mul_f32 v10, v10, v232
    v_mul_f32 v11, v11, v232
    v_mul_f32 v16, v16, v232
    v_mul_f32 v17, v17, v232
    v_mul_f32 v18, v18, v232
    v_mul_f32 v19, v19, v232
    v_mul_f32 v24, v24, v232
    v_mul_f32 v25, v25, v232
    v_mul_f32 v26, v26, v232
    v_mul_f32 v27, v27, v232
    v_mul_f32 v32, v32, v232
    v_mul_f32 v33, v33, v232
    v_mul_f32 v34, v34, v232
    v_mul_f32 v35, v35, v232
    v_mul_f32 v40, v40, v232
    v_mul_f32 v41, v41, v232
    v_mul_f32 v42, v42, v232
    v_mul_f32 v43, v43, v232
    v_mul_f32 v48, v48, v232
    v_mul_f32 v49, v49, v232
    v_mul_f32 v50, v50, v232
    v_mul_f32 v51, v51, v232
    v_mul_f32 v56, v56, v232
    v_mul_f32 v57, v57, v232
    v_mul_f32 v58, v58, v232
    v_mul_f32 v59, v59, v232
    v_mul_f32 v64, v64, v232
    v_mul_f32 v65, v65, v232
    v_mul_f32 v66, v66, v232
    v_mul_f32 v67, v67, v232
    v_mul_f32 v72, v72, v232
    v_mul_f32 v73, v73, v232
    v_mul_f32 v74, v74, v232
    v_mul_f32 v75, v75, v232
    v_mul_f32 v80, v80, v232
    v_mul_f32 v81, v81, v232
    v_mul_f32 v82, v82, v232
    v_mul_f32 v83, v83, v232
    v_mul_f32 v88, v88, v232
    v_mul_f32 v89, v89, v232
    v_mul_f32 v90, v90, v232
    v_mul_f32 v91, v91, v232
    v_sub_f32 v212, v212, v231
    v_sub_f32 v213, v213, v231
    v_sub_f32 v214, v214, v231
    v_sub_f32 v215, v215, v231
    v_sub_f32 v148, v148, v231
    v_sub_f32 v149, v149, v231
    v_sub_f32 v150, v150, v231
    v_sub_f32 v151, v151, v231
    v_sub_f32 v156, v156, v231
    v_sub_f32 v157, v157, v231
    v_sub_f32 v158, v158, v231
    v_sub_f32 v159, v159, v231
    v_sub_f32 v164, v164, v231
    v_sub_f32 v165, v165, v231
    v_sub_f32 v166, v166, v231
    v_sub_f32 v167, v167, v231
    v_sub_f32 v172, v172, v231
    v_sub_f32 v173, v173, v231
    v_sub_f32 v174, v174, v231
    v_sub_f32 v175, v175, v231
    v_mul_f32 v229, v229, v233
    v_mul_f32 v4, v4, v233
    v_mul_f32 v5, v5, v233
    v_mul_f32 v6, v6, v233
    v_mul_f32 v7, v7, v233
    v_mul_f32 v12, v12, v233
    v_mul_f32 v13, v13, v233
    v_mul_f32 v14, v14, v233
    v_mul_f32 v15, v15, v233
    v_mul_f32 v20, v20, v233
    v_mul_f32 v21, v21, v233
    v_mul_f32 v22, v22, v233
    v_mul_f32 v23, v23, v233
    v_mul_f32 v28, v28, v233
    v_mul_f32 v29, v29, v233
    v_mul_f32 v30, v30, v233
    v_mul_f32 v31, v31, v233
    v_mul_f32 v36, v36, v233
    v_mul_f32 v37, v37, v233
    v_mul_f32 v38, v38, v233
    v_mul_f32 v39, v39, v233
    v_mul_f32 v44, v44, v233
    v_mul_f32 v45, v45, v233
    v_mul_f32 v46, v46, v233
    v_mul_f32 v47, v47, v233
    v_mul_f32 v52, v52, v233
    v_mul_f32 v53, v53, v233
    v_mul_f32 v54, v54, v233
    v_mul_f32 v55, v55, v233
    v_mul_f32 v60, v60, v233
    v_mul_f32 v61, v61, v233
    v_mul_f32 v62, v62, v233
    v_mul_f32 v63, v63, v233
    v_mul_f32 v68, v68, v233
    v_mul_f32 v69, v69, v233
    v_mul_f32 v70, v70, v233
    v_mul_f32 v71, v71, v233
    v_mul_f32 v76, v76, v233
    v_mul_f32 v77, v77, v233
    v_mul_f32 v78, v78, v233
    v_mul_f32 v79, v79, v233
    v_mul_f32 v84, v84, v233
    v_mul_f32 v85, v85, v233
    v_mul_f32 v86, v86, v233
    v_mul_f32 v87, v87, v233
    v_mul_f32 v92, v92, v233
    v_mul_f32 v93, v93, v233
    v_mul_f32 v94, v94, v233
    v_mul_f32 v95, v95, v233
    v_exp_f32 v230, v144
    v_exp_f32 v231, v145
    v_exp_f32 v232, v146
    v_exp_f32 v233, v147
    v_exp_f32 v234, v148
    v_cvt_pk_bf16_f32 v192, v230, v231
    v_exp_f32 v235, v149
    v_cvt_pk_bf16_f32 v193, v232, v233
    v_exp_f32 v236, v150
    v_exp_f32 v237, v151
    v_cvt_pk_bf16_f32 v200, v234, v235
    v_cvt_pk_bf16_f32 v201, v236, v237
    v_exp_f32 v230, v152
    v_exp_f32 v231, v153
    v_exp_f32 v232, v154
    v_exp_f32 v233, v155
    v_exp_f32 v234, v156
    v_cvt_pk_bf16_f32 v194, v230, v231
    v_exp_f32 v235, v157
    v_cvt_pk_bf16_f32 v195, v232, v233
    v_exp_f32 v236, v158
    v_exp_f32 v237, v159
    v_cvt_pk_bf16_f32 v202, v234, v235
    v_cvt_pk_bf16_f32 v203, v236, v237
    s_nop 1
    v_mfma_f32_16x16x32_bf16 v[216:219], v[224:227], v[192:195], 0
    v_mfma_f32_16x16x32_bf16 v[220:223], v[224:227], v[200:203], 0
    s_nop 7
    s_setpc_b64 s[76:77]
L_k1_slow1:
    s_nop 15
    v_max3_f32 v230, v160, v161, v162
    v_max3_f32 v230, v230, v163, v168
    v_max3_f32 v230, v230, v169, v170
    v_max_f32 v230, v230, v171
    v_max3_f32 v231, v164, v165, v166
    v_max3_f32 v231, v231, v167, v172
    v_max3_f32 v231, v231, v173, v174
    v_max_f32 v231, v231, v175
    v_mov_b32 v234, v230
    v_mov_b32 v235, v231
    s_nop 1
    v_permlane32_swap_b32 v230, v234
    v_permlane32_swap_b32 v231, v235
    v_max_f32 v230, v230, v234
    v_max_f32 v231, v231, v235
    v_mov_b32 v234, v230
    v_mov_b32 v235, v231
    s_nop 1
    v_permlane16_swap_b32 v230, v234
    v_permlane16_swap_b32 v231, v235
    v_max_f32 v230, v230, v234
    v_max_f32 v231, v231, v235
    v_max_f32 v230, 0, v230
    v_exp_f32 v232, -v230
    v_max_f32 v231, 0, v231
    v_exp_f32 v233, -v231
    v_sub_f32 v208, v208, v230
    v_sub_f32 v209, v209, v230
    v_sub_f32 v210, v210, v230
    v_sub_f32 v211, v211, v230
    v_sub_f32 v144, v144, v230
    v_sub_f32 v145, v145, v230
    v_sub_f32 v146, v146, v230
    v_sub_f32 v147, v147, v230
    v_sub_f32 v152, v152, v230
    v_sub_f32 v153, v153, v230
    v_sub_f32 v154, v154, v230
    v_sub_f32 v155, v155, v230
    v_sub_f32 v160, v160, v230
    v_sub_f32 v161, v161, v230
    v_sub_f32 v162, v162, v230
    v_sub_f32 v163, v163, v230
    v_sub_f32 v168, v168, v230
    v_sub_f32 v169, v169, v230
    v_sub_f32 v170, v170, v230
    v_sub_f32 v171, v171, v230
    v_mul_f32 v228, v228, v232
    v_mul_f32 v0, v0, v232
    v_mul_f32 v1, v1, v232
    v_mul_f32 v2, v2, v232
    v_mul_f32 v3, v3, v232
    v_mul_f32 v8, v8, v232
    v_mul_f32 v9, v9, v232
    v_mul_f32 v10, v10, v232
    v_mul_f32 v11, v11, v232
    v_mul_f32 v16, v16, v232
    v_mul_f32 v17, v17, v232
    v_mul_f32 v18, v18, v232
    v_mul_f32 v19, v19, v232
    v_mul_f32 v24, v24, v232
    v_mul_f32 v25, v25, v232
    v_mul_f32 v26, v26, v232
    v_mul_f32 v27, v27, v232
    v_mul_f32 v32, v32, v232
    v_mul_f32 v33, v33, v232
    v_mul_f32 v34, v34, v232
    v_mul_f32 v35, v35, v232
    v_mul_f32 v40, v40, v232
    v_mul_f32 v41, v41, v232
    v_mul_f32 v42, v42, v232
    v_mul_f32 v43, v43, v232
    v_mul_f32 v48, v48, v232
    v_mul_f32 v49, v49, v232
    v_mul_f32 v50, v50, v232
    v_mul_f32 v51, v51, v232
    v_mul_f32 v56, v56, v232
    v_mul_f32 v57, v57, v232
    v_mul_f32 v58, v58, v232
    v_mul_f32 v59, v59, v232
    v_mul_f32 v64, v64, v232
    v_mul_f32 v65, v65, v232
    v_mul_f32 v66, v66, v232
    v_mul_f32 v67, v67, v232
    v_mul_f32 v72, v72, v232
    v_mul_f32 v73, v73, v232
    v_mul_f32 v74, v74, v232
    v_mul_f32 v75, v75, v232
    v_mul_f32 v80, v80, v232
    v_mul_f32 v81, v81, v232
    v_mul_f32 v82, v82, v232
    v_mul_f32 v83, v83, v232
    v_mul_f32 v88, v88, v232
    v_mul_f32 v89, v89, v232
    v_mul_f32 v90, v90, v232
    v_mul_f32 v91, v91, v232
    v_sub_f32 v212, v212, v231
    v_sub_f32 v213, v213, v231
    v_sub_f32 v214, v214, v231
    v_sub_f32 v215, v215, v231
    v_sub_f32 v148, v148, v231
    v_sub_f32 v149, v149, v231
    v_sub_f32 v150, v150, v231
    v_sub_f32 v151, v151, v231
    v_sub_f32 v156, v156, v231
    v_sub_f32 v157, v157, v231
    v_sub_f32 v158, v158, v231
    v_sub_f32 v159, v159, v231
    v_sub_f32 v164, v164, v231
    v_sub_f32 v165, v165, v231
    v_sub_f32 v166, v166, v231
    v_sub_f32 v167, v167, v231
    v_sub_f32 v172, v172, v231
    v_sub_f32 v173, v173, v231
    v_sub_f32 v174, v174, v231
    v_sub_f32 v175, v175, v231
    v_mul_f32 v229, v229, v233
    v_mul_f32 v4, v4, v233
    v_mul_f32 v5, v5, v233
    v_mul_f32 v6, v6, v233
    v_mul_f32 v7, v7, v233
    v_mul_f32 v12, v12, v233
    v_mul_f32 v13, v13, v233
    v_mul_f32 v14, v14, v233
    v_mul_f32 v15, v15, v233
    v_mul_f32 v20, v20, v233
    v_mul_f32 v21, v21, v233
    v_mul_f32 v22, v22, v233
    v_mul_f32 v23, v23, v233
    v_mul_f32 v28, v28, v233
    v_mul_f32 v29, v29, v233
    v_mul_f32 v30, v30, v233
    v_mul_f32 v31, v31, v233
    v_mul_f32 v36, v36, v233
    v_mul_f32 v37, v37, v233
    v_mul_f32 v38, v38, v233
    v_mul_f32 v39, v39, v233
    v_mul_f32 v44, v44, v233
    v_mul_f32 v45, v45, v233
    v_mul_f32 v46, v46, v233
    v_mul_f32 v47, v47, v233
    v_mul_f32 v52, v52, v233
    v_mul_f32 v53, v53, v233
    v_mul_f32 v54, v54, v233
    v_mul_f32 v55, v55, v233
    v_mul_f32 v60, v60, v233
    v_mul_f32 v61, v61, v233
    v_mul_f32 v62, v62, v233
    v_mul_f32 v63, v63, v233
    v_mul_f32 v68, v68, v233
    v_mul_f32 v69, v69, v233
    v_mul_f32 v70, v70, v233
    v_mul_f32 v71, v71, v233
    v_mul_f32 v76, v76, v233
    v_mul_f32 v77, v77, v233
    v_mul_f32 v78, v78, v233
    v_mul_f32 v79, v79, v233
    v_mul_f32 v84, v84, v233
    v_mul_f32 v85, v85, v233
    v_mul_f32 v86, v86, v233
    v_mul_f32 v87, v87, v233
    v_mul_f32 v92, v92, v233
    v_mul_f32 v93, v93, v233
    v_mul_f32 v94, v94, v233
    v_mul_f32 v95, v95, v233
    v_exp_f32 v230, v160
    v_exp_f32 v231, v161
    v_exp_f32 v232, v162
    v_exp_f32 v233, v163
    v_exp_f32 v234, v164
    v_cvt_pk_bf16_f32 v196, v230, v231
    v_exp_f32 v235, v165
    v_cvt_pk_bf16_f32 v197, v232, v233
    v_exp_f32 v236, v166
    v_exp_f32 v237, v167
    v_cvt_pk_bf16_f32 v204, v234, v235
    v_cvt_pk_bf16_f32 v205, v236, v237
    v_exp_f32 v230, v168
    v_exp_f32 v231, v169
    v_exp_f32 v232, v170
    v_exp_f32 v233, v171
    v_exp_f32 v234, v172
    v_cvt_pk_bf16_f32 v198, v230, v231
    v_exp_f32 v235, v173
    v_cvt_pk_bf16_f32 v199, v232, v233
    v_exp_f32 v236, v174
    v_exp_f32 v237, v175
    v_cvt_pk_bf16_f32 v206, v234, v235
    v_cvt_pk_bf16_f32 v207, v236, v237
    s_nop 1
    v_mfma_f32_16x16x32_bf16 v[216:219], v[224:227], v[196:199], 0
    v_mfma_f32_16x16x32_bf16 v[220:223], v[224:227], v[204:207], 0
    s_nop 7
    s_setpc_b64 s[76:77]
.section .rodata,"a"
.p2align 6
.amdhsa_kernel recurrent_scan__sliding_block_cached__glu_gated_geglu__prompt_kernel
  .amdhsa_next_free_vgpr 256
  .amdhsa_next_free_sgpr 102
  .amdhsa_accum_offset 256
  .amdhsa_group_segment_fixed_size 0
  .amdhsa_kernarg_size 96
  .amdhsa_user_sgpr_count 2
  .amdhsa_user_sgpr_kernarg_segment_ptr 1
  .amdhsa_system_sgpr_workgroup_id_x 1
.end_amdhsa_kernel
```
